```python
import torch

def _softmax(x, axis=-1):
    return torch.softmax(x, dim=axis)
def _gelu(x):
    return torch.nn.functional.gelu(x, approximate="tanh")
def _silu(x):
    return torch.nn.functional.silu(x)
def _sigmoid(x):
    return torch.sigmoid(x)
def _layernorm(x, axis=-1, eps=1e-5):
    m = x.mean(dim=axis, keepdim=True)
    v = x.var(dim=axis, keepdim=True, unbiased=False)
    return (x - m) / torch.sqrt(v + eps)
def _scatter_add(tgt, idx, src, axis=0):
    return tgt.clone().index_add_(axis, idx, src)
def _segment_sum(src, seg, n):
    out = torch.zeros((n,) + src.shape[1:], dtype=src.dtype)
    return out.index_add_(0, seg, src)
def _pad(x, pw):
    flat = tuple(v for pair in reversed(pw) for v in pair)
    return torch.nn.functional.pad(x, flat)

kernel_name = 'sequential_preLN__linear_kernel_hedgehog__glu_gated_glu__prompt'

def setup_inputs():

    _w = (lambda a: (lambda t: t.to(torch.bfloat16) if t.is_floating_point() else t)(torch.as_tensor(a)))
    def _A_setup():
        B, S, D, H = 1, 2048, 448, 16
        Dh = D // H
        return {
            "x": _w((lambda *s: torch.randn(*s, dtype=torch.bfloat16) * 0.05)(B, S, D)),
            "wqkv": _w((lambda *s: torch.randn(*s, dtype=torch.bfloat16) * 0.2)(D, 3 * D)),
            "w_phi": _w((lambda *s: torch.randn(*s, dtype=torch.bfloat16) * 0.2)(H, Dh, Dh) * (Dh ** -0.5)),
            "wo": _w((lambda *s: torch.randn(*s, dtype=torch.bfloat16) * 0.05)(D, D)),
        }
    _A_in = _A_setup()

    def _B_setup():
        B, S, D, F = 1, 2048, 448, 1792
        return {
            "x": _w((lambda *s: torch.randn(*s, dtype=torch.bfloat16) * 0.05)(B, S, D)),
            "w_gate": _w((lambda *s: torch.randn(*s, dtype=torch.bfloat16) * 0.05)(D, F)),
            "w_up": _w((lambda *s: torch.randn(*s, dtype=torch.bfloat16) * 0.05)(D, F)),
            "w_down": _w((lambda *s: torch.randn(*s, dtype=torch.bfloat16) * 0.05)(F, D)),
        }
    _B_in = _B_setup()

    return {
        "A_x": _A_in["x"],
        "A_wqkv": _A_in["wqkv"],
        "A_w_phi": _A_in["w_phi"],
        "A_wo": _A_in["wo"],
        "B_x": _B_in["x"],
        "B_w_gate": _B_in["w_gate"],
        "B_w_up": _B_in["w_up"],
        "B_w_down": _B_in["w_down"],
    }

def reference(A_x, A_wqkv, A_w_phi, A_wo, B_x, B_w_gate, B_w_up, B_w_down):
    def _A_ref(x, wqkv, w_phi, wo):
        B, S, D = x.shape
        H = 16; Dh = D // H
        qkv = (lambda x, *d: x.permute(*d))((x @ wqkv).reshape(B, S, 3, H, Dh), 2, 0, 3, 1, 4)
        q, k, v = qkv[0], qkv[1], qkv[2]
        pq = torch.einsum("bhsd,hdf->bhsf", q, w_phi)
        pk = torch.einsum("bhsd,hdf->bhsf", k, w_phi)
        phi_q = torch.concatenate([_softmax(pq, axis=-1), _softmax(-pq, axis=-1)], axis=-1)
        phi_k = torch.concatenate([_softmax(pk, axis=-1), _softmax(-pk, axis=-1)], axis=-1)
        kv = torch.einsum("bhsf,bhsd->bhfd", phi_k, v)
        z  = torch.einsum("bhsf->bhf", phi_k)
        num = torch.einsum("bhqf,bhfd->bhqd", phi_q, kv)
        den = torch.einsum("bhqf,bhf->bhq", phi_q, z)[..., None] + 1e-6
        o = num / den
        return (lambda x, *d: x.permute(*d))(o, 0, 2, 1, 3).reshape(B, S, D) @ wo

    def _B_ref(x, w_gate, w_up, w_down):
        g = torch.einsum("bsd,df->bsf", x, w_gate)
        u = torch.einsum("bsd,df->bsf", x, w_up)
        h = _sigmoid(g) * u
        return torch.einsum("bsf,fd->bsd", h, w_down)

    x = A_x
    h = x + _A_ref(_layernorm(x, axis=-1), A_wqkv, A_w_phi, A_wo)
    h2 = h + _B_ref(_layernorm(h, axis=-1), B_w_gate, B_w_up, B_w_down)
    return h2
```

```asm
; @launch kernel=k1_kernel grid=(256,1,1) block=(512,1,1) lds=155904
; @launch kernel=k3_kernel grid=(256,1,1) block=(256,1,1) lds=163840
.amdgcn_target "amdgcn-amd-amdhsa--gfx950"
.text
.globl k1_kernel
.p2align 8
.type k1_kernel,@function
k1_kernel:
    s_cmp_ge_u32 s2, 256
    s_cbranch_scc1 K1_END
    s_getpc_b64 s[52:53]
K1_PC:
    s_sub_u32 s52, s52, K1_PC-k1_kernel
    s_subb_u32 s53, s53, 0
    s_mov_b32 s54, K3_END-k1_kernel
    s_mov_b32 s55, 0x00020000
    s_lshr_b32 s50, s2, 3
    s_lshl_b32 s50, s50, 11
    v_lshrrev_b32 v254, 6, v0
    v_and_b32 v255, 1, v0
    v_lshl_add_u32 v254, v254, 1, v255
    v_lshlrev_b32 v254, 7, v254
    s_mov_b64 exec, 3
    buffer_load_dword v255, v254, s[52:55], s50 offen
    s_mov_b64 exec, -1
    s_load_dwordx4 s[4:7], s[0:1], 0
    s_load_dwordx4 s[8:11], s[0:1], 16
    s_load_dwordx4 s[12:15], s[0:1], 72
    s_load_dwordx4 s[56:59], s[0:1], 40
    s_load_dwordx2 s[68:69], s[0:1], 56
    v_and_b32 v1, 63, v0
    v_lshrrev_b32 v6, 6, v0
    s_nop 0
    v_readfirstlane_b32 s38, v6
    v_and_b32 v2, 31, v1
    v_lshrrev_b32 v3, 5, v1
    v_and_b32 v4, 15, v1
    v_lshrrev_b32 v5, 4, v1
    s_and_b32 s36, s2, 7
    s_lshl_b32 s36, s36, 1
    s_bfe_u32 s37, s2, 0x10003
    s_add_u32 s36, s36, s37
    s_lshr_b32 s37, s2, 4
    s_and_b32 s39, s38, 3
    s_lshr_b32 s40, s38, 2
    s_mov_b32 s42, 0
    s_mov_b32 s43, -1
    s_mov_b32 s44, 1069066811
    s_mov_b32 s45, 0x3f803f80
    s_mov_b32 s41, 0xffff0000
    s_and_b32 s67, s36, 1
    s_mul_i32 s67, s67, 3
    s_add_u32 s67, s67, s37
    s_cmp_ge_u32 s67, 7
    s_cselect_b32 s61, 7, 0
    s_sub_u32 s67, s67, s61
    s_cmp_ge_u32 s67, 7
    s_cselect_b32 s61, 7, 0
    s_sub_u32 s67, s67, s61
    s_lshl_b32 s46, s36, 7
    s_lshl_b32 s47, s39, 5
    s_add_u32 s46, s46, s47
    s_mul_i32 s47, s46, 896
    s_mul_i32 s48, s37, 56
    s_and_b32 s48, s48, 0xfffffff0
    s_mul_i32 s49, s39, 43008
    s_add_u32 s48, s48, s49
    s_lshl_b32 s60, s67, 7
    s_add_u32 s60, s60, s47
    s_mul_i32 s72, s67, 172032
    s_add_u32 s72, s72, s48
    s_add_u32 s67, s67, 1
    s_cmp_ge_u32 s67, 7
    s_cselect_b32 s67, 0, s67
    s_lshl_b32 s61, s67, 7
    s_add_u32 s61, s61, s47
    s_mul_i32 s73, s67, 172032
    s_add_u32 s73, s73, s48
    s_add_u32 s67, s67, 1
    s_cmp_ge_u32 s67, 7
    s_cselect_b32 s67, 0, s67
    s_lshl_b32 s62, s67, 7
    s_add_u32 s62, s62, s47
    s_mul_i32 s74, s67, 172032
    s_add_u32 s74, s74, s48
    s_add_u32 s67, s67, 1
    s_cmp_ge_u32 s67, 7
    s_cselect_b32 s67, 0, s67
    s_lshl_b32 s63, s67, 7
    s_add_u32 s63, s63, s47
    s_mul_i32 s75, s67, 172032
    s_add_u32 s75, s75, s48
    s_add_u32 s67, s67, 1
    s_cmp_ge_u32 s67, 7
    s_cselect_b32 s67, 0, s67
    s_lshl_b32 s64, s67, 7
    s_add_u32 s64, s64, s47
    s_mul_i32 s76, s67, 172032
    s_add_u32 s76, s76, s48
    s_add_u32 s67, s67, 1
    s_cmp_ge_u32 s67, 7
    s_cselect_b32 s67, 0, s67
    s_lshl_b32 s65, s67, 7
    s_add_u32 s65, s65, s47
    s_mul_i32 s77, s67, 172032
    s_add_u32 s77, s77, s48
    s_add_u32 s67, s67, 1
    s_cmp_ge_u32 s67, 7
    s_cselect_b32 s67, 0, s67
    s_lshl_b32 s66, s67, 7
    s_add_u32 s66, s66, s47
    s_mul_i32 s78, s67, 172032
    s_add_u32 s78, s78, s48
    s_cmp_eq_u32 s40, 1
    s_cbranch_scc1 K1_Q
    v_lshrrev_b32 v7, 3, v1
    v_and_b32 v8, 7, v1
    v_lshrrev_b32 v9, 1, v7
    v_and_b32 v9, 1, v9
    v_lshlrev_b32 v9, 2, v9
    v_xor_b32 v8, v8, v9
    v_mul_u32_u24 v7, 2688, v7
    v_lshrrev_b32 v9, 2, v8
    v_mul_u32_u24 v9, 896, v9
    v_and_b32 v8, 3, v8
    v_lshlrev_b32 v8, 4, v8
    v_add3_u32 v30, v7, v8, v9
    v_add_u32 v30, 896, v30
    s_lshl_b32 s49, s39, 11
    s_waitcnt lgkmcnt(0)
    s_mov_b32 s16, s4
    s_mov_b32 s17, s5
    s_mov_b32 s18, 1835008
    s_mov_b32 s19, 0x00020000
    s_mov_b32 s20, s6
    s_mov_b32 s21, s7
    s_mov_b32 s22, 1204224
    s_mov_b32 s23, 0x00020000
    s_mov_b32 s24, s8
    s_mov_b32 s25, s9
    s_mov_b32 s26, 25088
    s_mov_b32 s27, 0x00020000
    s_mov_b32 s28, s12
    s_mov_b32 s29, s13
    s_mov_b32 s30, 256
    s_mov_b32 s31, 0x00020000
    s_mov_b32 s32, s14
    s_mov_b32 s33, s15
    s_mov_b32 s34, 268435456
    s_mov_b32 s35, 0x00020000
    s_add_u32 m0, s49, 49152
    s_add_u32 s50, s72, 0
    buffer_load_dwordx4 v30, s[20:23], s50 offen lds
    s_add_u32 m0, s49, 50176
    s_add_u32 s50, s72, 21504
    buffer_load_dwordx4 v30, s[20:23], s50 offen lds
    s_add_u32 m0, s49, 73728
    s_add_u32 s50, s73, 0
    buffer_load_dwordx4 v30, s[20:23], s50 offen lds
    s_add_u32 m0, s49, 74752
    s_add_u32 s50, s73, 21504
    buffer_load_dwordx4 v30, s[20:23], s50 offen lds
    s_mul_i32 s50, s37, 1568
    s_and_b32 s51, s39, 1
    s_lshl_b32 s51, s51, 10
    s_add_u32 s50, s50, s51
    s_add_u32 m0, s51, 2048
    v_lshlrev_b32 v7, 4, v1
    buffer_load_dwordx4 v7, s[24:27], s50 offen lds
    v_lshrrev_b32 v7, 2, v4
    v_lshl_add_u32 v8, v3, 3, v7
    v_lshlrev_b32 v8, 7, v8
    v_and_b32 v9, 1, v5
    v_lshlrev_b32 v9, 2, v9
    v_and_b32 v10, 3, v4
    v_add_u32 v9, v9, v10
    v_lshl_add_u32 v8, v9, 3, v8
    s_and_b32 s50, s37, 1
    s_lshl_b32 s50, s50, 3
    s_add_u32 s51, s50, 49152
    v_add_u32 v8, s51, v8
    v_lshrrev_b32 v7, 1, v7
    v_lshl_add_u32 v240, v7, 6, v8
    v_xor_b32 v7, 1, v7
    v_lshl_add_u32 v241, v7, 6, v8
    v_add_u32 v242, 49152, v240
    v_add_u32 v243, 49152, v241
    v_add_u32 v244, 98304, v240
    v_add_u32 v245, 98304, v241
    s_lshl_b32 s50, s39, 5
    v_add_u32 v7, s50, v2
    v_lshrrev_b32 v8, 1, v7
    v_and_b32 v8, 7, v8
    v_xor_b32 v8, v8, v3
    v_lshlrev_b32 v8, 4, v8
    v_lshl_add_u32 v11, v7, 7, v8
    v_xor_b32 v7, 0, v11
    v_add_u32 v228, 32768, v7
    v_add_u32 v232, 81920, v7
    v_add_u32 v236, 131072, v7
    v_xor_b32 v7, 32, v11
    v_add_u32 v229, 32768, v7
    v_add_u32 v233, 81920, v7
    v_add_u32 v237, 131072, v7
    v_xor_b32 v7, 64, v11
    v_add_u32 v230, 32768, v7
    v_add_u32 v234, 81920, v7
    v_add_u32 v238, 131072, v7
    v_xor_b32 v7, 96, v11
    v_add_u32 v231, 32768, v7
    v_add_u32 v235, 81920, v7
    v_add_u32 v239, 131072, v7
    v_lshrrev_b32 v7, 2, v4
    v_lshl_add_u32 v7, v3, 2, v7
    v_mul_u32_u24 v7, 56, v7
    v_lshl_add_u32 v12, v9, 3, v7
    s_lshl_b32 s50, s39, 7
    v_lshl_add_u32 v9, v2, 2, s50
    v_cmp_eq_u32 s[52:53], 28, v2
    v_mov_b32 v92, s45
    s_lshl_b32 s50, s39, 5
    v_add_u32 v7, s50, v2
    v_lshrrev_b32 v8, 1, v7
    v_and_b32 v8, 7, v8
    v_xor_b32 v8, v8, v3
    v_lshlrev_b32 v8, 3, v8
    v_lshl_add_u32 v74, v7, 6, v8
    v_lshrrev_b32 v8, 1, v7
    v_and_b32 v8, 1, v8
    v_lshlrev_b32 v8, 3, v8
    v_and_b32 v10, 1, v7
    v_or_b32 v8, v8, v10
    v_lshrrev_b32 v10, 2, v7
    v_and_b32 v10, 3, v10
    v_lshl_or_b32 v8, v10, 1, v8
    v_xor_b32 v8, v8, v3
    v_lshlrev_b32 v8, 3, v8
    v_lshl_add_u32 v75, v7, 7, v8
    v_lshrrev_b32 v7, 2, v4
    v_lshl_add_u32 v7, v3, 3, v7
    v_and_b32 v8, 1, v5
    v_lshlrev_b32 v8, 2, v8
    v_and_b32 v13, 3, v4
    v_add_u32 v8, v8, v13
    v_add_u32 v13, 0, v7
    v_lshrrev_b32 v10, 1, v13
    v_xor_b32 v10, v10, v8
    v_lshlrev_b32 v10, 3, v10
    v_lshl_add_u32 v76, v13, 6, v10
    v_lshrrev_b32 v10, 1, v13
    v_and_b32 v10, 1, v10
    v_lshlrev_b32 v10, 3, v10
    v_and_b32 v11, 1, v13
    v_or_b32 v10, v10, v11
    v_lshrrev_b32 v11, 2, v13
    v_lshl_or_b32 v10, v11, 1, v10
    v_xor_b32 v10, v10, v8
    s_lshl_b32 s50, s39, 3
    v_xor_b32 v10, s50, v10
    v_lshlrev_b32 v10, 3, v10
    v_lshl_add_u32 v78, v13, 7, v10
    v_add_u32 v13, 4, v7
    v_lshrrev_b32 v10, 1, v13
    v_xor_b32 v10, v10, v8
    v_lshlrev_b32 v10, 3, v10
    v_lshl_add_u32 v77, v13, 6, v10
    v_lshrrev_b32 v10, 1, v13
    v_and_b32 v10, 1, v10
    v_lshlrev_b32 v10, 3, v10
    v_and_b32 v11, 1, v13
    v_or_b32 v10, v10, v11
    v_lshrrev_b32 v11, 2, v13
    v_lshl_or_b32 v10, v11, 1, v10
    v_xor_b32 v10, v10, v8
    s_lshl_b32 s50, s39, 3
    v_xor_b32 v10, s50, v10
    v_lshlrev_b32 v10, 3, v10
    v_lshl_add_u32 v79, v13, 7, v10
    s_lshl_b32 s50, s37, 13
    s_lshl_b32 s51, s39, 7
    s_add_u32 s50, s50, s51
    v_lshlrev_b32 v80, 10, v3
    v_lshl_add_u32 v80, v2, 2, v80
    v_add_u32 v80, s50, v80
    v_add_u32 v81, 4096, v80
    v_mov_b32 v82, 0
    v_mov_b32 v83, 0
    v_mov_b32 v84, 0
    v_mov_b32 v85, 0
    ds_write_b128 v82, v[82:85] offset:448
    ds_write_b128 v82, v[82:85] offset:464
    s_lshl_b32 s50, s39, 2
    v_mov_b32 v86, s50
    v_mov_b32 v87, 1
    s_waitcnt lgkmcnt(0)
    v_mov_b32 v72, 0
    v_mov_b32 v73, 0
    s_waitcnt vmcnt(3)
    s_barrier
    s_add_u32 m0, s49, 98304
    s_add_u32 s50, s74, 0
    buffer_load_dwordx4 v30, s[20:23], s50 offen lds
    s_add_u32 m0, s49, 99328
    s_add_u32 s50, s74, 21504
    buffer_load_dwordx4 v30, s[20:23], s50 offen lds
    s_add_u32 m0, s49, 122880
    s_add_u32 s50, s75, 0
    buffer_load_dwordx4 v30, s[20:23], s50 offen lds
    s_add_u32 m0, s49, 123904
    s_add_u32 s50, s75, 21504
    buffer_load_dwordx4 v30, s[20:23], s50 offen lds
    s_add_u32 m0, s49, 147456
    s_add_u32 s50, s76, 0
    buffer_load_dwordx4 v30, s[20:23], s50 offen lds
    s_add_u32 m0, s49, 148480
    s_add_u32 s50, s76, 21504
    buffer_load_dwordx4 v30, s[20:23], s50 offen lds
    ds_read_b128 v[34:37], v228 offset:0
    ds_read_b64_tr_b16 v[46:47], v240 offset:0
    ds_read_b64_tr_b16 v[48:49], v240 offset:512
    ds_read_b64_tr_b16 v[50:51], v241 offset:0
    ds_read_b64_tr_b16 v[52:53], v241 offset:512
    ds_read_b128 v[38:41], v229 offset:0
    ds_read_b64_tr_b16 v[54:55], v240 offset:2048
    ds_read_b64_tr_b16 v[56:57], v240 offset:2560
    ds_read_b64_tr_b16 v[58:59], v241 offset:2048
    ds_read_b64_tr_b16 v[60:61], v241 offset:2560
    ds_read_b128 v[42:45], v230 offset:0
    ds_read_b64_tr_b16 v[62:63], v240 offset:4096
    ds_read_b64_tr_b16 v[64:65], v240 offset:4608
    ds_read_b64_tr_b16 v[66:67], v241 offset:4096
    ds_read_b64_tr_b16 v[68:69], v241 offset:4608
    s_waitcnt lgkmcnt(10)
    v_cndmask_b32 v50, v50, v92, s[52:53]
    v_cndmask_b32 v51, v51, v92, s[52:53]
    v_cndmask_b32 v52, v52, v92, s[52:53]
    v_cndmask_b32 v53, v53, v92, s[52:53]
    v_mfma_f32_32x32x16_bf16 v[100:115], v[46:49], v[34:37], 0
    v_lshlrev_b32 v10, 16, v36
    v_and_b32 v11, s41, v36
    v_fmac_f32 v72, v10, v10
    v_fmac_f32 v73, v11, v11
    v_mfma_f32_32x32x16_bf16 v[116:131], v[50:53], v[34:37], 0
    v_lshlrev_b32 v10, 16, v37
    v_and_b32 v11, s41, v37
    v_fmac_f32 v72, v10, v10
    v_fmac_f32 v73, v11, v11
    ds_read_b128 v[34:37], v231 offset:0
    ds_read_b64_tr_b16 v[46:47], v240 offset:6144
    ds_read_b64_tr_b16 v[48:49], v240 offset:6656
    ds_read_b64_tr_b16 v[50:51], v241 offset:6144
    ds_read_b64_tr_b16 v[52:53], v241 offset:6656
    s_waitcnt lgkmcnt(10)
    v_cndmask_b32 v58, v58, v92, s[52:53]
    v_cndmask_b32 v59, v59, v92, s[52:53]
    v_cndmask_b32 v60, v60, v92, s[52:53]
    v_cndmask_b32 v61, v61, v92, s[52:53]
    v_mfma_f32_32x32x16_bf16 v[100:115], v[54:57], v[38:41], v[100:115]
    v_lshlrev_b32 v10, 16, v40
    v_and_b32 v11, s41, v40
    v_fmac_f32 v72, v10, v10
    v_fmac_f32 v73, v11, v11
    v_mfma_f32_32x32x16_bf16 v[116:131], v[58:61], v[38:41], v[116:131]
    v_lshlrev_b32 v10, 16, v41
    v_and_b32 v11, s41, v41
    v_fmac_f32 v72, v10, v10
    v_fmac_f32 v73, v11, v11
    s_waitcnt vmcnt(6)
    s_barrier
    ds_read_b128 v[38:41], v228 offset:24576
    ds_read_b64_tr_b16 v[54:55], v240 offset:24576
    ds_read_b64_tr_b16 v[56:57], v240 offset:25088
    ds_read_b64_tr_b16 v[58:59], v241 offset:24576
    ds_read_b64_tr_b16 v[60:61], v241 offset:25088
    s_waitcnt lgkmcnt(10)
    v_cndmask_b32 v66, v66, v92, s[52:53]
    v_cndmask_b32 v67, v67, v92, s[52:53]
    v_cndmask_b32 v68, v68, v92, s[52:53]
    v_cndmask_b32 v69, v69, v92, s[52:53]
    v_mfma_f32_32x32x16_bf16 v[100:115], v[62:65], v[42:45], v[100:115]
    v_lshlrev_b32 v10, 16, v44
    v_and_b32 v11, s41, v44
    v_fmac_f32 v72, v10, v10
    v_fmac_f32 v73, v11, v11
    v_mfma_f32_32x32x16_bf16 v[116:131], v[66:69], v[42:45], v[116:131]
    v_lshlrev_b32 v10, 16, v45
    v_and_b32 v11, s41, v45
    v_fmac_f32 v72, v10, v10
    v_fmac_f32 v73, v11, v11
    ds_read_b128 v[42:45], v229 offset:24576
    ds_read_b64_tr_b16 v[62:63], v240 offset:26624
    ds_read_b64_tr_b16 v[64:65], v240 offset:27136
    ds_read_b64_tr_b16 v[66:67], v241 offset:26624
    ds_read_b64_tr_b16 v[68:69], v241 offset:27136
    s_waitcnt lgkmcnt(10)
    v_cndmask_b32 v50, v50, v92, s[52:53]
    v_cndmask_b32 v51, v51, v92, s[52:53]
    v_cndmask_b32 v52, v52, v92, s[52:53]
    v_cndmask_b32 v53, v53, v92, s[52:53]
    v_mfma_f32_32x32x16_bf16 v[100:115], v[46:49], v[34:37], v[100:115]
    v_lshlrev_b32 v10, 16, v36
    v_and_b32 v11, s41, v36
    v_fmac_f32 v72, v10, v10
    v_fmac_f32 v73, v11, v11
    v_mfma_f32_32x32x16_bf16 v[116:131], v[50:53], v[34:37], v[116:131]
    v_lshlrev_b32 v10, 16, v37
    v_and_b32 v11, s41, v37
    v_fmac_f32 v72, v10, v10
    v_fmac_f32 v73, v11, v11
    ds_read_b128 v[34:37], v230 offset:24576
    ds_read_b64_tr_b16 v[46:47], v240 offset:28672
    ds_read_b64_tr_b16 v[48:49], v240 offset:29184
    ds_read_b64_tr_b16 v[50:51], v241 offset:28672
    ds_read_b64_tr_b16 v[52:53], v241 offset:29184
    s_waitcnt lgkmcnt(10)
    v_cndmask_b32 v58, v58, v92, s[52:53]
    v_cndmask_b32 v59, v59, v92, s[52:53]
    v_cndmask_b32 v60, v60, v92, s[52:53]
    v_cndmask_b32 v61, v61, v92, s[52:53]
    v_mfma_f32_32x32x16_bf16 v[100:115], v[54:57], v[38:41], v[100:115]
    v_lshlrev_b32 v10, 16, v40
    v_and_b32 v11, s41, v40
    v_fmac_f32 v72, v10, v10
    v_fmac_f32 v73, v11, v11
    v_mfma_f32_32x32x16_bf16 v[116:131], v[58:61], v[38:41], v[116:131]
    v_lshlrev_b32 v10, 16, v41
    v_and_b32 v11, s41, v41
    v_fmac_f32 v72, v10, v10
    v_fmac_f32 v73, v11, v11
    ds_read_b128 v[38:41], v231 offset:24576
    ds_read_b64_tr_b16 v[54:55], v240 offset:30720
    ds_read_b64_tr_b16 v[56:57], v240 offset:31232
    ds_read_b64_tr_b16 v[58:59], v241 offset:30720
    ds_read_b64_tr_b16 v[60:61], v241 offset:31232
    s_waitcnt lgkmcnt(10)
    v_cndmask_b32 v66, v66, v92, s[52:53]
    v_cndmask_b32 v67, v67, v92, s[52:53]
    v_cndmask_b32 v68, v68, v92, s[52:53]
    v_cndmask_b32 v69, v69, v92, s[52:53]
    v_mfma_f32_32x32x16_bf16 v[100:115], v[62:65], v[42:45], v[100:115]
    v_lshlrev_b32 v10, 16, v44
    v_and_b32 v11, s41, v44
    v_fmac_f32 v72, v10, v10
    v_fmac_f32 v73, v11, v11
    v_mfma_f32_32x32x16_bf16 v[116:131], v[66:69], v[42:45], v[116:131]
    v_lshlrev_b32 v10, 16, v45
    v_and_b32 v11, s41, v45
    v_fmac_f32 v72, v10, v10
    v_fmac_f32 v73, v11, v11
    s_waitcnt vmcnt(4)
    s_barrier
    ds_read_b128 v[42:45], v232 offset:0
    ds_read_b64_tr_b16 v[62:63], v242 offset:0
    ds_read_b64_tr_b16 v[64:65], v242 offset:512
    ds_read_b64_tr_b16 v[66:67], v243 offset:0
    ds_read_b64_tr_b16 v[68:69], v243 offset:512
    s_waitcnt lgkmcnt(10)
    v_cndmask_b32 v50, v50, v92, s[52:53]
    v_cndmask_b32 v51, v51, v92, s[52:53]
    v_cndmask_b32 v52, v52, v92, s[52:53]
    v_cndmask_b32 v53, v53, v92, s[52:53]
    v_mfma_f32_32x32x16_bf16 v[100:115], v[46:49], v[34:37], v[100:115]
    v_lshlrev_b32 v10, 16, v36
    v_and_b32 v11, s41, v36
    v_fmac_f32 v72, v10, v10
    v_fmac_f32 v73, v11, v11
    v_mfma_f32_32x32x16_bf16 v[116:131], v[50:53], v[34:37], v[116:131]
    v_lshlrev_b32 v10, 16, v37
    v_and_b32 v11, s41, v37
    v_fmac_f32 v72, v10, v10
    v_fmac_f32 v73, v11, v11
    s_add_u32 m0, s49, 49152
    s_add_u32 s50, s77, 0
    buffer_load_dwordx4 v30, s[20:23], s50 offen lds
    s_add_u32 m0, s49, 50176
    s_add_u32 s50, s77, 21504
    buffer_load_dwordx4 v30, s[20:23], s50 offen lds
    ds_read_b128 v[34:37], v233 offset:0
    ds_read_b64_tr_b16 v[46:47], v242 offset:2048
    ds_read_b64_tr_b16 v[48:49], v242 offset:2560
    ds_read_b64_tr_b16 v[50:51], v243 offset:2048
    ds_read_b64_tr_b16 v[52:53], v243 offset:2560
    s_waitcnt lgkmcnt(10)
    v_cndmask_b32 v58, v58, v92, s[52:53]
    v_cndmask_b32 v59, v59, v92, s[52:53]
    v_cndmask_b32 v60, v60, v92, s[52:53]
    v_cndmask_b32 v61, v61, v92, s[52:53]
    v_mfma_f32_32x32x16_bf16 v[100:115], v[54:57], v[38:41], v[100:115]
    v_lshlrev_b32 v10, 16, v40
    v_and_b32 v11, s41, v40
    v_fmac_f32 v72, v10, v10
    v_fmac_f32 v73, v11, v11
    v_mfma_f32_32x32x16_bf16 v[116:131], v[58:61], v[38:41], v[116:131]
    v_lshlrev_b32 v10, 16, v41
    v_and_b32 v11, s41, v41
    v_fmac_f32 v72, v10, v10
    v_fmac_f32 v73, v11, v11
    ds_read_b128 v[38:41], v234 offset:0
    ds_read_b64_tr_b16 v[54:55], v242 offset:4096
    ds_read_b64_tr_b16 v[56:57], v242 offset:4608
    ds_read_b64_tr_b16 v[58:59], v243 offset:4096
    ds_read_b64_tr_b16 v[60:61], v243 offset:4608
    s_waitcnt lgkmcnt(10)
    v_cndmask_b32 v66, v66, v92, s[52:53]
    v_cndmask_b32 v67, v67, v92, s[52:53]
    v_cndmask_b32 v68, v68, v92, s[52:53]
    v_cndmask_b32 v69, v69, v92, s[52:53]
    v_mfma_f32_32x32x16_bf16 v[100:115], v[62:65], v[42:45], v[100:115]
    v_lshlrev_b32 v10, 16, v44
    v_and_b32 v11, s41, v44
    v_fmac_f32 v72, v10, v10
    v_fmac_f32 v73, v11, v11
    v_mfma_f32_32x32x16_bf16 v[116:131], v[66:69], v[42:45], v[116:131]
    v_lshlrev_b32 v10, 16, v45
    v_and_b32 v11, s41, v45
    v_fmac_f32 v72, v10, v10
    v_fmac_f32 v73, v11, v11
    ds_read_b128 v[42:45], v235 offset:0
    ds_read_b64_tr_b16 v[62:63], v242 offset:6144
    ds_read_b64_tr_b16 v[64:65], v242 offset:6656
    ds_read_b64_tr_b16 v[66:67], v243 offset:6144
    ds_read_b64_tr_b16 v[68:69], v243 offset:6656
    s_waitcnt lgkmcnt(10)
    v_cndmask_b32 v50, v50, v92, s[52:53]
    v_cndmask_b32 v51, v51, v92, s[52:53]
    v_cndmask_b32 v52, v52, v92, s[52:53]
    v_cndmask_b32 v53, v53, v92, s[52:53]
    v_mfma_f32_32x32x16_bf16 v[100:115], v[46:49], v[34:37], v[100:115]
    v_lshlrev_b32 v10, 16, v36
    v_and_b32 v11, s41, v36
    v_fmac_f32 v72, v10, v10
    v_fmac_f32 v73, v11, v11
    v_mfma_f32_32x32x16_bf16 v[116:131], v[50:53], v[34:37], v[116:131]
    v_lshlrev_b32 v10, 16, v37
    v_and_b32 v11, s41, v37
    v_fmac_f32 v72, v10, v10
    v_fmac_f32 v73, v11, v11
    s_waitcnt vmcnt(4)
    s_barrier
    ds_read_b128 v[34:37], v232 offset:24576
    ds_read_b64_tr_b16 v[46:47], v242 offset:24576
    ds_read_b64_tr_b16 v[48:49], v242 offset:25088
    ds_read_b64_tr_b16 v[50:51], v243 offset:24576
    ds_read_b64_tr_b16 v[52:53], v243 offset:25088
    s_waitcnt lgkmcnt(10)
    v_cndmask_b32 v58, v58, v92, s[52:53]
    v_cndmask_b32 v59, v59, v92, s[52:53]
    v_cndmask_b32 v60, v60, v92, s[52:53]
    v_cndmask_b32 v61, v61, v92, s[52:53]
    v_mfma_f32_32x32x16_bf16 v[100:115], v[54:57], v[38:41], v[100:115]
    v_lshlrev_b32 v10, 16, v40
    v_and_b32 v11, s41, v40
    v_fmac_f32 v72, v10, v10
    v_fmac_f32 v73, v11, v11
    v_mfma_f32_32x32x16_bf16 v[116:131], v[58:61], v[38:41], v[116:131]
    v_lshlrev_b32 v10, 16, v41
    v_and_b32 v11, s41, v41
    v_fmac_f32 v72, v10, v10
    v_fmac_f32 v73, v11, v11
    s_add_u32 m0, s49, 73728
    s_add_u32 s50, s78, 0
    buffer_load_dwordx4 v30, s[20:23], s50 offen lds
    s_add_u32 m0, s49, 74752
    s_add_u32 s50, s78, 21504
    buffer_load_dwordx4 v30, s[20:23], s50 offen lds
    ds_read_b128 v[38:41], v233 offset:24576
    ds_read_b64_tr_b16 v[54:55], v242 offset:26624
    ds_read_b64_tr_b16 v[56:57], v242 offset:27136
    ds_read_b64_tr_b16 v[58:59], v243 offset:26624
    ds_read_b64_tr_b16 v[60:61], v243 offset:27136
    s_waitcnt lgkmcnt(10)
    v_cndmask_b32 v66, v66, v92, s[52:53]
    v_cndmask_b32 v67, v67, v92, s[52:53]
    v_cndmask_b32 v68, v68, v92, s[52:53]
    v_cndmask_b32 v69, v69, v92, s[52:53]
    v_mfma_f32_32x32x16_bf16 v[100:115], v[62:65], v[42:45], v[100:115]
    v_lshlrev_b32 v10, 16, v44
    v_and_b32 v11, s41, v44
    v_fmac_f32 v72, v10, v10
    v_fmac_f32 v73, v11, v11
    v_mfma_f32_32x32x16_bf16 v[116:131], v[66:69], v[42:45], v[116:131]
    v_lshlrev_b32 v10, 16, v45
    v_and_b32 v11, s41, v45
    v_fmac_f32 v72, v10, v10
    v_fmac_f32 v73, v11, v11
    ds_read_b128 v[42:45], v234 offset:24576
    ds_read_b64_tr_b16 v[62:63], v242 offset:28672
    ds_read_b64_tr_b16 v[64:65], v242 offset:29184
    ds_read_b64_tr_b16 v[66:67], v243 offset:28672
    ds_read_b64_tr_b16 v[68:69], v243 offset:29184
    s_waitcnt lgkmcnt(10)
    v_cndmask_b32 v50, v50, v92, s[52:53]
    v_cndmask_b32 v51, v51, v92, s[52:53]
    v_cndmask_b32 v52, v52, v92, s[52:53]
    v_cndmask_b32 v53, v53, v92, s[52:53]
    v_mfma_f32_32x32x16_bf16 v[100:115], v[46:49], v[34:37], v[100:115]
    v_lshlrev_b32 v10, 16, v36
    v_and_b32 v11, s41, v36
    v_fmac_f32 v72, v10, v10
    v_fmac_f32 v73, v11, v11
    v_mfma_f32_32x32x16_bf16 v[116:131], v[50:53], v[34:37], v[116:131]
    v_lshlrev_b32 v10, 16, v37
    v_and_b32 v11, s41, v37
    v_fmac_f32 v72, v10, v10
    v_fmac_f32 v73, v11, v11
    ds_read_b128 v[34:37], v235 offset:24576
    ds_read_b64_tr_b16 v[46:47], v242 offset:30720
    ds_read_b64_tr_b16 v[48:49], v242 offset:31232
    ds_read_b64_tr_b16 v[50:51], v243 offset:30720
    ds_read_b64_tr_b16 v[52:53], v243 offset:31232
    s_waitcnt lgkmcnt(10)
    v_cndmask_b32 v58, v58, v92, s[52:53]
    v_cndmask_b32 v59, v59, v92, s[52:53]
    v_cndmask_b32 v60, v60, v92, s[52:53]
    v_cndmask_b32 v61, v61, v92, s[52:53]
    v_mfma_f32_32x32x16_bf16 v[100:115], v[54:57], v[38:41], v[100:115]
    v_lshlrev_b32 v10, 16, v40
    v_and_b32 v11, s41, v40
    v_fmac_f32 v72, v10, v10
    v_fmac_f32 v73, v11, v11
    v_mfma_f32_32x32x16_bf16 v[116:131], v[58:61], v[38:41], v[116:131]
    v_lshlrev_b32 v10, 16, v41
    v_and_b32 v11, s41, v41
    v_fmac_f32 v72, v10, v10
    v_fmac_f32 v73, v11, v11
    s_waitcnt vmcnt(4)
    s_barrier
    ds_read_b128 v[38:41], v236 offset:0
    ds_read_b64_tr_b16 v[54:55], v244 offset:0
    ds_read_b64_tr_b16 v[56:57], v244 offset:512
    ds_read_b64_tr_b16 v[58:59], v245 offset:0
    ds_read_b64_tr_b16 v[60:61], v245 offset:512
    s_waitcnt lgkmcnt(10)
    v_cndmask_b32 v66, v66, v92, s[52:53]
    v_cndmask_b32 v67, v67, v92, s[52:53]
    v_cndmask_b32 v68, v68, v92, s[52:53]
    v_cndmask_b32 v69, v69, v92, s[52:53]
    v_mfma_f32_32x32x16_bf16 v[100:115], v[62:65], v[42:45], v[100:115]
    v_lshlrev_b32 v10, 16, v44
    v_and_b32 v11, s41, v44
    v_fmac_f32 v72, v10, v10
    v_fmac_f32 v73, v11, v11
    v_mfma_f32_32x32x16_bf16 v[116:131], v[66:69], v[42:45], v[116:131]
    v_lshlrev_b32 v10, 16, v45
    v_and_b32 v11, s41, v45
    v_fmac_f32 v72, v10, v10
    v_fmac_f32 v73, v11, v11
    ds_read_b128 v[42:45], v237 offset:0
    ds_read_b64_tr_b16 v[62:63], v244 offset:2048
    ds_read_b64_tr_b16 v[64:65], v244 offset:2560
    ds_read_b64_tr_b16 v[66:67], v245 offset:2048
    ds_read_b64_tr_b16 v[68:69], v245 offset:2560
    s_waitcnt lgkmcnt(10)
    v_cndmask_b32 v50, v50, v92, s[52:53]
    v_cndmask_b32 v51, v51, v92, s[52:53]
    v_cndmask_b32 v52, v52, v92, s[52:53]
    v_cndmask_b32 v53, v53, v92, s[52:53]
    v_mfma_f32_32x32x16_bf16 v[100:115], v[46:49], v[34:37], v[100:115]
    v_lshlrev_b32 v10, 16, v36
    v_and_b32 v11, s41, v36
    v_fmac_f32 v72, v10, v10
    v_fmac_f32 v73, v11, v11
    v_mfma_f32_32x32x16_bf16 v[116:131], v[50:53], v[34:37], v[116:131]
    v_lshlrev_b32 v10, 16, v37
    v_and_b32 v11, s41, v37
    v_fmac_f32 v72, v10, v10
    v_fmac_f32 v73, v11, v11
    ds_read_b128 v[34:37], v238 offset:0
    ds_read_b64_tr_b16 v[46:47], v244 offset:4096
    ds_read_b64_tr_b16 v[48:49], v244 offset:4608
    ds_read_b64_tr_b16 v[50:51], v245 offset:4096
    ds_read_b64_tr_b16 v[52:53], v245 offset:4608
    s_waitcnt lgkmcnt(10)
    v_cndmask_b32 v58, v58, v92, s[52:53]
    v_cndmask_b32 v59, v59, v92, s[52:53]
    v_cndmask_b32 v60, v60, v92, s[52:53]
    v_cndmask_b32 v61, v61, v92, s[52:53]
    v_mfma_f32_32x32x16_bf16 v[100:115], v[54:57], v[38:41], v[100:115]
    v_lshlrev_b32 v10, 16, v40
    v_and_b32 v11, s41, v40
    v_fmac_f32 v72, v10, v10
    v_fmac_f32 v73, v11, v11
    v_mfma_f32_32x32x16_bf16 v[116:131], v[58:61], v[38:41], v[116:131]
    v_lshlrev_b32 v10, 16, v41
    v_and_b32 v11, s41, v41
    v_fmac_f32 v72, v10, v10
    v_fmac_f32 v73, v11, v11
    ds_read_b128 v[38:41], v239 offset:0
    ds_read_b64_tr_b16 v[54:55], v244 offset:6144
    ds_read_b64_tr_b16 v[56:57], v244 offset:6656
    ds_read_b64_tr_b16 v[58:59], v245 offset:6144
    ds_read_b64_tr_b16 v[60:61], v245 offset:6656
    s_waitcnt lgkmcnt(10)
    v_cndmask_b32 v66, v66, v92, s[52:53]
    v_cndmask_b32 v67, v67, v92, s[52:53]
    v_cndmask_b32 v68, v68, v92, s[52:53]
    v_cndmask_b32 v69, v69, v92, s[52:53]
    v_mfma_f32_32x32x16_bf16 v[100:115], v[62:65], v[42:45], v[100:115]
    v_lshlrev_b32 v10, 16, v44
    v_and_b32 v11, s41, v44
    v_fmac_f32 v72, v10, v10
    v_fmac_f32 v73, v11, v11
    v_mfma_f32_32x32x16_bf16 v[116:131], v[66:69], v[42:45], v[116:131]
    v_lshlrev_b32 v10, 16, v45
    v_and_b32 v11, s41, v45
    v_fmac_f32 v72, v10, v10
    v_fmac_f32 v73, v11, v11
    s_waitcnt vmcnt(2)
    s_barrier
    ds_read_b128 v[42:45], v228 offset:0
    ds_read_b64_tr_b16 v[62:63], v240 offset:0
    ds_read_b64_tr_b16 v[64:65], v240 offset:512
    ds_read_b64_tr_b16 v[66:67], v241 offset:0
    ds_read_b64_tr_b16 v[68:69], v241 offset:512
    s_waitcnt lgkmcnt(10)
    v_cndmask_b32 v50, v50, v92, s[52:53]
    v_cndmask_b32 v51, v51, v92, s[52:53]
    v_cndmask_b32 v52, v52, v92, s[52:53]
    v_cndmask_b32 v53, v53, v92, s[52:53]
    v_mfma_f32_32x32x16_bf16 v[100:115], v[46:49], v[34:37], v[100:115]
    v_lshlrev_b32 v10, 16, v36
    v_and_b32 v11, s41, v36
    v_fmac_f32 v72, v10, v10
    v_fmac_f32 v73, v11, v11
    v_mfma_f32_32x32x16_bf16 v[116:131], v[50:53], v[34:37], v[116:131]
    v_lshlrev_b32 v10, 16, v37
    v_and_b32 v11, s41, v37
    v_fmac_f32 v72, v10, v10
    v_fmac_f32 v73, v11, v11
    ds_read_b128 v[34:37], v229 offset:0
    ds_read_b64_tr_b16 v[46:47], v240 offset:2048
    ds_read_b64_tr_b16 v[48:49], v240 offset:2560
    ds_read_b64_tr_b16 v[50:51], v241 offset:2048
    ds_read_b64_tr_b16 v[52:53], v241 offset:2560
    s_waitcnt lgkmcnt(10)
    v_cndmask_b32 v58, v58, v92, s[52:53]
    v_cndmask_b32 v59, v59, v92, s[52:53]
    v_cndmask_b32 v60, v60, v92, s[52:53]
    v_cndmask_b32 v61, v61, v92, s[52:53]
    v_mfma_f32_32x32x16_bf16 v[100:115], v[54:57], v[38:41], v[100:115]
    v_lshlrev_b32 v10, 16, v40
    v_and_b32 v11, s41, v40
    v_fmac_f32 v72, v10, v10
    v_fmac_f32 v73, v11, v11
    v_mfma_f32_32x32x16_bf16 v[116:131], v[58:61], v[38:41], v[116:131]
    v_lshlrev_b32 v10, 16, v41
    v_and_b32 v11, s41, v41
    v_fmac_f32 v72, v10, v10
    v_fmac_f32 v73, v11, v11
    ds_read_b128 v[38:41], v230 offset:0
    ds_read_b64_tr_b16 v[54:55], v240 offset:4096
    ds_read_b64_tr_b16 v[56:57], v240 offset:4608
    ds_read_b64_tr_b16 v[58:59], v241 offset:4096
    ds_read_b64_tr_b16 v[60:61], v241 offset:4608
    s_waitcnt lgkmcnt(10)
    v_cndmask_b32 v66, v66, v92, s[52:53]
    v_cndmask_b32 v67, v67, v92, s[52:53]
    v_cndmask_b32 v68, v68, v92, s[52:53]
    v_cndmask_b32 v69, v69, v92, s[52:53]
    v_mfma_f32_32x32x16_bf16 v[100:115], v[62:65], v[42:45], v[100:115]
    v_lshlrev_b32 v10, 16, v44
    v_and_b32 v11, s41, v44
    v_fmac_f32 v72, v10, v10
    v_fmac_f32 v73, v11, v11
    v_mfma_f32_32x32x16_bf16 v[116:131], v[66:69], v[42:45], v[116:131]
    v_lshlrev_b32 v10, 16, v45
    v_and_b32 v11, s41, v45
    v_fmac_f32 v72, v10, v10
    v_fmac_f32 v73, v11, v11
    ds_read_b128 v[42:45], v231 offset:0
    ds_read_b64_tr_b16 v[62:63], v240 offset:6144
    ds_read_b64_tr_b16 v[64:65], v240 offset:6656
    ds_read_b64_tr_b16 v[66:67], v241 offset:6144
    ds_read_b64_tr_b16 v[68:69], v241 offset:6656
    s_waitcnt lgkmcnt(10)
    v_cndmask_b32 v50, v50, v92, s[52:53]
    v_cndmask_b32 v51, v51, v92, s[52:53]
    v_cndmask_b32 v52, v52, v92, s[52:53]
    v_cndmask_b32 v53, v53, v92, s[52:53]
    v_mfma_f32_32x32x16_bf16 v[100:115], v[46:49], v[34:37], v[100:115]
    v_lshlrev_b32 v10, 16, v36
    v_and_b32 v11, s41, v36
    v_fmac_f32 v72, v10, v10
    v_fmac_f32 v73, v11, v11
    v_mfma_f32_32x32x16_bf16 v[116:131], v[50:53], v[34:37], v[116:131]
    v_lshlrev_b32 v10, 16, v37
    v_and_b32 v11, s41, v37
    v_fmac_f32 v72, v10, v10
    v_fmac_f32 v73, v11, v11
    s_waitcnt vmcnt(0)
    s_barrier
    ds_read_b128 v[34:37], v228 offset:24576
    ds_read_b64_tr_b16 v[46:47], v240 offset:24576
    ds_read_b64_tr_b16 v[48:49], v240 offset:25088
    ds_read_b64_tr_b16 v[50:51], v241 offset:24576
    ds_read_b64_tr_b16 v[52:53], v241 offset:25088
    s_waitcnt lgkmcnt(10)
    v_cndmask_b32 v58, v58, v92, s[52:53]
    v_cndmask_b32 v59, v59, v92, s[52:53]
    v_cndmask_b32 v60, v60, v92, s[52:53]
    v_cndmask_b32 v61, v61, v92, s[52:53]
    v_mfma_f32_32x32x16_bf16 v[100:115], v[54:57], v[38:41], v[100:115]
    v_lshlrev_b32 v10, 16, v40
    v_and_b32 v11, s41, v40
    v_fmac_f32 v72, v10, v10
    v_fmac_f32 v73, v11, v11
    v_mfma_f32_32x32x16_bf16 v[116:131], v[58:61], v[38:41], v[116:131]
    v_lshlrev_b32 v10, 16, v41
    v_and_b32 v11, s41, v41
    v_fmac_f32 v72, v10, v10
    v_fmac_f32 v73, v11, v11
    ds_read_b128 v[38:41], v229 offset:24576
    ds_read_b64_tr_b16 v[54:55], v240 offset:26624
    ds_read_b64_tr_b16 v[56:57], v240 offset:27136
    ds_read_b64_tr_b16 v[58:59], v241 offset:26624
    ds_read_b64_tr_b16 v[60:61], v241 offset:27136
    s_waitcnt lgkmcnt(10)
    v_cndmask_b32 v66, v66, v92, s[52:53]
    v_cndmask_b32 v67, v67, v92, s[52:53]
    v_cndmask_b32 v68, v68, v92, s[52:53]
    v_cndmask_b32 v69, v69, v92, s[52:53]
    v_mfma_f32_32x32x16_bf16 v[100:115], v[62:65], v[42:45], v[100:115]
    v_lshlrev_b32 v10, 16, v44
    v_and_b32 v11, s41, v44
    v_fmac_f32 v72, v10, v10
    v_fmac_f32 v73, v11, v11
    v_mfma_f32_32x32x16_bf16 v[116:131], v[66:69], v[42:45], v[116:131]
    v_lshlrev_b32 v10, 16, v45
    v_and_b32 v11, s41, v45
    v_fmac_f32 v72, v10, v10
    v_fmac_f32 v73, v11, v11
    ds_read_b128 v[42:45], v230 offset:24576
    ds_read_b64_tr_b16 v[62:63], v240 offset:28672
    ds_read_b64_tr_b16 v[64:65], v240 offset:29184
    ds_read_b64_tr_b16 v[66:67], v241 offset:28672
    ds_read_b64_tr_b16 v[68:69], v241 offset:29184
    s_waitcnt lgkmcnt(10)
    v_cndmask_b32 v50, v50, v92, s[52:53]
    v_cndmask_b32 v51, v51, v92, s[52:53]
    v_cndmask_b32 v52, v52, v92, s[52:53]
    v_cndmask_b32 v53, v53, v92, s[52:53]
    v_mfma_f32_32x32x16_bf16 v[100:115], v[46:49], v[34:37], v[100:115]
    v_lshlrev_b32 v10, 16, v36
    v_and_b32 v11, s41, v36
    v_fmac_f32 v72, v10, v10
    v_fmac_f32 v73, v11, v11
    v_mfma_f32_32x32x16_bf16 v[116:131], v[50:53], v[34:37], v[116:131]
    v_lshlrev_b32 v10, 16, v37
    v_and_b32 v11, s41, v37
    v_fmac_f32 v72, v10, v10
    v_fmac_f32 v73, v11, v11
    ds_read_b128 v[34:37], v231 offset:24576
    ds_read_b64_tr_b16 v[46:47], v240 offset:30720
    ds_read_b64_tr_b16 v[48:49], v240 offset:31232
    ds_read_b64_tr_b16 v[50:51], v241 offset:30720
    ds_read_b64_tr_b16 v[52:53], v241 offset:31232
    s_waitcnt lgkmcnt(10)
    v_cndmask_b32 v58, v58, v92, s[52:53]
    v_cndmask_b32 v59, v59, v92, s[52:53]
    v_cndmask_b32 v60, v60, v92, s[52:53]
    v_cndmask_b32 v61, v61, v92, s[52:53]
    v_mfma_f32_32x32x16_bf16 v[100:115], v[54:57], v[38:41], v[100:115]
    v_lshlrev_b32 v10, 16, v40
    v_and_b32 v11, s41, v40
    v_fmac_f32 v72, v10, v10
    v_fmac_f32 v73, v11, v11
    v_mfma_f32_32x32x16_bf16 v[116:131], v[58:61], v[38:41], v[116:131]
    v_lshlrev_b32 v10, 16, v41
    v_and_b32 v11, s41, v41
    v_fmac_f32 v72, v10, v10
    v_fmac_f32 v73, v11, v11
    s_waitcnt lgkmcnt(5)
    v_cndmask_b32 v66, v66, v92, s[52:53]
    v_cndmask_b32 v67, v67, v92, s[52:53]
    v_cndmask_b32 v68, v68, v92, s[52:53]
    v_cndmask_b32 v69, v69, v92, s[52:53]
    v_mfma_f32_32x32x16_bf16 v[100:115], v[62:65], v[42:45], v[100:115]
    v_lshlrev_b32 v10, 16, v44
    v_and_b32 v11, s41, v44
    v_fmac_f32 v72, v10, v10
    v_fmac_f32 v73, v11, v11
    v_mfma_f32_32x32x16_bf16 v[116:131], v[66:69], v[42:45], v[116:131]
    v_lshlrev_b32 v10, 16, v45
    v_and_b32 v11, s41, v45
    v_fmac_f32 v72, v10, v10
    v_fmac_f32 v73, v11, v11
    s_waitcnt lgkmcnt(0)
    v_cndmask_b32 v50, v50, v92, s[52:53]
    v_cndmask_b32 v51, v51, v92, s[52:53]
    v_cndmask_b32 v52, v52, v92, s[52:53]
    v_cndmask_b32 v53, v53, v92, s[52:53]
    v_mfma_f32_32x32x16_bf16 v[100:115], v[46:49], v[34:37], v[100:115]
    v_lshlrev_b32 v10, 16, v36
    v_and_b32 v11, s41, v36
    v_fmac_f32 v72, v10, v10
    v_fmac_f32 v73, v11, v11
    v_mfma_f32_32x32x16_bf16 v[116:131], v[50:53], v[34:37], v[116:131]
    v_lshlrev_b32 v10, 16, v37
    v_and_b32 v11, s41, v37
    v_fmac_f32 v72, v10, v10
    v_fmac_f32 v73, v11, v11
    v_add_f32 v72, v72, v73
    v_mov_b32 v10, v72
    v_mov_b32 v11, v72
    s_nop 1
    v_permlane32_swap_b32 v10, v11
    v_add_f32 v72, v10, v11
    ds_write_b32 v9, v72 offset:512
    s_mov_b64 exec, s[42:43]
    ds_write_b32 v9, v128 offset:1536
    s_mov_b64 exec, -1
    s_waitcnt lgkmcnt(0)
    s_barrier
    s_setprio 2
    v_lshlrev_b32 v8, 4, v3
    ds_read_b32 v66, v9 offset:1536
    ds_read_b32 v67, v9 offset:512
    ds_read_b32 v68, v9 offset:1024
    ds_read_b128 v[34:37], v8 offset:128
    ds_read_b128 v[38:41], v8 offset:160
    ds_read_b128 v[42:45], v8 offset:192
    ds_read_b128 v[46:49], v8 offset:224
    ds_read_b128 v[50:53], v8 offset:256
    ds_read_b128 v[54:57], v8 offset:288
    ds_read_b128 v[58:61], v8 offset:320
    ds_read_b128 v[62:65], v8 offset:352
    ds_read_b64_tr_b16 v[92:93], v12 offset:2048
    ds_read_b64_tr_b16 v[94:95], v12 offset:2496
    ds_read_b64_tr_b16 v[96:97], v12 offset:2944
    ds_read_b64_tr_b16 v[98:99], v12 offset:3392
    s_lshl_b32 s50, s2, 7
    s_add_u32 s50, s50, 786432
    v_mov_b32 v13, 0
    v_lshlrev_b32 v14, 2, v1
    s_mov_b64 exec, 0xfff
    buffer_store_dword v13, v14, s[32:35], s50 offen
    s_mov_b64 exec, -1
    s_lshl_b32 s50, s37, 2
    s_add_u32 s50, s50, 64
    v_mov_b32 v13, s50
    buffer_load_dword v14, v13, s[28:31], 0 offen sc1
    s_waitcnt lgkmcnt(12)
    v_add_f32 v67, v67, v68
    v_mul_f32 v66, 0x3b124925, v66
    v_mul_f32 v67, 0x3b124925, v67
    v_fma_f32 v67, -v66, v66, v67
    v_max_f32 v67, 0, v67
    v_cvt_pk_bf16_f32 v66, v67, v66
    v_lshlrev_b32 v67, 16, v66
    v_and_b32 v66, 0xffff0000, v66
    v_add_f32 v67, 0x3727c5ac, v67
    v_xor_b32 v68, 0x80000000, v66
    v_cvt_pk_bf16_f32 v67, v67, v67
    v_and_b32 v67, 0xffff0000, v67
    v_sqrt_f32 v67, v67
    s_nop 0
    v_cvt_pk_bf16_f32 v70, v67, v67
    v_and_b32 v70, 0xffff0000, v70
    v_rcp_f32 v69, v70
    s_waitcnt lgkmcnt(0)
    v_fmac_f32 v100, v34, v68
    v_fmac_f32 v101, v35, v68
    v_cvt_pk_bf16_f32 v132, v100, v101
    v_fmac_f32 v102, v36, v68
    v_fmac_f32 v103, v37, v68
    v_cvt_pk_bf16_f32 v133, v102, v103
    v_fmac_f32 v104, v38, v68
    v_fmac_f32 v105, v39, v68
    v_cvt_pk_bf16_f32 v134, v104, v105
    v_fmac_f32 v106, v40, v68
    v_fmac_f32 v107, v41, v68
    v_cvt_pk_bf16_f32 v135, v106, v107
    v_fmac_f32 v108, v42, v68
    v_fmac_f32 v109, v43, v68
    v_cvt_pk_bf16_f32 v136, v108, v109
    v_fmac_f32 v110, v44, v68
    v_fmac_f32 v111, v45, v68
    v_cvt_pk_bf16_f32 v137, v110, v111
    v_fmac_f32 v112, v46, v68
    v_fmac_f32 v113, v47, v68
    v_cvt_pk_bf16_f32 v138, v112, v113
    v_fmac_f32 v114, v48, v68
    v_fmac_f32 v115, v49, v68
    v_cvt_pk_bf16_f32 v139, v114, v115
    v_cndmask_b32 v138, v138, 0, s[42:43]
    v_cndmask_b32 v139, v139, 0, s[42:43]
    v_mfma_f32_32x32x16_bf16 v[148:163], v[92:95], v[132:135], 0
    s_nop 0
    v_mfma_f32_32x32x16_bf16 v[148:163], v[96:99], v[136:139], v[148:163]
    v_fmac_f32 v116, v50, v68
    v_fmac_f32 v117, v51, v68
    v_cvt_pk_bf16_f32 v140, v116, v117
    v_fmac_f32 v118, v52, v68
    v_fmac_f32 v119, v53, v68
    v_cvt_pk_bf16_f32 v141, v118, v119
    v_fmac_f32 v120, v54, v68
    v_fmac_f32 v121, v55, v68
    v_cvt_pk_bf16_f32 v142, v120, v121
    v_fmac_f32 v122, v56, v68
    v_fmac_f32 v123, v57, v68
    v_cvt_pk_bf16_f32 v143, v122, v123
    v_fmac_f32 v124, v58, v68
    v_fmac_f32 v125, v59, v68
    v_cvt_pk_bf16_f32 v144, v124, v125
    v_fmac_f32 v126, v60, v68
    v_fmac_f32 v127, v61, v68
    v_cvt_pk_bf16_f32 v145, v126, v127
    v_fmac_f32 v128, v62, v68
    v_fmac_f32 v129, v63, v68
    v_cvt_pk_bf16_f32 v146, v128, v129
    v_fmac_f32 v130, v64, v68
    v_fmac_f32 v131, v65, v68
    v_cvt_pk_bf16_f32 v147, v130, v131
    v_lshrrev_b32 v9, 16, v70
    v_mul_f32 v71, s44, v69
    v_cndmask_b32 v146, v146, v9, s[42:43]
    v_cndmask_b32 v147, v147, 0, s[42:43]
    v_xor_b32 v9, 0, v74
    ds_write_b64 v9, v[140:141] offset:49152
    v_xor_b32 v9, 16, v74
    ds_write_b64 v9, v[142:143] offset:49152
    v_xor_b32 v9, 32, v74
    ds_write_b64 v9, v[144:145] offset:49152
    v_xor_b32 v9, 48, v74
    ds_write_b64 v9, v[146:147] offset:49152
    v_cndmask_b32 v160, v160, v148, s[42:43]
    v_cndmask_b32 v161, v161, v148, s[42:43]
    v_cndmask_b32 v162, v162, v148, s[42:43]
    v_cndmask_b32 v163, v163, v148, s[42:43]
    v_max3_f32 v50, v148, v149, v150
    v_min3_f32 v51, v148, v149, v150
    v_max3_f32 v50, v50, v151, v152
    v_min3_f32 v51, v51, v151, v152
    v_max3_f32 v50, v50, v153, v154
    v_min3_f32 v51, v51, v153, v154
    v_max3_f32 v50, v50, v155, v156
    v_min3_f32 v51, v51, v155, v156
    v_max3_f32 v50, v50, v157, v158
    v_min3_f32 v51, v51, v157, v158
    v_max3_f32 v50, v50, v159, v160
    v_min3_f32 v51, v51, v159, v160
    v_max3_f32 v50, v50, v161, v162
    v_min3_f32 v51, v51, v161, v162
    v_max_f32 v50, v50, v163
    v_min_f32 v51, v51, v163
    v_mov_b32 v52, v50
    v_mov_b32 v54, v51
    s_nop 0
    v_permlane32_swap_b32 v52, v50
    v_permlane32_swap_b32 v54, v51
    v_max_f32 v50, v52, v50
    v_min_f32 v51, v54, v51
    v_mul_f32 v50, v71, v50
    v_mul_f32 v51, v71, v51
    v_fma_f32 v164, v148, v71, -v50
    v_fma_f32 v180, -v148, v71, v51
    v_fma_f32 v165, v149, v71, -v50
    v_fma_f32 v181, -v149, v71, v51
    v_exp_f32 v164, v164
    v_exp_f32 v180, v180
    v_fma_f32 v166, v150, v71, -v50
    v_fma_f32 v182, -v150, v71, v51
    v_exp_f32 v165, v165
    v_exp_f32 v181, v181
    v_fma_f32 v167, v151, v71, -v50
    v_fma_f32 v183, -v151, v71, v51
    v_exp_f32 v166, v166
    v_exp_f32 v182, v182
    v_fma_f32 v168, v152, v71, -v50
    v_fma_f32 v184, -v152, v71, v51
    v_exp_f32 v167, v167
    v_exp_f32 v183, v183
    v_fma_f32 v169, v153, v71, -v50
    v_fma_f32 v185, -v153, v71, v51
    v_exp_f32 v168, v168
    v_exp_f32 v184, v184
    v_fma_f32 v170, v154, v71, -v50
    v_fma_f32 v186, -v154, v71, v51
    v_exp_f32 v169, v169
    v_exp_f32 v185, v185
    v_fma_f32 v171, v155, v71, -v50
    v_fma_f32 v187, -v155, v71, v51
    v_exp_f32 v170, v170
    v_exp_f32 v186, v186
    v_fma_f32 v172, v156, v71, -v50
    v_fma_f32 v188, -v156, v71, v51
    v_exp_f32 v171, v171
    v_exp_f32 v187, v187
    v_fma_f32 v173, v157, v71, -v50
    v_fma_f32 v189, -v157, v71, v51
    v_exp_f32 v172, v172
    v_exp_f32 v188, v188
    v_fma_f32 v174, v158, v71, -v50
    v_fma_f32 v190, -v158, v71, v51
    v_exp_f32 v173, v173
    v_exp_f32 v189, v189
    v_fma_f32 v175, v159, v71, -v50
    v_fma_f32 v191, -v159, v71, v51
    v_exp_f32 v174, v174
    v_exp_f32 v190, v190
    v_fma_f32 v176, v160, v71, -v50
    v_fma_f32 v192, -v160, v71, v51
    v_exp_f32 v175, v175
    v_exp_f32 v191, v191
    v_fma_f32 v177, v161, v71, -v50
    v_fma_f32 v193, -v161, v71, v51
    v_exp_f32 v176, v176
    v_exp_f32 v192, v192
    v_fma_f32 v178, v162, v71, -v50
    v_fma_f32 v194, -v162, v71, v51
    v_exp_f32 v177, v177
    v_exp_f32 v193, v193
    v_fma_f32 v179, v163, v71, -v50
    v_fma_f32 v195, -v163, v71, v51
    v_exp_f32 v178, v178
    v_exp_f32 v194, v194
    v_exp_f32 v179, v179
    v_exp_f32 v195, v195
    v_add_f32 v54, v164, v165
    v_add_f32 v55, v180, v181
    v_add_f32 v52, v166, v167
    v_add_f32 v53, v182, v183
    v_add_f32 v54, v54, v168
    v_add_f32 v55, v55, v184
    v_add_f32 v52, v52, v169
    v_add_f32 v53, v53, v185
    v_add_f32 v54, v54, v170
    v_add_f32 v55, v55, v186
    v_add_f32 v52, v52, v171
    v_add_f32 v53, v53, v187
    v_add_f32 v54, v54, v172
    v_add_f32 v55, v55, v188
    v_add_f32 v52, v52, v173
    v_add_f32 v53, v53, v189
    v_add_f32 v54, v54, v174
    v_add_f32 v55, v55, v190
    v_add_f32 v52, v52, v175
    v_add_f32 v53, v53, v191
    v_cndmask_b32 v176, v176, 0, s[42:43]
    v_cndmask_b32 v192, v192, 0, s[42:43]
    v_cndmask_b32 v177, v177, 0, s[42:43]
    v_cndmask_b32 v193, v193, 0, s[42:43]
    v_cndmask_b32 v178, v178, 0, s[42:43]
    v_cndmask_b32 v194, v194, 0, s[42:43]
    v_cndmask_b32 v179, v179, 0, s[42:43]
    v_cndmask_b32 v195, v195, 0, s[42:43]
    v_add_f32 v54, v54, v176
    v_add_f32 v55, v55, v192
    v_add_f32 v52, v52, v177
    v_add_f32 v53, v53, v193
    v_add_f32 v54, v54, v178
    v_add_f32 v55, v55, v194
    v_add_f32 v52, v52, v179
    v_add_f32 v53, v53, v195
    v_add_f32 v54, v54, v52
    v_add_f32 v55, v55, v53
    v_mov_b32 v52, v54
    v_mov_b32 v53, v55
    s_nop 0
    v_permlane32_swap_b32 v52, v54
    v_permlane32_swap_b32 v53, v55
    v_add_f32 v54, v52, v54
    v_add_f32 v55, v53, v55
    v_rcp_f32 v54, v54
    v_rcp_f32 v55, v55
    v_mul_f32 v54, v54, v69
    v_mul_f32 v55, v55, v69
    v_mul_f32 v164, v164, v54
    v_mul_f32 v165, v165, v54
    v_cvt_pk_bf16_f32 v34, v164, v165
    v_mul_f32 v166, v166, v54
    v_mul_f32 v167, v167, v54
    v_cvt_pk_bf16_f32 v35, v166, v167
    v_mul_f32 v168, v168, v54
    v_mul_f32 v169, v169, v54
    v_cvt_pk_bf16_f32 v36, v168, v169
    v_mul_f32 v170, v170, v54
    v_mul_f32 v171, v171, v54
    v_cvt_pk_bf16_f32 v37, v170, v171
    v_mul_f32 v172, v172, v54
    v_mul_f32 v173, v173, v54
    v_cvt_pk_bf16_f32 v38, v172, v173
    v_mul_f32 v174, v174, v54
    v_mul_f32 v175, v175, v54
    v_cvt_pk_bf16_f32 v39, v174, v175
    v_mul_f32 v176, v176, v54
    v_mul_f32 v177, v177, v54
    v_cvt_pk_bf16_f32 v40, v176, v177
    v_mul_f32 v178, v178, v54
    v_mul_f32 v179, v179, v54
    v_cvt_pk_bf16_f32 v41, v178, v179
    v_mul_f32 v180, v180, v55
    v_mul_f32 v181, v181, v55
    v_cvt_pk_bf16_f32 v42, v180, v181
    v_mul_f32 v182, v182, v55
    v_mul_f32 v183, v183, v55
    v_cvt_pk_bf16_f32 v43, v182, v183
    v_mul_f32 v184, v184, v55
    v_mul_f32 v185, v185, v55
    v_cvt_pk_bf16_f32 v44, v184, v185
    v_mul_f32 v186, v186, v55
    v_mul_f32 v187, v187, v55
    v_cvt_pk_bf16_f32 v45, v186, v187
    v_mul_f32 v188, v188, v55
    v_mul_f32 v189, v189, v55
    v_cvt_pk_bf16_f32 v46, v188, v189
    v_mul_f32 v190, v190, v55
    v_mul_f32 v191, v191, v55
    v_cvt_pk_bf16_f32 v47, v190, v191
    v_mul_f32 v192, v192, v55
    v_mul_f32 v193, v193, v55
    v_cvt_pk_bf16_f32 v48, v192, v193
    v_mul_f32 v194, v194, v55
    v_mul_f32 v195, v195, v55
    v_cvt_pk_bf16_f32 v49, v194, v195
    v_xor_b32 v9, 0, v75
    ds_write_b64 v9, v[34:35] offset:32768
    v_xor_b32 v9, 16, v75
    ds_write_b64 v9, v[36:37] offset:32768
    v_xor_b32 v9, 32, v75
    ds_write_b64 v9, v[38:39] offset:32768
    v_xor_b32 v9, 48, v75
    ds_write_b64 v9, v[40:41] offset:32768
    v_xor_b32 v9, 64, v75
    ds_write_b64 v9, v[42:43] offset:32768
    v_xor_b32 v9, 80, v75
    ds_write_b64 v9, v[44:45] offset:32768
    v_xor_b32 v9, 96, v75
    ds_write_b64 v9, v[46:47] offset:32768
    v_xor_b32 v9, 112, v75
    ds_write_b64 v9, v[48:49] offset:32768
    s_waitcnt lgkmcnt(0)
    ds_write_b32 v86, v87 offset:448
    s_cmp_ge_u32 s39, 2
    s_cbranch_scc1 K1_PF2
K1_LPOLL:
    ds_read_b128 v[88:91], v82 offset:448
    s_waitcnt lgkmcnt(0)
    v_and_b32 v88, v88, v89
    v_and_b32 v90, v90, v91
    v_and_b32 v88, v88, v90
    s_nop 0
    v_readfirstlane_b32 s51, v88
    s_cmp_eq_u32 s51, 0
    s_cbranch_scc1 K1_LPOLL
    ds_read_b64_tr_b16 v[100:101], v76 offset:49152
    ds_read_b64_tr_b16 v[102:103], v77 offset:49152
    ds_read_b64_tr_b16 v[104:105], v78 offset:32768
    ds_read_b64_tr_b16 v[106:107], v79 offset:32768
    ds_read_b64_tr_b16 v[108:109], v76 offset:50176
    ds_read_b64_tr_b16 v[110:111], v77 offset:50176
    ds_read_b64_tr_b16 v[112:113], v78 offset:34816
    ds_read_b64_tr_b16 v[114:115], v79 offset:34816
    ds_read_b64_tr_b16 v[116:117], v76 offset:51200
    ds_read_b64_tr_b16 v[118:119], v77 offset:51200
    ds_read_b64_tr_b16 v[120:121], v78 offset:36864
    ds_read_b64_tr_b16 v[122:123], v79 offset:36864
    ds_read_b64_tr_b16 v[124:125], v76 offset:52224
    ds_read_b64_tr_b16 v[126:127], v77 offset:52224
    ds_read_b64_tr_b16 v[128:129], v78 offset:38912
    ds_read_b64_tr_b16 v[130:131], v79 offset:38912
    ds_read_b64_tr_b16 v[132:133], v76 offset:53248
    ds_read_b64_tr_b16 v[134:135], v77 offset:53248
    ds_read_b64_tr_b16 v[136:137], v78 offset:40960
    ds_read_b64_tr_b16 v[138:139], v79 offset:40960
    ds_read_b64_tr_b16 v[140:141], v76 offset:54272
    ds_read_b64_tr_b16 v[142:143], v77 offset:54272
    ds_read_b64_tr_b16 v[144:145], v78 offset:43008
    ds_read_b64_tr_b16 v[146:147], v79 offset:43008
    ds_read_b64_tr_b16 v[148:149], v76 offset:55296
    ds_read_b64_tr_b16 v[150:151], v77 offset:55296
    ds_read_b64_tr_b16 v[152:153], v78 offset:45056
    ds_read_b64_tr_b16 v[154:155], v79 offset:45056
    ds_read_b64_tr_b16 v[156:157], v76 offset:56320
    ds_read_b64_tr_b16 v[158:159], v77 offset:56320
    ds_read_b64_tr_b16 v[160:161], v78 offset:47104
    ds_read_b64_tr_b16 v[162:163], v79 offset:47104
    s_waitcnt lgkmcnt(15)
    v_mfma_f32_32x32x16_bf16 v[16:31], v[100:103], v[104:107], 0
    s_waitcnt lgkmcnt(15)
    v_mfma_f32_32x32x16_bf16 v[16:31], v[108:111], v[112:115], v[16:31]
    s_waitcnt lgkmcnt(15)
    v_mfma_f32_32x32x16_bf16 v[16:31], v[116:119], v[120:123], v[16:31]
    s_waitcnt lgkmcnt(15)
    v_mfma_f32_32x32x16_bf16 v[16:31], v[124:127], v[128:131], v[16:31]
    s_waitcnt lgkmcnt(12)
    v_mfma_f32_32x32x16_bf16 v[16:31], v[132:135], v[136:139], v[16:31]
    s_waitcnt lgkmcnt(8)
    v_mfma_f32_32x32x16_bf16 v[16:31], v[140:143], v[144:147], v[16:31]
    s_waitcnt lgkmcnt(4)
    v_mfma_f32_32x32x16_bf16 v[16:31], v[148:151], v[152:155], v[16:31]
    s_waitcnt lgkmcnt(0)
    v_mfma_f32_32x32x16_bf16 v[16:31], v[156:159], v[160:163], v[16:31]
    s_waitcnt vmcnt(0)
    v_readfirstlane_b32 s51, v14
    s_cmp_lg_u32 s51, 0
    s_cbranch_scc1 K1_GO
    s_mov_b32 s50, 0
K1_POLL:
    buffer_load_dword v14, v13, s[28:31], 0 offen sc1
    s_add_u32 s50, s50, 1
    s_waitcnt vmcnt(0)
    v_readfirstlane_b32 s51, v14
    s_cmp_gt_u32 s50, 0x400000
    s_cbranch_scc1 K1_GO
    s_cmp_eq_u32 s51, 0
    s_cbranch_scc1 K1_POLL
K1_GO:
    s_nop 7
    buffer_atomic_add_f32 v16, v80, s[32:35], 0 offen offset:0
    buffer_atomic_add_f32 v17, v80, s[32:35], 0 offen offset:256
    buffer_atomic_add_f32 v18, v80, s[32:35], 0 offen offset:512
    buffer_atomic_add_f32 v19, v80, s[32:35], 0 offen offset:768
    buffer_atomic_add_f32 v20, v80, s[32:35], 0 offen offset:2048
    buffer_atomic_add_f32 v21, v80, s[32:35], 0 offen offset:2304
    buffer_atomic_add_f32 v22, v80, s[32:35], 0 offen offset:2560
    buffer_atomic_add_f32 v23, v80, s[32:35], 0 offen offset:2816
    buffer_atomic_add_f32 v24, v81, s[32:35], 0 offen offset:0
    buffer_atomic_add_f32 v25, v81, s[32:35], 0 offen offset:256
    buffer_atomic_add_f32 v26, v81, s[32:35], 0 offen offset:512
    buffer_atomic_add_f32 v27, v81, s[32:35], 0 offen offset:768
    buffer_atomic_add_f32 v28, v81, s[32:35], 0 offen offset:2048
    buffer_atomic_add_f32 v29, v81, s[32:35], 0 offen offset:2304
    buffer_atomic_add_f32 v30, v81, s[32:35], 0 offen offset:2560
    buffer_atomic_add_f32 v31, v81, s[32:35], 0 offen offset:2816
    s_branch K1_FIN
K1_PF2:
    s_branch K1_FIN
K1_Q:
    v_lshrrev_b32 v7, 3, v1
    v_and_b32 v8, 7, v1
    v_lshrrev_b32 v9, 1, v7
    v_xor_b32 v8, v8, v9
    v_mul_u32_u24 v7, 896, v7
    v_lshl_add_u32 v30, v8, 4, v7
    v_xor_b32 v31, 64, v30
    v_lshrrev_b32 v7, 2, v1
    v_mul_u32_u24 v7, 2688, v7
    v_and_b32 v8, 3, v1
    v_lshl_add_u32 v32, v8, 4, v7
    s_lshl_b32 s49, s39, 12
    s_lshl_b32 s54, s39, 10
    s_waitcnt lgkmcnt(0)
    s_mov_b32 s16, s4
    s_mov_b32 s17, s5
    s_mov_b32 s18, 1835008
    s_mov_b32 s19, 0x00020000
    s_mov_b32 s20, s6
    s_mov_b32 s21, s7
    s_mov_b32 s22, 1204224
    s_mov_b32 s23, 0x00020000
    s_mov_b32 s24, s8
    s_mov_b32 s25, s9
    s_mov_b32 s26, 25088
    s_mov_b32 s27, 0x00020000
    s_mov_b32 s28, s12
    s_mov_b32 s29, s13
    s_mov_b32 s30, 256
    s_mov_b32 s31, 0x00020000
    s_mov_b32 s32, s14
    s_mov_b32 s33, s15
    s_mov_b32 s34, 268435456
    s_mov_b32 s35, 0x00020000
    s_or_b32 s55, s36, s39
    s_cmp_lg_u32 s55, 0
    s_cbranch_scc1 K1_Q2
    s_lshl_b32 s50, s37, 13
    v_lshl_add_u32 v7, v1, 4, s50
    v_mov_b32 v34, 0
    v_mov_b32 v35, 0
    v_mov_b32 v36, 0
    v_mov_b32 v37, 0
    v_add_u32 v8, 4096, v7
    buffer_store_dwordx4 v[34:37], v7, s[32:35], 0 offen offset:0 sc1
    buffer_store_dwordx4 v[34:37], v8, s[32:35], 0 offen offset:0 sc1
    buffer_store_dwordx4 v[34:37], v7, s[32:35], 0 offen offset:1024 sc1
    buffer_store_dwordx4 v[34:37], v8, s[32:35], 0 offen offset:1024 sc1
    buffer_store_dwordx4 v[34:37], v7, s[32:35], 0 offen offset:2048 sc1
    buffer_store_dwordx4 v[34:37], v8, s[32:35], 0 offen offset:2048 sc1
    buffer_store_dwordx4 v[34:37], v7, s[32:35], 0 offen offset:3072 sc1
    buffer_store_dwordx4 v[34:37], v8, s[32:35], 0 offen offset:3072 sc1
K1_Q2:
    s_add_u32 m0, s49, 32768
    s_add_u32 s50, s60, 0
    buffer_load_dwordx4 v30, s[16:19], s50 offen lds
    s_add_u32 m0, s49, 33792
    s_add_u32 s50, s60, 7168
    buffer_load_dwordx4 v31, s[16:19], s50 offen lds
    s_add_u32 m0, s49, 34816
    s_add_u32 s50, s60, 14336
    buffer_load_dwordx4 v30, s[16:19], s50 offen lds
    s_add_u32 m0, s49, 35840
    s_add_u32 s50, s60, 21504
    buffer_load_dwordx4 v31, s[16:19], s50 offen lds
    s_add_u32 m0, s49, 57344
    s_add_u32 s50, s61, 0
    buffer_load_dwordx4 v30, s[16:19], s50 offen lds
    s_add_u32 m0, s49, 58368
    s_add_u32 s50, s61, 7168
    buffer_load_dwordx4 v31, s[16:19], s50 offen lds
    s_add_u32 m0, s49, 59392
    s_add_u32 s50, s61, 14336
    buffer_load_dwordx4 v30, s[16:19], s50 offen lds
    s_add_u32 m0, s49, 60416
    s_add_u32 s50, s61, 21504
    buffer_load_dwordx4 v31, s[16:19], s50 offen lds
    v_lshrrev_b32 v7, 2, v4
    v_lshl_add_u32 v8, v3, 3, v7
    v_lshlrev_b32 v8, 7, v8
    v_and_b32 v9, 1, v5
    v_lshlrev_b32 v9, 2, v9
    v_and_b32 v10, 3, v4
    v_add_u32 v9, v9, v10
    v_lshl_add_u32 v8, v9, 3, v8
    s_and_b32 s50, s37, 1
    s_lshl_b32 s50, s50, 3
    s_add_u32 s51, s50, 49152
    v_add_u32 v8, s51, v8
    v_lshrrev_b32 v7, 1, v7
    s_and_b32 s51, s39, 1
    v_xor_b32 v7, s51, v7
    v_lshl_add_u32 v240, v7, 6, v8
    v_add_u32 v242, 49152, v240
    v_add_u32 v244, 98304, v240
    v_lshrrev_b32 v7, 2, v4
    v_lshl_add_u32 v7, v3, 3, v7
    v_lshlrev_b32 v7, 6, v7
    v_lshl_add_u32 v7, v9, 3, v7
    s_add_u32 s51, s50, 4096
    v_add_u32 v246, s51, v7
    s_lshl_b32 s50, s39, 5
    v_add_u32 v7, s50, v2
    v_lshrrev_b32 v8, 1, v7
    v_and_b32 v8, 7, v8
    v_xor_b32 v8, v8, v3
    v_lshlrev_b32 v8, 4, v8
    v_lshl_add_u32 v11, v7, 7, v8
    v_xor_b32 v7, 0, v11
    v_add_u32 v228, 32768, v7
    v_add_u32 v232, 81920, v7
    v_add_u32 v236, 131072, v7
    v_xor_b32 v7, 32, v11
    v_add_u32 v229, 32768, v7
    v_add_u32 v233, 81920, v7
    v_add_u32 v237, 131072, v7
    v_xor_b32 v7, 64, v11
    v_add_u32 v230, 32768, v7
    v_add_u32 v234, 81920, v7
    v_add_u32 v238, 131072, v7
    v_xor_b32 v7, 96, v11
    v_add_u32 v231, 32768, v7
    v_add_u32 v235, 81920, v7
    v_add_u32 v239, 131072, v7
    v_lshrrev_b32 v7, 2, v4
    v_lshl_add_u32 v7, v3, 2, v7
    v_mul_u32_u24 v7, 56, v7
    v_lshl_add_u32 v12, v9, 3, v7
    s_lshl_b32 s50, s39, 7
    v_lshl_add_u32 v9, v2, 2, s50
    v_mov_b32 v80, s45
    v_mov_b32 v81, s45
    v_mov_b32 v82, s45
    v_mov_b32 v83, s45
    s_lshl_b32 s50, s39, 2
    v_mov_b32 v86, s50
    v_mov_b32 v87, 1
    v_mov_b32 v85, 0
    v_mov_b32 v72, 0
    v_mov_b32 v73, 0
    s_waitcnt vmcnt(4)
    s_barrier
    s_cmp_lg_u32 s55, 0
    s_cbranch_scc1 K1_Q3
    s_lshl_b32 s50, s37, 2
    s_add_u32 s50, s50, 64
    v_mov_b32 v7, s50
    s_mov_b64 exec, 1
    buffer_store_dword v87, v7, s[28:31], 0 offen sc1
    s_mov_b64 exec, -1
K1_Q3:
    s_add_u32 m0, s49, 81920
    s_add_u32 s50, s62, 0
    buffer_load_dwordx4 v30, s[16:19], s50 offen lds
    s_add_u32 m0, s49, 82944
    s_add_u32 s50, s62, 7168
    buffer_load_dwordx4 v31, s[16:19], s50 offen lds
    s_add_u32 m0, s49, 83968
    s_add_u32 s50, s62, 14336
    buffer_load_dwordx4 v30, s[16:19], s50 offen lds
    s_add_u32 m0, s49, 84992
    s_add_u32 s50, s62, 21504
    buffer_load_dwordx4 v31, s[16:19], s50 offen lds
    s_add_u32 m0, s49, 106496
    s_add_u32 s50, s63, 0
    buffer_load_dwordx4 v30, s[16:19], s50 offen lds
    s_add_u32 m0, s49, 107520
    s_add_u32 s50, s63, 7168
    buffer_load_dwordx4 v31, s[16:19], s50 offen lds
    s_add_u32 m0, s49, 108544
    s_add_u32 s50, s63, 14336
    buffer_load_dwordx4 v30, s[16:19], s50 offen lds
    s_add_u32 m0, s49, 109568
    s_add_u32 s50, s63, 21504
    buffer_load_dwordx4 v31, s[16:19], s50 offen lds
    s_add_u32 m0, s49, 131072
    s_add_u32 s50, s64, 0
    buffer_load_dwordx4 v30, s[16:19], s50 offen lds
    s_add_u32 m0, s49, 132096
    s_add_u32 s50, s64, 7168
    buffer_load_dwordx4 v31, s[16:19], s50 offen lds
    s_add_u32 m0, s49, 133120
    s_add_u32 s50, s64, 14336
    buffer_load_dwordx4 v30, s[16:19], s50 offen lds
    s_add_u32 m0, s49, 134144
    s_add_u32 s50, s64, 21504
    buffer_load_dwordx4 v31, s[16:19], s50 offen lds
    ds_read_b128 v[100:103], v228 offset:0
    ds_read_b64_tr_b16 v[46:47], v240 offset:0
    ds_read_b64_tr_b16 v[48:49], v240 offset:512
    ds_read_b128 v[104:107], v229 offset:0
    ds_read_b64_tr_b16 v[50:51], v240 offset:2048
    ds_read_b64_tr_b16 v[52:53], v240 offset:2560
    ds_read_b128 v[108:111], v230 offset:0
    ds_read_b64_tr_b16 v[54:55], v240 offset:4096
    ds_read_b64_tr_b16 v[56:57], v240 offset:4608
    s_waitcnt lgkmcnt(6)
    v_mfma_f32_32x32x16_bf16 v[212:227], v[46:49], v[80:83], 0
    v_lshlrev_b32 v10, 16, v100
    v_and_b32 v11, s41, v100
    v_fmac_f32 v72, v10, v10
    v_fmac_f32 v73, v11, v11
    v_lshlrev_b32 v10, 16, v101
    v_and_b32 v11, s41, v101
    v_fmac_f32 v72, v10, v10
    v_fmac_f32 v73, v11, v11
    ds_read_b128 v[112:115], v231 offset:0
    ds_read_b64_tr_b16 v[46:47], v240 offset:6144
    ds_read_b64_tr_b16 v[48:49], v240 offset:6656
    s_waitcnt lgkmcnt(6)
    v_mfma_f32_32x32x16_bf16 v[212:227], v[50:53], v[80:83], v[212:227]
    v_lshlrev_b32 v10, 16, v104
    v_and_b32 v11, s41, v104
    v_fmac_f32 v72, v10, v10
    v_fmac_f32 v73, v11, v11
    v_lshlrev_b32 v10, 16, v105
    v_and_b32 v11, s41, v105
    v_fmac_f32 v72, v10, v10
    v_fmac_f32 v73, v11, v11
    s_waitcnt vmcnt(12)
    s_barrier
    ds_read_b128 v[116:119], v228 offset:24576
    ds_read_b64_tr_b16 v[50:51], v240 offset:24576
    ds_read_b64_tr_b16 v[52:53], v240 offset:25088
    s_waitcnt lgkmcnt(6)
    v_mfma_f32_32x32x16_bf16 v[212:227], v[54:57], v[80:83], v[212:227]
    v_lshlrev_b32 v10, 16, v108
    v_and_b32 v11, s41, v108
    v_fmac_f32 v72, v10, v10
    v_fmac_f32 v73, v11, v11
    v_lshlrev_b32 v10, 16, v109
    v_and_b32 v11, s41, v109
    v_fmac_f32 v72, v10, v10
    v_fmac_f32 v73, v11, v11
    ds_read_b128 v[120:123], v229 offset:24576
    ds_read_b64_tr_b16 v[54:55], v240 offset:26624
    ds_read_b64_tr_b16 v[56:57], v240 offset:27136
    s_waitcnt lgkmcnt(6)
    v_mfma_f32_32x32x16_bf16 v[212:227], v[46:49], v[80:83], v[212:227]
    v_lshlrev_b32 v10, 16, v112
    v_and_b32 v11, s41, v112
    v_fmac_f32 v72, v10, v10
    v_fmac_f32 v73, v11, v11
    v_lshlrev_b32 v10, 16, v113
    v_and_b32 v11, s41, v113
    v_fmac_f32 v72, v10, v10
    v_fmac_f32 v73, v11, v11
    ds_read_b128 v[124:127], v230 offset:24576
    ds_read_b64_tr_b16 v[46:47], v240 offset:28672
    ds_read_b64_tr_b16 v[48:49], v240 offset:29184
    s_waitcnt lgkmcnt(6)
    v_mfma_f32_32x32x16_bf16 v[212:227], v[50:53], v[80:83], v[212:227]
    v_lshlrev_b32 v10, 16, v116
    v_and_b32 v11, s41, v116
    v_fmac_f32 v72, v10, v10
    v_fmac_f32 v73, v11, v11
    v_lshlrev_b32 v10, 16, v117
    v_and_b32 v11, s41, v117
    v_fmac_f32 v72, v10, v10
    v_fmac_f32 v73, v11, v11
    ds_read_b128 v[128:131], v231 offset:24576
    ds_read_b64_tr_b16 v[50:51], v240 offset:30720
    ds_read_b64_tr_b16 v[52:53], v240 offset:31232
    s_waitcnt lgkmcnt(6)
    v_mfma_f32_32x32x16_bf16 v[212:227], v[54:57], v[80:83], v[212:227]
    v_lshlrev_b32 v10, 16, v120
    v_and_b32 v11, s41, v120
    v_fmac_f32 v72, v10, v10
    v_fmac_f32 v73, v11, v11
    v_lshlrev_b32 v10, 16, v121
    v_and_b32 v11, s41, v121
    v_fmac_f32 v72, v10, v10
    v_fmac_f32 v73, v11, v11
    s_waitcnt vmcnt(8)
    s_barrier
    ds_read_b128 v[132:135], v232 offset:0
    ds_read_b64_tr_b16 v[54:55], v242 offset:0
    ds_read_b64_tr_b16 v[56:57], v242 offset:512
    s_waitcnt lgkmcnt(6)
    v_mfma_f32_32x32x16_bf16 v[212:227], v[46:49], v[80:83], v[212:227]
    v_lshlrev_b32 v10, 16, v124
    v_and_b32 v11, s41, v124
    v_fmac_f32 v72, v10, v10
    v_fmac_f32 v73, v11, v11
    v_lshlrev_b32 v10, 16, v125
    v_and_b32 v11, s41, v125
    v_fmac_f32 v72, v10, v10
    v_fmac_f32 v73, v11, v11
    s_add_u32 m0, s49, 32768
    s_add_u32 s50, s65, 0
    buffer_load_dwordx4 v30, s[16:19], s50 offen lds
    s_add_u32 m0, s49, 33792
    s_add_u32 s50, s65, 7168
    buffer_load_dwordx4 v31, s[16:19], s50 offen lds
    ds_read_b128 v[136:139], v233 offset:0
    ds_read_b64_tr_b16 v[46:47], v242 offset:2048
    ds_read_b64_tr_b16 v[48:49], v242 offset:2560
    s_waitcnt lgkmcnt(6)
    v_mfma_f32_32x32x16_bf16 v[212:227], v[50:53], v[80:83], v[212:227]
    v_lshlrev_b32 v10, 16, v128
    v_and_b32 v11, s41, v128
    v_fmac_f32 v72, v10, v10
    v_fmac_f32 v73, v11, v11
    v_lshlrev_b32 v10, 16, v129
    v_and_b32 v11, s41, v129
    v_fmac_f32 v72, v10, v10
    v_fmac_f32 v73, v11, v11
    s_add_u32 m0, s49, 34816
    s_add_u32 s50, s65, 14336
    buffer_load_dwordx4 v30, s[16:19], s50 offen lds
    s_add_u32 m0, s49, 35840
    s_add_u32 s50, s65, 21504
    buffer_load_dwordx4 v31, s[16:19], s50 offen lds
    ds_read_b128 v[140:143], v234 offset:0
    ds_read_b64_tr_b16 v[50:51], v242 offset:4096
    ds_read_b64_tr_b16 v[52:53], v242 offset:4608
    s_waitcnt lgkmcnt(6)
    v_mfma_f32_32x32x16_bf16 v[212:227], v[54:57], v[80:83], v[212:227]
    v_lshlrev_b32 v10, 16, v132
    v_and_b32 v11, s41, v132
    v_fmac_f32 v72, v10, v10
    v_fmac_f32 v73, v11, v11
    v_lshlrev_b32 v10, 16, v133
    v_and_b32 v11, s41, v133
    v_fmac_f32 v72, v10, v10
    v_fmac_f32 v73, v11, v11
    ds_read_b128 v[144:147], v235 offset:0
    ds_read_b64_tr_b16 v[54:55], v242 offset:6144
    ds_read_b64_tr_b16 v[56:57], v242 offset:6656
    s_waitcnt lgkmcnt(6)
    v_mfma_f32_32x32x16_bf16 v[212:227], v[46:49], v[80:83], v[212:227]
    v_lshlrev_b32 v10, 16, v136
    v_and_b32 v11, s41, v136
    v_fmac_f32 v72, v10, v10
    v_fmac_f32 v73, v11, v11
    v_lshlrev_b32 v10, 16, v137
    v_and_b32 v11, s41, v137
    v_fmac_f32 v72, v10, v10
    v_fmac_f32 v73, v11, v11
    s_waitcnt vmcnt(8)
    s_barrier
    ds_read_b128 v[148:151], v232 offset:24576
    ds_read_b64_tr_b16 v[46:47], v242 offset:24576
    ds_read_b64_tr_b16 v[48:49], v242 offset:25088
    s_waitcnt lgkmcnt(6)
    v_mfma_f32_32x32x16_bf16 v[212:227], v[50:53], v[80:83], v[212:227]
    v_lshlrev_b32 v10, 16, v140
    v_and_b32 v11, s41, v140
    v_fmac_f32 v72, v10, v10
    v_fmac_f32 v73, v11, v11
    v_lshlrev_b32 v10, 16, v141
    v_and_b32 v11, s41, v141
    v_fmac_f32 v72, v10, v10
    v_fmac_f32 v73, v11, v11
    s_add_u32 m0, s49, 57344
    s_add_u32 s50, s66, 0
    buffer_load_dwordx4 v30, s[16:19], s50 offen lds
    s_add_u32 m0, s49, 58368
    s_add_u32 s50, s66, 7168
    buffer_load_dwordx4 v31, s[16:19], s50 offen lds
    ds_read_b128 v[152:155], v233 offset:24576
    ds_read_b64_tr_b16 v[50:51], v242 offset:26624
    ds_read_b64_tr_b16 v[52:53], v242 offset:27136
    s_waitcnt lgkmcnt(6)
    v_mfma_f32_32x32x16_bf16 v[212:227], v[54:57], v[80:83], v[212:227]
    v_lshlrev_b32 v10, 16, v144
    v_and_b32 v11, s41, v144
    v_fmac_f32 v72, v10, v10
    v_fmac_f32 v73, v11, v11
    v_lshlrev_b32 v10, 16, v145
    v_and_b32 v11, s41, v145
    v_fmac_f32 v72, v10, v10
    v_fmac_f32 v73, v11, v11
    s_add_u32 m0, s49, 59392
    s_add_u32 s50, s66, 14336
    buffer_load_dwordx4 v30, s[16:19], s50 offen lds
    s_add_u32 m0, s49, 60416
    s_add_u32 s50, s66, 21504
    buffer_load_dwordx4 v31, s[16:19], s50 offen lds
    ds_read_b128 v[156:159], v234 offset:24576
    ds_read_b64_tr_b16 v[54:55], v242 offset:28672
    ds_read_b64_tr_b16 v[56:57], v242 offset:29184
    s_waitcnt lgkmcnt(6)
    v_mfma_f32_32x32x16_bf16 v[212:227], v[46:49], v[80:83], v[212:227]
    v_lshlrev_b32 v10, 16, v148
    v_and_b32 v11, s41, v148
    v_fmac_f32 v72, v10, v10
    v_fmac_f32 v73, v11, v11
    v_lshlrev_b32 v10, 16, v149
    v_and_b32 v11, s41, v149
    v_fmac_f32 v72, v10, v10
    v_fmac_f32 v73, v11, v11
    s_add_u32 m0, s54, 4096
    s_nop 0
    buffer_load_dwordx4 v32, s[20:23], s72 offen lds
    s_add_u32 m0, s54, 8192
    s_nop 0
    buffer_load_dwordx4 v32, s[20:23], s73 offen lds
    ds_read_b128 v[160:163], v235 offset:24576
    ds_read_b64_tr_b16 v[46:47], v242 offset:30720
    ds_read_b64_tr_b16 v[48:49], v242 offset:31232
    s_waitcnt lgkmcnt(6)
    v_mfma_f32_32x32x16_bf16 v[212:227], v[50:53], v[80:83], v[212:227]
    v_lshlrev_b32 v10, 16, v152
    v_and_b32 v11, s41, v152
    v_fmac_f32 v72, v10, v10
    v_fmac_f32 v73, v11, v11
    v_lshlrev_b32 v10, 16, v153
    v_and_b32 v11, s41, v153
    v_fmac_f32 v72, v10, v10
    v_fmac_f32 v73, v11, v11
    s_add_u32 m0, s54, 12288
    s_nop 0
    buffer_load_dwordx4 v32, s[20:23], s74 offen lds
    s_add_u32 m0, s54, 16384
    s_nop 0
    buffer_load_dwordx4 v32, s[20:23], s75 offen lds
    s_waitcnt vmcnt(12)
    s_barrier
    ds_read_b128 v[164:167], v236 offset:0
    ds_read_b64_tr_b16 v[50:51], v244 offset:0
    ds_read_b64_tr_b16 v[52:53], v244 offset:512
    s_waitcnt lgkmcnt(6)
    v_mfma_f32_32x32x16_bf16 v[212:227], v[54:57], v[80:83], v[212:227]
    v_lshlrev_b32 v10, 16, v156
    v_and_b32 v11, s41, v156
    v_fmac_f32 v72, v10, v10
    v_fmac_f32 v73, v11, v11
    v_lshlrev_b32 v10, 16, v157
    v_and_b32 v11, s41, v157
    v_fmac_f32 v72, v10, v10
    v_fmac_f32 v73, v11, v11
    s_add_u32 m0, s54, 20480
    s_nop 0
    buffer_load_dwordx4 v32, s[20:23], s76 offen lds
    s_add_u32 m0, s54, 24576
    s_nop 0
    buffer_load_dwordx4 v32, s[20:23], s77 offen lds
    ds_read_b128 v[168:171], v237 offset:0
    ds_read_b64_tr_b16 v[54:55], v244 offset:2048
    ds_read_b64_tr_b16 v[56:57], v244 offset:2560
    s_waitcnt lgkmcnt(6)
    v_mfma_f32_32x32x16_bf16 v[212:227], v[46:49], v[80:83], v[212:227]
    v_lshlrev_b32 v10, 16, v160
    v_and_b32 v11, s41, v160
    v_fmac_f32 v72, v10, v10
    v_fmac_f32 v73, v11, v11
    v_lshlrev_b32 v10, 16, v161
    v_and_b32 v11, s41, v161
    v_fmac_f32 v72, v10, v10
    v_fmac_f32 v73, v11, v11
    s_add_u32 m0, s54, 28672
    s_nop 0
    buffer_load_dwordx4 v32, s[20:23], s78 offen lds
    ds_read_b128 v[172:175], v238 offset:0
    ds_read_b64_tr_b16 v[46:47], v244 offset:4096
    ds_read_b64_tr_b16 v[48:49], v244 offset:4608
    s_waitcnt lgkmcnt(6)
    v_mfma_f32_32x32x16_bf16 v[212:227], v[50:53], v[80:83], v[212:227]
    v_lshlrev_b32 v10, 16, v164
    v_and_b32 v11, s41, v164
    v_fmac_f32 v72, v10, v10
    v_fmac_f32 v73, v11, v11
    v_lshlrev_b32 v10, 16, v165
    v_and_b32 v11, s41, v165
    v_fmac_f32 v72, v10, v10
    v_fmac_f32 v73, v11, v11
    ds_read_b128 v[176:179], v239 offset:0
    ds_read_b64_tr_b16 v[50:51], v244 offset:6144
    ds_read_b64_tr_b16 v[52:53], v244 offset:6656
    s_waitcnt lgkmcnt(6)
    v_mfma_f32_32x32x16_bf16 v[212:227], v[54:57], v[80:83], v[212:227]
    v_lshlrev_b32 v10, 16, v168
    v_and_b32 v11, s41, v168
    v_fmac_f32 v72, v10, v10
    v_fmac_f32 v73, v11, v11
    v_lshlrev_b32 v10, 16, v169
    v_and_b32 v11, s41, v169
    v_fmac_f32 v72, v10, v10
    v_fmac_f32 v73, v11, v11
    s_waitcnt vmcnt(11)
    s_barrier
    ds_read_b128 v[180:183], v228 offset:0
    ds_read_b64_tr_b16 v[54:55], v240 offset:0
    ds_read_b64_tr_b16 v[56:57], v240 offset:512
    s_waitcnt lgkmcnt(6)
    v_mfma_f32_32x32x16_bf16 v[212:227], v[46:49], v[80:83], v[212:227]
    v_lshlrev_b32 v10, 16, v172
    v_and_b32 v11, s41, v172
    v_fmac_f32 v72, v10, v10
    v_fmac_f32 v73, v11, v11
    v_lshlrev_b32 v10, 16, v173
    v_and_b32 v11, s41, v173
    v_fmac_f32 v72, v10, v10
    v_fmac_f32 v73, v11, v11
    ds_read_b128 v[184:187], v229 offset:0
    ds_read_b64_tr_b16 v[46:47], v240 offset:2048
    ds_read_b64_tr_b16 v[48:49], v240 offset:2560
    s_waitcnt lgkmcnt(6)
    v_mfma_f32_32x32x16_bf16 v[212:227], v[50:53], v[80:83], v[212:227]
    v_lshlrev_b32 v10, 16, v176
    v_and_b32 v11, s41, v176
    v_fmac_f32 v72, v10, v10
    v_fmac_f32 v73, v11, v11
    v_lshlrev_b32 v10, 16, v177
    v_and_b32 v11, s41, v177
    v_fmac_f32 v72, v10, v10
    v_fmac_f32 v73, v11, v11
    ds_read_b128 v[188:191], v230 offset:0
    ds_read_b64_tr_b16 v[50:51], v240 offset:4096
    ds_read_b64_tr_b16 v[52:53], v240 offset:4608
    s_waitcnt lgkmcnt(6)
    v_mfma_f32_32x32x16_bf16 v[212:227], v[54:57], v[80:83], v[212:227]
    v_lshlrev_b32 v10, 16, v180
    v_and_b32 v11, s41, v180
    v_fmac_f32 v72, v10, v10
    v_fmac_f32 v73, v11, v11
    v_lshlrev_b32 v10, 16, v181
    v_and_b32 v11, s41, v181
    v_fmac_f32 v72, v10, v10
    v_fmac_f32 v73, v11, v11
    ds_read_b128 v[192:195], v231 offset:0
    ds_read_b64_tr_b16 v[54:55], v240 offset:6144
    ds_read_b64_tr_b16 v[56:57], v240 offset:6656
    s_waitcnt lgkmcnt(6)
    v_mfma_f32_32x32x16_bf16 v[212:227], v[46:49], v[80:83], v[212:227]
    v_lshlrev_b32 v10, 16, v184
    v_and_b32 v11, s41, v184
    v_fmac_f32 v72, v10, v10
    v_fmac_f32 v73, v11, v11
    v_lshlrev_b32 v10, 16, v185
    v_and_b32 v11, s41, v185
    v_fmac_f32 v72, v10, v10
    v_fmac_f32 v73, v11, v11
    s_waitcnt vmcnt(7)
    s_barrier
    ds_read_b128 v[196:199], v228 offset:24576
    ds_read_b64_tr_b16 v[46:47], v240 offset:24576
    ds_read_b64_tr_b16 v[48:49], v240 offset:25088
    s_waitcnt lgkmcnt(6)
    v_mfma_f32_32x32x16_bf16 v[212:227], v[50:53], v[80:83], v[212:227]
    v_lshlrev_b32 v10, 16, v188
    v_and_b32 v11, s41, v188
    v_fmac_f32 v72, v10, v10
    v_fmac_f32 v73, v11, v11
    v_lshlrev_b32 v10, 16, v189
    v_and_b32 v11, s41, v189
    v_fmac_f32 v72, v10, v10
    v_fmac_f32 v73, v11, v11
    ds_read_b128 v[200:203], v229 offset:24576
    ds_read_b64_tr_b16 v[50:51], v240 offset:26624
    ds_read_b64_tr_b16 v[52:53], v240 offset:27136
    s_waitcnt lgkmcnt(6)
    v_mfma_f32_32x32x16_bf16 v[212:227], v[54:57], v[80:83], v[212:227]
    v_lshlrev_b32 v10, 16, v192
    v_and_b32 v11, s41, v192
    v_fmac_f32 v72, v10, v10
    v_fmac_f32 v73, v11, v11
    v_lshlrev_b32 v10, 16, v193
    v_and_b32 v11, s41, v193
    v_fmac_f32 v72, v10, v10
    v_fmac_f32 v73, v11, v11
    ds_read_b128 v[204:207], v230 offset:24576
    ds_read_b64_tr_b16 v[54:55], v240 offset:28672
    ds_read_b64_tr_b16 v[56:57], v240 offset:29184
    s_waitcnt lgkmcnt(6)
    v_mfma_f32_32x32x16_bf16 v[212:227], v[46:49], v[80:83], v[212:227]
    v_lshlrev_b32 v10, 16, v196
    v_and_b32 v11, s41, v196
    v_fmac_f32 v72, v10, v10
    v_fmac_f32 v73, v11, v11
    v_lshlrev_b32 v10, 16, v197
    v_and_b32 v11, s41, v197
    v_fmac_f32 v72, v10, v10
    v_fmac_f32 v73, v11, v11
    ds_read_b128 v[208:211], v231 offset:24576
    ds_read_b64_tr_b16 v[46:47], v240 offset:30720
    ds_read_b64_tr_b16 v[48:49], v240 offset:31232
    s_waitcnt lgkmcnt(6)
    v_mfma_f32_32x32x16_bf16 v[212:227], v[50:53], v[80:83], v[212:227]
    v_lshlrev_b32 v10, 16, v200
    v_and_b32 v11, s41, v200
    v_fmac_f32 v72, v10, v10
    v_fmac_f32 v73, v11, v11
    v_lshlrev_b32 v10, 16, v201
    v_and_b32 v11, s41, v201
    v_fmac_f32 v72, v10, v10
    v_fmac_f32 v73, v11, v11
    s_waitcnt lgkmcnt(3)
    v_mfma_f32_32x32x16_bf16 v[212:227], v[54:57], v[80:83], v[212:227]
    v_lshlrev_b32 v10, 16, v204
    v_and_b32 v11, s41, v204
    v_fmac_f32 v72, v10, v10
    v_fmac_f32 v73, v11, v11
    v_lshlrev_b32 v10, 16, v205
    v_and_b32 v11, s41, v205
    v_fmac_f32 v72, v10, v10
    v_fmac_f32 v73, v11, v11
    s_waitcnt lgkmcnt(0)
    v_mfma_f32_32x32x16_bf16 v[212:227], v[46:49], v[80:83], v[212:227]
    v_lshlrev_b32 v10, 16, v208
    v_and_b32 v11, s41, v208
    v_fmac_f32 v72, v10, v10
    v_fmac_f32 v73, v11, v11
    v_lshlrev_b32 v10, 16, v209
    v_and_b32 v11, s41, v209
    v_fmac_f32 v72, v10, v10
    v_fmac_f32 v73, v11, v11
    v_add_f32 v72, v72, v73
    v_mov_b32 v10, v72
    v_mov_b32 v11, v72
    s_nop 1
    v_permlane32_swap_b32 v10, v11
    v_add_f32 v72, v10, v11
    ds_write_b32 v9, v72 offset:1024
    s_mov_b32 s54, 1
    s_mov_b32 s55, 1
    s_mov_b64 exec, s[54:55]
    s_and_b32 s50, s39, 1
    s_lshl_b32 s50, s50, 7
    v_lshl_add_u32 v8, v3, 4, s50
    ds_write_b128 v8, v[212:215] offset:128
    ds_write_b128 v8, v[216:219] offset:160
    ds_write_b128 v8, v[220:223] offset:192
    ds_write_b128 v8, v[224:227] offset:224
    s_mov_b64 exec, -1
    s_waitcnt lgkmcnt(0)
    s_barrier
    s_waitcnt vmcnt(0)
    ds_write_b32 v86, v87 offset:464
    s_mov_b32 s64, s10
    s_mov_b32 s65, s11
    s_mov_b32 s66, 401408
    s_mov_b32 s67, 0x00020000
    s_lshr_b32 s60, s2, 3
    s_lshl_b32 s60, s60, 2
    s_add_u32 s60, s60, s39
    v_lshlrev_b32 v247, 7, v1
    v_mov_b32 v248, 0x7fff0000
    v_cmp_gt_u32 vcc, 25, v1
    s_nop 1
    v_cndmask_b32 v249, v248, v247, vcc
    s_mul_i32 s61, s60, 3200
    buffer_load_dword v250, v249, s[64:67], s61 offen
    v_cmp_gt_u32 vcc, 32, v1
    s_nop 1
    v_cndmask_b32 v249, v248, v247, vcc
    s_lshl_b32 s61, s60, 12
    s_mov_b32 s64, s56
    s_mov_b32 s65, s57
    s_mov_b32 s66, 1605632
    s_mov_b32 s67, 0x00020000
    buffer_load_dword v251, v249, s[64:67], s61 offen
    s_mov_b32 s64, s58
    s_mov_b32 s65, s59
    s_mov_b32 s66, 1605632
    s_mov_b32 s67, 0x00020000
    buffer_load_dword v252, v249, s[64:67], s61 offen
    v_cmp_gt_u32 vcc, 13, v1
    s_nop 1
    v_cndmask_b32 v249, v248, v247, vcc
    s_lshl_b32 s61, s2, 2
    s_add_u32 s61, s61, s39
    s_mul_i32 s61, s61, 1664
    s_mov_b32 s64, s68
    s_mov_b32 s65, s69
    s_mov_b32 s66, 1605632
    s_mov_b32 s67, 0x00020000
    buffer_load_dword v253, v249, s[64:67], s61 offen
K1_QPOLL:
    ds_read_b128 v[88:91], v85 offset:464
    s_waitcnt lgkmcnt(0)
    v_and_b32 v88, v88, v89
    v_and_b32 v90, v90, v91
    v_and_b32 v88, v88, v90
    s_nop 0
    v_readfirstlane_b32 s51, v88
    s_cmp_eq_u32 s51, 0
    s_cbranch_scc1 K1_QPOLL
    ds_read_b32 v66, v9 offset:1536
    ds_read_b32 v67, v9 offset:512
    ds_read_b32 v68, v9 offset:1024
    ds_read_b64_tr_b16 v[92:93], v12 offset:2048
    ds_read_b64_tr_b16 v[94:95], v12 offset:2496
    ds_read_b64_tr_b16 v[96:97], v12 offset:2944
    ds_read_b64_tr_b16 v[98:99], v12 offset:3392
    ds_read_b64_tr_b16 v[34:35], v246 offset:0
    ds_read_b64_tr_b16 v[36:37], v246 offset:256
    ds_read_b64_tr_b16 v[38:39], v246 offset:1024
    ds_read_b64_tr_b16 v[40:41], v246 offset:1280
    ds_read_b64_tr_b16 v[42:43], v246 offset:2048
    ds_read_b64_tr_b16 v[44:45], v246 offset:2304
    ds_read_b64_tr_b16 v[46:47], v246 offset:3072
    ds_read_b64_tr_b16 v[48:49], v246 offset:3328
    ds_read_b64_tr_b16 v[50:51], v246 offset:4096
    ds_read_b64_tr_b16 v[52:53], v246 offset:4352
    s_waitcnt lgkmcnt(8)
    v_mfma_f32_32x32x16_bf16 v[14:29], v[34:37], v[100:103], 0
    v_mfma_f32_32x32x16_bf16 v[212:227], v[34:37], v[80:83], 0
    v_add_f32 v67, v67, v68
    ds_read_b64_tr_b16 v[54:55], v246 offset:5120
    ds_read_b64_tr_b16 v[56:57], v246 offset:5376
    s_waitcnt lgkmcnt(8)
    v_mfma_f32_32x32x16_bf16 v[14:29], v[38:41], v[104:107], v[14:29]
    v_mfma_f32_32x32x16_bf16 v[212:227], v[38:41], v[80:83], v[212:227]
    v_mul_f32 v66, 0x3b124925, v66
    ds_read_b64_tr_b16 v[34:35], v246 offset:6144
    ds_read_b64_tr_b16 v[36:37], v246 offset:6400
    s_waitcnt lgkmcnt(8)
    v_mfma_f32_32x32x16_bf16 v[14:29], v[42:45], v[108:111], v[14:29]
    v_mfma_f32_32x32x16_bf16 v[212:227], v[42:45], v[80:83], v[212:227]
    v_mul_f32 v67, 0x3b124925, v67
    ds_read_b64_tr_b16 v[38:39], v246 offset:7168
    ds_read_b64_tr_b16 v[40:41], v246 offset:7424
    s_waitcnt lgkmcnt(8)
    v_mfma_f32_32x32x16_bf16 v[14:29], v[46:49], v[112:115], v[14:29]
    v_mfma_f32_32x32x16_bf16 v[212:227], v[46:49], v[80:83], v[212:227]
    v_fma_f32 v67, -v66, v66, v67
    ds_read_b64_tr_b16 v[42:43], v246 offset:8192
    ds_read_b64_tr_b16 v[44:45], v246 offset:8448
    s_waitcnt lgkmcnt(8)
    v_mfma_f32_32x32x16_bf16 v[14:29], v[50:53], v[116:119], v[14:29]
    v_mfma_f32_32x32x16_bf16 v[212:227], v[50:53], v[80:83], v[212:227]
    v_max_f32 v67, 0, v67
    ds_read_b64_tr_b16 v[46:47], v246 offset:9216
    ds_read_b64_tr_b16 v[48:49], v246 offset:9472
    s_waitcnt lgkmcnt(8)
    v_mfma_f32_32x32x16_bf16 v[14:29], v[54:57], v[120:123], v[14:29]
    v_mfma_f32_32x32x16_bf16 v[212:227], v[54:57], v[80:83], v[212:227]
    v_cvt_pk_bf16_f32 v66, v67, v66
    ds_read_b64_tr_b16 v[50:51], v246 offset:10240
    ds_read_b64_tr_b16 v[52:53], v246 offset:10496
    s_waitcnt lgkmcnt(8)
    v_mfma_f32_32x32x16_bf16 v[14:29], v[34:37], v[124:127], v[14:29]
    v_mfma_f32_32x32x16_bf16 v[212:227], v[34:37], v[80:83], v[212:227]
    v_lshlrev_b32 v67, 16, v66
    ds_read_b64_tr_b16 v[54:55], v246 offset:11264
    ds_read_b64_tr_b16 v[56:57], v246 offset:11520
    s_waitcnt lgkmcnt(8)
    v_mfma_f32_32x32x16_bf16 v[14:29], v[38:41], v[128:131], v[14:29]
    v_mfma_f32_32x32x16_bf16 v[212:227], v[38:41], v[80:83], v[212:227]
    v_and_b32 v66, 0xffff0000, v66
    ds_read_b64_tr_b16 v[34:35], v246 offset:12288
    ds_read_b64_tr_b16 v[36:37], v246 offset:12544
    s_waitcnt lgkmcnt(8)
    v_mfma_f32_32x32x16_bf16 v[14:29], v[42:45], v[132:135], v[14:29]
    v_mfma_f32_32x32x16_bf16 v[212:227], v[42:45], v[80:83], v[212:227]
    v_add_f32 v67, 0x3727c5ac, v67
    ds_read_b64_tr_b16 v[38:39], v246 offset:13312
    ds_read_b64_tr_b16 v[40:41], v246 offset:13568
    s_waitcnt lgkmcnt(8)
    v_mfma_f32_32x32x16_bf16 v[14:29], v[46:49], v[136:139], v[14:29]
    v_mfma_f32_32x32x16_bf16 v[212:227], v[46:49], v[80:83], v[212:227]
    v_xor_b32 v68, 0x80000000, v66
    ds_read_b64_tr_b16 v[42:43], v246 offset:14336
    ds_read_b64_tr_b16 v[44:45], v246 offset:14592
    s_waitcnt lgkmcnt(8)
    v_mfma_f32_32x32x16_bf16 v[14:29], v[50:53], v[140:143], v[14:29]
    v_mfma_f32_32x32x16_bf16 v[212:227], v[50:53], v[80:83], v[212:227]
    v_cvt_pk_bf16_f32 v67, v67, v67
    ds_read_b64_tr_b16 v[46:47], v246 offset:15360
    ds_read_b64_tr_b16 v[48:49], v246 offset:15616
    s_waitcnt lgkmcnt(8)
    v_mfma_f32_32x32x16_bf16 v[14:29], v[54:57], v[144:147], v[14:29]
    v_mfma_f32_32x32x16_bf16 v[212:227], v[54:57], v[80:83], v[212:227]
    v_and_b32 v67, 0xffff0000, v67
    ds_read_b64_tr_b16 v[50:51], v246 offset:16384
    ds_read_b64_tr_b16 v[52:53], v246 offset:16640
    s_waitcnt lgkmcnt(8)
    v_mfma_f32_32x32x16_bf16 v[14:29], v[34:37], v[148:151], v[14:29]
    v_mfma_f32_32x32x16_bf16 v[212:227], v[34:37], v[80:83], v[212:227]
    v_sqrt_f32 v67, v67
    ds_read_b64_tr_b16 v[54:55], v246 offset:17408
    ds_read_b64_tr_b16 v[56:57], v246 offset:17664
    s_waitcnt lgkmcnt(8)
    v_mfma_f32_32x32x16_bf16 v[14:29], v[38:41], v[152:155], v[14:29]
    v_mfma_f32_32x32x16_bf16 v[212:227], v[38:41], v[80:83], v[212:227]
    v_cvt_pk_bf16_f32 v70, v67, v67
    ds_read_b64_tr_b16 v[34:35], v246 offset:18432
    ds_read_b64_tr_b16 v[36:37], v246 offset:18688
    s_waitcnt lgkmcnt(8)
    v_mfma_f32_32x32x16_bf16 v[14:29], v[42:45], v[156:159], v[14:29]
    v_mfma_f32_32x32x16_bf16 v[212:227], v[42:45], v[80:83], v[212:227]
    v_and_b32 v70, 0xffff0000, v70
    ds_read_b64_tr_b16 v[38:39], v246 offset:19456
    ds_read_b64_tr_b16 v[40:41], v246 offset:19712
    s_waitcnt lgkmcnt(8)
    v_mfma_f32_32x32x16_bf16 v[14:29], v[46:49], v[160:163], v[14:29]
    v_mfma_f32_32x32x16_bf16 v[212:227], v[46:49], v[80:83], v[212:227]
    v_rcp_f32 v69, v70
    ds_read_b64_tr_b16 v[42:43], v246 offset:20480
    ds_read_b64_tr_b16 v[44:45], v246 offset:20736
    s_waitcnt lgkmcnt(8)
    v_mfma_f32_32x32x16_bf16 v[14:29], v[50:53], v[164:167], v[14:29]
    v_mfma_f32_32x32x16_bf16 v[212:227], v[50:53], v[80:83], v[212:227]
    v_mul_f32 v71, s44, v69
    ds_read_b64_tr_b16 v[46:47], v246 offset:21504
    ds_read_b64_tr_b16 v[48:49], v246 offset:21760
    s_waitcnt lgkmcnt(8)
    v_mfma_f32_32x32x16_bf16 v[14:29], v[54:57], v[168:171], v[14:29]
    v_mfma_f32_32x32x16_bf16 v[212:227], v[54:57], v[80:83], v[212:227]
    ds_read_b64_tr_b16 v[50:51], v246 offset:22528
    ds_read_b64_tr_b16 v[52:53], v246 offset:22784
    s_waitcnt lgkmcnt(8)
    v_mfma_f32_32x32x16_bf16 v[14:29], v[34:37], v[172:175], v[14:29]
    v_mfma_f32_32x32x16_bf16 v[212:227], v[34:37], v[80:83], v[212:227]
    ds_read_b64_tr_b16 v[54:55], v246 offset:23552
    ds_read_b64_tr_b16 v[56:57], v246 offset:23808
    s_waitcnt lgkmcnt(8)
    v_mfma_f32_32x32x16_bf16 v[14:29], v[38:41], v[176:179], v[14:29]
    v_mfma_f32_32x32x16_bf16 v[212:227], v[38:41], v[80:83], v[212:227]
    ds_read_b64_tr_b16 v[34:35], v246 offset:24576
    ds_read_b64_tr_b16 v[36:37], v246 offset:24832
    s_waitcnt lgkmcnt(8)
    v_mfma_f32_32x32x16_bf16 v[14:29], v[42:45], v[180:183], v[14:29]
    v_mfma_f32_32x32x16_bf16 v[212:227], v[42:45], v[80:83], v[212:227]
    ds_read_b64_tr_b16 v[38:39], v246 offset:25600
    ds_read_b64_tr_b16 v[40:41], v246 offset:25856
    s_waitcnt lgkmcnt(8)
    v_mfma_f32_32x32x16_bf16 v[14:29], v[46:49], v[184:187], v[14:29]
    v_mfma_f32_32x32x16_bf16 v[212:227], v[46:49], v[80:83], v[212:227]
    ds_read_b64_tr_b16 v[42:43], v246 offset:26624
    ds_read_b64_tr_b16 v[44:45], v246 offset:26880
    s_waitcnt lgkmcnt(8)
    v_mfma_f32_32x32x16_bf16 v[14:29], v[50:53], v[188:191], v[14:29]
    v_mfma_f32_32x32x16_bf16 v[212:227], v[50:53], v[80:83], v[212:227]
    ds_read_b64_tr_b16 v[46:47], v246 offset:27648
    ds_read_b64_tr_b16 v[48:49], v246 offset:27904
    s_waitcnt lgkmcnt(8)
    v_mfma_f32_32x32x16_bf16 v[14:29], v[54:57], v[192:195], v[14:29]
    v_mfma_f32_32x32x16_bf16 v[212:227], v[54:57], v[80:83], v[212:227]
    s_waitcnt lgkmcnt(6)
    v_mfma_f32_32x32x16_bf16 v[14:29], v[34:37], v[196:199], v[14:29]
    v_mfma_f32_32x32x16_bf16 v[212:227], v[34:37], v[80:83], v[212:227]
    s_waitcnt lgkmcnt(4)
    v_mfma_f32_32x32x16_bf16 v[14:29], v[38:41], v[200:203], v[14:29]
    v_mfma_f32_32x32x16_bf16 v[212:227], v[38:41], v[80:83], v[212:227]
    s_waitcnt lgkmcnt(2)
    v_mfma_f32_32x32x16_bf16 v[14:29], v[42:45], v[204:207], v[14:29]
    v_mfma_f32_32x32x16_bf16 v[212:227], v[42:45], v[80:83], v[212:227]
    s_waitcnt lgkmcnt(0)
    v_mfma_f32_32x32x16_bf16 v[14:29], v[46:49], v[208:211], v[14:29]
    v_mfma_f32_32x32x16_bf16 v[212:227], v[46:49], v[80:83], v[212:227]
    s_lshl_b32 s50, s36, 2
    s_add_u32 s50, s50, s39
    s_lshl_b32 s50, s50, 4
    s_add_u32 s50, s50, s37
    s_lshl_b32 s50, s50, 12
    s_add_u32 s50, s50, 1048576
    v_lshlrev_b32 v7, 4, v1
    s_nop 4
    v_fmac_f32 v14, v212, v68
    v_fmac_f32 v15, v213, v68
    v_cvt_pk_bf16_f32 v132, v14, v15
    v_fmac_f32 v16, v214, v68
    v_fmac_f32 v17, v215, v68
    v_cvt_pk_bf16_f32 v133, v16, v17
    v_fmac_f32 v18, v216, v68
    v_fmac_f32 v19, v217, v68
    v_cvt_pk_bf16_f32 v134, v18, v19
    v_fmac_f32 v20, v218, v68
    v_fmac_f32 v21, v219, v68
    v_cvt_pk_bf16_f32 v135, v20, v21
    v_fmac_f32 v22, v220, v68
    v_fmac_f32 v23, v221, v68
    v_cvt_pk_bf16_f32 v136, v22, v23
    v_fmac_f32 v24, v222, v68
    v_fmac_f32 v25, v223, v68
    v_cvt_pk_bf16_f32 v137, v24, v25
    v_fmac_f32 v26, v224, v68
    v_fmac_f32 v27, v225, v68
    v_cvt_pk_bf16_f32 v138, v26, v27
    v_fmac_f32 v28, v226, v68
    v_fmac_f32 v29, v227, v68
    v_cvt_pk_bf16_f32 v139, v28, v29
    v_cndmask_b32 v138, v138, 0, s[42:43]
    v_cndmask_b32 v139, v139, 0, s[42:43]
    v_mfma_f32_32x32x16_bf16 v[148:163], v[92:95], v[132:135], 0
    s_nop 0
    v_mfma_f32_32x32x16_bf16 v[148:163], v[96:99], v[136:139], v[148:163]
    s_nop 11
    v_cndmask_b32 v160, v160, v148, s[42:43]
    v_cndmask_b32 v161, v161, v148, s[42:43]
    v_cndmask_b32 v162, v162, v148, s[42:43]
    v_cndmask_b32 v163, v163, v148, s[42:43]
    v_max3_f32 v52, v148, v149, v150
    v_min3_f32 v53, v148, v149, v150
    v_max3_f32 v52, v52, v151, v152
    v_min3_f32 v53, v53, v151, v152
    v_max3_f32 v52, v52, v153, v154
    v_min3_f32 v53, v53, v153, v154
    v_max3_f32 v52, v52, v155, v156
    v_min3_f32 v53, v53, v155, v156
    v_max3_f32 v52, v52, v157, v158
    v_min3_f32 v53, v53, v157, v158
    v_max3_f32 v52, v52, v159, v160
    v_min3_f32 v53, v53, v159, v160
    v_max3_f32 v52, v52, v161, v162
    v_min3_f32 v53, v53, v161, v162
    v_max_f32 v52, v52, v163
    v_min_f32 v53, v53, v163
    v_mov_b32 v54, v52
    v_mov_b32 v56, v53
    s_nop 0
    v_permlane32_swap_b32 v54, v52
    v_permlane32_swap_b32 v56, v53
    v_max_f32 v52, v54, v52
    v_min_f32 v53, v56, v53
    v_mul_f32 v52, v71, v52
    v_mul_f32 v53, v71, v53
    v_fma_f32 v164, v148, v71, -v52
    v_fma_f32 v180, -v148, v71, v53
    v_fma_f32 v165, v149, v71, -v52
    v_fma_f32 v181, -v149, v71, v53
    v_exp_f32 v164, v164
    v_exp_f32 v180, v180
    v_fma_f32 v166, v150, v71, -v52
    v_fma_f32 v182, -v150, v71, v53
    v_exp_f32 v165, v165
    v_exp_f32 v181, v181
    v_fma_f32 v167, v151, v71, -v52
    v_fma_f32 v183, -v151, v71, v53
    v_exp_f32 v166, v166
    v_exp_f32 v182, v182
    v_fma_f32 v168, v152, v71, -v52
    v_fma_f32 v184, -v152, v71, v53
    v_exp_f32 v167, v167
    v_exp_f32 v183, v183
    v_fma_f32 v169, v153, v71, -v52
    v_fma_f32 v185, -v153, v71, v53
    v_exp_f32 v168, v168
    v_exp_f32 v184, v184
    v_fma_f32 v170, v154, v71, -v52
    v_fma_f32 v186, -v154, v71, v53
    v_exp_f32 v169, v169
    v_exp_f32 v185, v185
    v_fma_f32 v171, v155, v71, -v52
    v_fma_f32 v187, -v155, v71, v53
    v_exp_f32 v170, v170
    v_exp_f32 v186, v186
    v_fma_f32 v172, v156, v71, -v52
    v_fma_f32 v188, -v156, v71, v53
    v_exp_f32 v171, v171
    v_exp_f32 v187, v187
    v_fma_f32 v173, v157, v71, -v52
    v_fma_f32 v189, -v157, v71, v53
    v_exp_f32 v172, v172
    v_exp_f32 v188, v188
    v_fma_f32 v174, v158, v71, -v52
    v_fma_f32 v190, -v158, v71, v53
    v_exp_f32 v173, v173
    v_exp_f32 v189, v189
    v_fma_f32 v175, v159, v71, -v52
    v_fma_f32 v191, -v159, v71, v53
    v_exp_f32 v174, v174
    v_exp_f32 v190, v190
    v_fma_f32 v176, v160, v71, -v52
    v_fma_f32 v192, -v160, v71, v53
    v_exp_f32 v175, v175
    v_exp_f32 v191, v191
    v_fma_f32 v177, v161, v71, -v52
    v_fma_f32 v193, -v161, v71, v53
    v_exp_f32 v176, v176
    v_exp_f32 v192, v192
    v_fma_f32 v178, v162, v71, -v52
    v_fma_f32 v194, -v162, v71, v53
    v_exp_f32 v177, v177
    v_exp_f32 v193, v193
    v_fma_f32 v179, v163, v71, -v52
    v_fma_f32 v195, -v163, v71, v53
    v_exp_f32 v178, v178
    v_exp_f32 v194, v194
    v_exp_f32 v179, v179
    v_exp_f32 v195, v195
    v_add_f32 v56, v164, v165
    v_add_f32 v57, v180, v181
    v_add_f32 v54, v166, v167
    v_add_f32 v55, v182, v183
    v_add_f32 v56, v56, v168
    v_add_f32 v57, v57, v184
    v_add_f32 v54, v54, v169
    v_add_f32 v55, v55, v185
    v_add_f32 v56, v56, v170
    v_add_f32 v57, v57, v186
    v_add_f32 v54, v54, v171
    v_add_f32 v55, v55, v187
    v_add_f32 v56, v56, v172
    v_add_f32 v57, v57, v188
    v_add_f32 v54, v54, v173
    v_add_f32 v55, v55, v189
    v_add_f32 v56, v56, v174
    v_add_f32 v57, v57, v190
    v_add_f32 v54, v54, v175
    v_add_f32 v55, v55, v191
    v_cndmask_b32 v176, v176, 0, s[42:43]
    v_cndmask_b32 v192, v192, 0, s[42:43]
    v_cndmask_b32 v177, v177, 0, s[42:43]
    v_cndmask_b32 v193, v193, 0, s[42:43]
    v_cndmask_b32 v178, v178, 0, s[42:43]
    v_cndmask_b32 v194, v194, 0, s[42:43]
    v_cndmask_b32 v179, v179, 0, s[42:43]
    v_cndmask_b32 v195, v195, 0, s[42:43]
    v_add_f32 v56, v56, v176
    v_add_f32 v57, v57, v192
    v_add_f32 v54, v54, v177
    v_add_f32 v55, v55, v193
    v_add_f32 v56, v56, v178
    v_add_f32 v57, v57, v194
    v_add_f32 v54, v54, v179
    v_add_f32 v55, v55, v195
    v_add_f32 v56, v56, v54
    v_add_f32 v57, v57, v55
    v_mov_b32 v54, v56
    v_mov_b32 v55, v57
    s_nop 0
    v_permlane32_swap_b32 v54, v56
    v_permlane32_swap_b32 v55, v57
    v_add_f32 v56, v54, v56
    v_add_f32 v57, v55, v57
    v_rcp_f32 v56, v56
    v_rcp_f32 v57, v57
    v_mul_f32 v164, v164, v56
    v_mul_f32 v165, v165, v56
    v_cvt_pk_bf16_f32 v36, v164, v165
    v_mul_f32 v166, v166, v56
    v_mul_f32 v167, v167, v56
    v_cvt_pk_bf16_f32 v37, v166, v167
    v_mul_f32 v168, v168, v56
    v_mul_f32 v169, v169, v56
    v_cvt_pk_bf16_f32 v38, v168, v169
    v_mul_f32 v170, v170, v56
    v_mul_f32 v171, v171, v56
    v_cvt_pk_bf16_f32 v39, v170, v171
    v_mul_f32 v172, v172, v56
    v_mul_f32 v173, v173, v56
    v_cvt_pk_bf16_f32 v40, v172, v173
    v_mul_f32 v174, v174, v56
    v_mul_f32 v175, v175, v56
    v_cvt_pk_bf16_f32 v41, v174, v175
    v_mul_f32 v176, v176, v56
    v_mul_f32 v177, v177, v56
    v_cvt_pk_bf16_f32 v42, v176, v177
    v_mul_f32 v178, v178, v56
    v_mul_f32 v179, v179, v56
    v_cvt_pk_bf16_f32 v43, v178, v179
    v_mul_f32 v180, v180, v57
    v_mul_f32 v181, v181, v57
    v_cvt_pk_bf16_f32 v44, v180, v181
    v_mul_f32 v182, v182, v57
    v_mul_f32 v183, v183, v57
    v_cvt_pk_bf16_f32 v45, v182, v183
    v_mul_f32 v184, v184, v57
    v_mul_f32 v185, v185, v57
    v_cvt_pk_bf16_f32 v46, v184, v185
    v_mul_f32 v186, v186, v57
    v_mul_f32 v187, v187, v57
    v_cvt_pk_bf16_f32 v47, v186, v187
    v_mul_f32 v188, v188, v57
    v_mul_f32 v189, v189, v57
    v_cvt_pk_bf16_f32 v48, v188, v189
    v_mul_f32 v190, v190, v57
    v_mul_f32 v191, v191, v57
    v_cvt_pk_bf16_f32 v49, v190, v191
    v_mul_f32 v192, v192, v57
    v_mul_f32 v193, v193, v57
    v_cvt_pk_bf16_f32 v50, v192, v193
    v_mul_f32 v194, v194, v57
    v_mul_f32 v195, v195, v57
    v_cvt_pk_bf16_f32 v51, v194, v195
    buffer_store_dwordx4 v[36:39], v7, s[32:35], s50 offen offset:0
    buffer_store_dwordx4 v[40:43], v7, s[32:35], s50 offen offset:1024
    buffer_store_dwordx4 v[44:47], v7, s[32:35], s50 offen offset:2048
    buffer_store_dwordx4 v[48:51], v7, s[32:35], s50 offen offset:3072
K1_FIN:
K1_END:
    s_endpgm
.globl k3_kernel
.p2align 8
.type k3_kernel,@function
k3_kernel:
    s_cmp_ge_u32 s2, 256
    s_cbranch_scc1 K3_END
    s_load_dwordx4 s[8:11], s[0:1], 40
    s_load_dwordx4 s[4:7], s[0:1], 56
    s_load_dwordx2 s[14:15], s[0:1], 80
    s_load_dwordx2 s[12:13], s[0:1], 24
    s_load_dwordx2 s[42:43], s[0:1], 0
    v_and_b32 v1, 63, v0
    v_lshrrev_b32 v6, 6, v0
    s_nop 0
    v_readfirstlane_b32 s38, v6
    v_and_b32 v2, 31, v1
    v_lshrrev_b32 v3, 5, v1
    v_and_b32 v4, 15, v1
    v_lshrrev_b32 v5, 4, v1
    s_mov_b32 s41, 0xffff0000
    s_cmp_ge_u32 s2, 224
    s_cbranch_scc1 K3_PF
    s_and_b32 s36, s2, 7
    s_lshl_b32 s36, s36, 1
    s_bfe_u32 s37, s2, 0x10003
    s_add_u32 s36, s36, s37
    s_lshr_b32 s37, s2, 4
    s_and_b32 s39, s38, 1
    s_lshr_b32 s40, s38, 1
    v_lshrrev_b32 v7, 3, v1
    v_and_b32 v8, 2, v7
    v_add_u32 v8, s39, v8
    v_lshlrev_b32 v8, 1, v8
    v_and_b32 v9, 7, v1
    v_xor_b32 v8, v8, v9
    v_mul_u32_u24 v7, 3584, v7
    v_lshl_add_u32 v10, v8, 4, v7
    v_lshlrev_b32 v11, 4, v1
    s_mul_i32 s46, s40, 114688
    s_lshl_b32 s47, s37, 8
    s_add_u32 s46, s46, s47
    s_and_b32 s57, s36, 1
    s_lshl_b32 s58, s57, 7
    s_xor_b32 s59, s58, 128
    s_add_u32 s56, s46, s59
    s_add_u32 s46, s46, s58
    s_lshl_b32 s47, s39, 13
    s_lshl_b32 s48, s40, 12
    s_add_u32 s47, s47, s48
    s_lshl_b32 s48, s36, 2
    s_add_u32 s48, s48, s38
    s_mul_i32 s49, s48, 28672
    s_add_u32 s49, s49, 8388608
    s_waitcnt lgkmcnt(0)
    s_cmp_eq_u32 s39, 0
    s_cselect_b32 s20, s8, s10
    s_cselect_b32 s21, s9, s11
    s_mov_b32 s22, 1605632
    s_mov_b32 s23, 0x00020000
    s_mov_b32 s32, s14
    s_mov_b32 s33, s15
    s_mov_b32 s34, 268435456
    s_mov_b32 s35, 0x00020000
    s_lshr_b32 s60, s2, 3
    s_lshl_b32 s61, s38, 15
    s_add_u32 s50, s60, 0
    s_and_b32 s50, s50, 31
    s_lshl_b32 s50, s50, 10
    s_add_u32 s50, s50, s61
    buffer_load_dwordx4 v[128:131], v11, s[32:35], s50 offen offset:0
    s_add_u32 s50, s60, 1
    s_and_b32 s50, s50, 31
    s_lshl_b32 s50, s50, 10
    s_add_u32 s50, s50, s61
    buffer_load_dwordx4 v[132:135], v11, s[32:35], s50 offen offset:0
    s_add_u32 s50, s60, 2
    s_and_b32 s50, s50, 31
    s_lshl_b32 s50, s50, 10
    s_add_u32 s50, s50, s61
    buffer_load_dwordx4 v[136:139], v11, s[32:35], s50 offen offset:0
    s_add_u32 s50, s60, 3
    s_and_b32 s50, s50, 31
    s_lshl_b32 s50, s50, 10
    s_add_u32 s50, s50, s61
    buffer_load_dwordx4 v[140:143], v11, s[32:35], s50 offen offset:0
    s_add_u32 s50, s60, 4
    s_and_b32 s50, s50, 31
    s_lshl_b32 s50, s50, 10
    s_add_u32 s50, s50, s61
    buffer_load_dwordx4 v[144:147], v11, s[32:35], s50 offen offset:0
    s_add_u32 s50, s60, 5
    s_and_b32 s50, s50, 31
    s_lshl_b32 s50, s50, 10
    s_add_u32 s50, s50, s61
    buffer_load_dwordx4 v[148:151], v11, s[32:35], s50 offen offset:0
    s_add_u32 s50, s60, 6
    s_and_b32 s50, s50, 31
    s_lshl_b32 s50, s50, 10
    s_add_u32 s50, s50, s61
    buffer_load_dwordx4 v[152:155], v11, s[32:35], s50 offen offset:0
    s_add_u32 s50, s60, 7
    s_and_b32 s50, s50, 31
    s_lshl_b32 s50, s50, 10
    s_add_u32 s50, s50, s61
    buffer_load_dwordx4 v[156:159], v11, s[32:35], s50 offen offset:0
    s_add_u32 s50, s60, 8
    s_and_b32 s50, s50, 31
    s_lshl_b32 s50, s50, 10
    s_add_u32 s50, s50, s61
    buffer_load_dwordx4 v[160:163], v11, s[32:35], s50 offen offset:0
    s_add_u32 s50, s60, 9
    s_and_b32 s50, s50, 31
    s_lshl_b32 s50, s50, 10
    s_add_u32 s50, s50, s61
    buffer_load_dwordx4 v[164:167], v11, s[32:35], s50 offen offset:0
    s_add_u32 s50, s60, 10
    s_and_b32 s50, s50, 31
    s_lshl_b32 s50, s50, 10
    s_add_u32 s50, s50, s61
    buffer_load_dwordx4 v[168:171], v11, s[32:35], s50 offen offset:0
    s_add_u32 s50, s60, 11
    s_and_b32 s50, s50, 31
    s_lshl_b32 s50, s50, 10
    s_add_u32 s50, s50, s61
    buffer_load_dwordx4 v[172:175], v11, s[32:35], s50 offen offset:0
    s_add_u32 s50, s60, 12
    s_and_b32 s50, s50, 31
    s_lshl_b32 s50, s50, 10
    s_add_u32 s50, s50, s61
    buffer_load_dwordx4 v[176:179], v11, s[32:35], s50 offen offset:0
    s_add_u32 s50, s60, 13
    s_and_b32 s50, s50, 31
    s_lshl_b32 s50, s50, 10
    s_add_u32 s50, s50, s61
    buffer_load_dwordx4 v[180:183], v11, s[32:35], s50 offen offset:0
    s_add_u32 s50, s60, 14
    s_and_b32 s50, s50, 31
    s_lshl_b32 s50, s50, 10
    s_add_u32 s50, s50, s61
    buffer_load_dwordx4 v[184:187], v11, s[32:35], s50 offen offset:0
    s_add_u32 s50, s60, 15
    s_and_b32 s50, s50, 31
    s_lshl_b32 s50, s50, 10
    s_add_u32 s50, s50, s61
    buffer_load_dwordx4 v[188:191], v11, s[32:35], s50 offen offset:0
    s_add_u32 s50, s60, 16
    s_and_b32 s50, s50, 31
    s_lshl_b32 s50, s50, 10
    s_add_u32 s50, s50, s61
    buffer_load_dwordx4 v[192:195], v11, s[32:35], s50 offen offset:0
    s_add_u32 s50, s60, 17
    s_and_b32 s50, s50, 31
    s_lshl_b32 s50, s50, 10
    s_add_u32 s50, s50, s61
    buffer_load_dwordx4 v[196:199], v11, s[32:35], s50 offen offset:0
    s_add_u32 s50, s60, 18
    s_and_b32 s50, s50, 31
    s_lshl_b32 s50, s50, 10
    s_add_u32 s50, s50, s61
    buffer_load_dwordx4 v[200:203], v11, s[32:35], s50 offen offset:0
    s_add_u32 s50, s60, 19
    s_and_b32 s50, s50, 31
    s_lshl_b32 s50, s50, 10
    s_add_u32 s50, s50, s61
    buffer_load_dwordx4 v[204:207], v11, s[32:35], s50 offen offset:0
    s_add_u32 s50, s60, 20
    s_and_b32 s50, s50, 31
    s_lshl_b32 s50, s50, 10
    s_add_u32 s50, s50, s61
    buffer_load_dwordx4 v[208:211], v11, s[32:35], s50 offen offset:0
    s_add_u32 s50, s60, 21
    s_and_b32 s50, s50, 31
    s_lshl_b32 s50, s50, 10
    s_add_u32 s50, s50, s61
    buffer_load_dwordx4 v[212:215], v11, s[32:35], s50 offen offset:0
    s_add_u32 s50, s60, 22
    s_and_b32 s50, s50, 31
    s_lshl_b32 s50, s50, 10
    s_add_u32 s50, s50, s61
    buffer_load_dwordx4 v[216:219], v11, s[32:35], s50 offen offset:0
    s_add_u32 s50, s60, 23
    s_and_b32 s50, s50, 31
    s_lshl_b32 s50, s50, 10
    s_add_u32 s50, s50, s61
    buffer_load_dwordx4 v[220:223], v11, s[32:35], s50 offen offset:0
    s_add_u32 s50, s60, 24
    s_and_b32 s50, s50, 31
    s_lshl_b32 s50, s50, 10
    s_add_u32 s50, s50, s61
    buffer_load_dwordx4 v[224:227], v11, s[32:35], s50 offen offset:0
    s_add_u32 s50, s60, 25
    s_and_b32 s50, s50, 31
    s_lshl_b32 s50, s50, 10
    s_add_u32 s50, s50, s61
    buffer_load_dwordx4 v[228:231], v11, s[32:35], s50 offen offset:0
    s_add_u32 s50, s60, 26
    s_and_b32 s50, s50, 31
    s_lshl_b32 s50, s50, 10
    s_add_u32 s50, s50, s61
    buffer_load_dwordx4 v[232:235], v11, s[32:35], s50 offen offset:0
    s_add_u32 s50, s60, 27
    s_and_b32 s50, s50, 31
    s_lshl_b32 s50, s50, 10
    s_add_u32 s50, s50, s61
    buffer_load_dwordx4 v[236:239], v11, s[32:35], s50 offen offset:0
    s_add_u32 s50, s60, 28
    s_and_b32 s50, s50, 31
    s_lshl_b32 s50, s50, 10
    s_add_u32 s50, s50, s61
    buffer_load_dwordx4 v[240:243], v11, s[32:35], s50 offen offset:0
    s_add_u32 s50, s60, 29
    s_and_b32 s50, s50, 31
    s_lshl_b32 s50, s50, 10
    s_add_u32 s50, s50, s61
    buffer_load_dwordx4 v[244:247], v11, s[32:35], s50 offen offset:0
    s_add_u32 s50, s60, 30
    s_and_b32 s50, s50, 31
    s_lshl_b32 s50, s50, 10
    s_add_u32 s50, s50, s61
    buffer_load_dwordx4 v[248:251], v11, s[32:35], s50 offen offset:0
    s_add_u32 s50, s60, 31
    s_and_b32 s50, s50, 31
    s_lshl_b32 s50, s50, 10
    s_add_u32 s50, s50, s61
    buffer_load_dwordx4 v[252:255], v11, s[32:35], s50 offen offset:0
    v_and_b32 v7, 1, v5
    v_lshrrev_b32 v8, 2, v4
    v_and_b32 v9, 2, v8
    v_add_u32 v9, v9, v7
    v_lshl_add_u32 v8, v3, 3, v8
    v_lshlrev_b32 v8, 7, v8
    v_lshl_add_u32 v8, v7, 13, v8
    v_and_b32 v7, 3, v4
    v_lshl_add_u32 v8, v7, 3, v8
    v_lshl_add_u32 v8, v9, 5, v8
    v_xor_b32 v12, 0, v8
    v_add_u32 v16, 0x10000, v12
    v_add_u32 v20, 0x20000, v12
    v_xor_b32 v13, 32, v8
    v_add_u32 v17, 0x10000, v13
    v_add_u32 v21, 0x20000, v13
    v_xor_b32 v14, 64, v8
    v_add_u32 v18, 0x10000, v14
    v_add_u32 v22, 0x20000, v14
    v_xor_b32 v15, 96, v8
    v_add_u32 v19, 0x10000, v15
    v_add_u32 v23, 0x20000, v15
    v_lshlrev_b32 v9, 6, v2
    v_lshlrev_b32 v118, 3, v2
    v_lshl_add_u32 v118, v3, 14, v118
    v_accvgpr_write_b32 a128, 0
    v_accvgpr_write_b32 a129, 0
    s_lshl_b32 s52, s48, 8
    s_add_u32 s52, s52, 655360
    s_lshl_b32 s53, s37, 11
    s_add_u32 s53, s53, 524288
    s_lshl_b32 s58, s57, 5
    s_xor_b32 s59, s58, 32
    s_add_u32 s55, s53, s59
    s_add_u32 s53, s53, s58
    s_mul_i32 s54, s48, 114688
    s_lshl_b32 s51, s37, 13
    s_add_u32 s54, s54, s51
    s_add_u32 s54, s54, 16777216
    s_lshl_b32 s58, s57, 12
    s_xor_b32 s59, s58, 4096
    s_add_u32 s62, s54, s59
    s_add_u32 s54, s54, s58
    s_mov_b32 s16, s12
    s_mov_b32 s17, s13
    s_mov_b32 s18, 401408
    s_mov_b32 s19, 0x00020000
    s_mov_b32 s28, s42
    s_mov_b32 s29, s43
    s_mov_b32 s30, 1835008
    s_mov_b32 s31, 0x00020000
    s_mov_b32 s24, s6
    s_mov_b32 s25, s7
    s_mov_b32 s26, 1835008
    s_mov_b32 s27, 0x00020000
    s_and_b32 s64, s37, 1
    s_lshl_b32 s65, s36, 1
    s_add_u32 s64, s64, s65
    s_lshr_b32 s65, s37, 1
    v_lshrrev_b32 v7, 3, v1
    v_and_b32 v8, 7, v1
    v_lshrrev_b32 v27, 1, v7
    v_and_b32 v27, 1, v27
    v_lshlrev_b32 v27, 2, v27
    v_xor_b32 v27, v8, v27
    v_mul_u32_u24 v32, 896, v7
    v_lshl_add_u32 v27, v27, 4, v32
    v_lshl_add_u32 v32, v8, 4, v32
    v_lshrrev_b32 v26, 1, v8
    v_lshlrev_b32 v26, 10, v26
    v_and_b32 v31, 1, v8
    v_lshl_add_u32 v26, v31, 9, v26
    v_lshl_add_u32 v26, v7, 4, v26
    s_mul_i32 s63, s64, 57344
    s_lshl_b32 s66, s65, 12
    s_add_u32 s63, s63, s66
    s_lshr_b32 s66, s38, 1
    s_mul_i32 s66, s66, 28672
    s_add_u32 s63, s63, s66
    s_and_b32 s66, s38, 1
    s_lshl_b32 s66, s66, 8
    s_add_u32 s63, s63, s66
    s_add_u32 s63, s63, 8388608
    s_lshl_b32 s66, s38, 4
    v_add_u32 v31, s66, v7
    v_mul_u32_u24 v31, 272, v31
    v_lshl_add_u32 v31, v8, 5, v31
    v_add_u32 v33, 49152, v31
    s_lshl_b32 s76, s64, 6
    s_add_u32 s76, s76, s66
    s_mul_i32 s76, s76, 896
    s_lshl_b32 s66, s65, 7
    s_add_u32 s76, s76, s66
    s_mul_i32 s78, s38, 24576
    s_lshl_b32 s79, s38, 14
    s_add_u32 s79, s79, 98304
    v_lshrrev_b32 v7, 2, v4
    v_lshl_add_u32 v8, v3, 2, v7
    v_lshrrev_b32 v7, 1, v7
    v_lshlrev_b32 v7, 3, v7
    v_and_b32 v30, 1, v5
    v_lshl_add_u32 v7, v30, 2, v7
    v_and_b32 v30, 3, v4
    v_add_u32 v7, v7, v30
    v_lshlrev_b32 v7, 3, v7
    v_lshl_add_u32 v7, v8, 7, v7
    v_add_u32 v28, s78, v7
    v_xor_b32 v29, 64, v28
    v_add_u32 v24, s79, v7
    v_xor_b32 v25, 64, v24
    v_mul_u32_u24 v30, 272, v2
    v_lshl_add_u32 v30, v3, 4, v30
    v_add_u32 v30, s78, v30
    s_mov_b32 s44, 0
    s_mov_b32 s45, -1
    v_lshrrev_b32 v7, 2, v4
    v_mul_u32_u24 v7, 1056, v7
    v_and_b32 v8, 1, v4
    v_mul_u32_u24 v8, 528, v8
    v_add_u32 v7, v7, v8
    v_lshrrev_b32 v8, 1, v4
    v_and_b32 v8, 1, v8
    v_lshl_add_u32 v7, v8, 3, v7
    v_lshl_add_u32 v7, v5, 4, v7
    s_mul_i32 s50, s38, 16896
    v_add_u32 v34, s50, v7
    s_lshl_b32 s66, s64, 1
    s_add_u32 s66, s66, s39
    s_lshl_b32 s66, s66, 4
    s_lshl_b32 s50, s40, 3
    s_add_u32 s66, s66, s50
    s_lshl_b32 s66, s66, 12
    s_add_u32 s66, s66, 1048576
    s_mul_i32 s67, s38, 100352
    s_lshl_b32 s50, s65, 7
    s_add_u32 s67, s67, s50
    s_mul_i32 s77, s38, 14336
    s_add_u32 m0, s77, 102400
    s_add_u32 s50, s67, 0
    buffer_load_dwordx4 v27, s[16:19], s50 offen lds
    s_add_u32 m0, s77, 103424
    s_add_u32 s50, s67, 7168
    buffer_load_dwordx4 v27, s[16:19], s50 offen lds
    s_add_u32 m0, s77, 104448
    s_add_u32 s50, s67, 14336
    buffer_load_dwordx4 v27, s[16:19], s50 offen lds
    s_add_u32 m0, s77, 105472
    s_add_u32 s50, s67, 21504
    buffer_load_dwordx4 v27, s[16:19], s50 offen lds
    s_add_u32 m0, s77, 106496
    s_add_u32 s50, s67, 28672
    buffer_load_dwordx4 v27, s[16:19], s50 offen lds
    s_add_u32 m0, s77, 107520
    s_add_u32 s50, s67, 35840
    buffer_load_dwordx4 v27, s[16:19], s50 offen lds
    s_add_u32 m0, s77, 108544
    s_add_u32 s50, s67, 43008
    buffer_load_dwordx4 v27, s[16:19], s50 offen lds
    s_add_u32 m0, s77, 109568
    s_add_u32 s50, s67, 50176
    buffer_load_dwordx4 v27, s[16:19], s50 offen lds
    s_waitcnt vmcnt(39)
    v_cvt_pk_bf16_f32 v128, v128, v129
    v_cvt_pk_bf16_f32 v129, v130, v131
    s_add_u32 s50, s60, 0
    s_bfe_u32 s51, s50, 0x20003
    s_mul_i32 s51, s51, 4224
    s_and_b32 s50, s50, 7
    s_lshl_b32 s50, s50, 6
    s_add_u32 s50, s50, s51
    v_add_u32 v35, s50, v34
    ds_write_b64 v35, v[128:129] offset:0
    s_waitcnt vmcnt(38)
    v_cvt_pk_bf16_f32 v132, v132, v133
    v_cvt_pk_bf16_f32 v133, v134, v135
    s_add_u32 s50, s60, 1
    s_bfe_u32 s51, s50, 0x20003
    s_mul_i32 s51, s51, 4224
    s_and_b32 s50, s50, 7
    s_lshl_b32 s50, s50, 6
    s_add_u32 s50, s50, s51
    v_add_u32 v35, s50, v34
    ds_write_b64 v35, v[132:133] offset:0
    s_waitcnt vmcnt(37)
    v_cvt_pk_bf16_f32 v136, v136, v137
    v_cvt_pk_bf16_f32 v137, v138, v139
    s_add_u32 s50, s60, 2
    s_bfe_u32 s51, s50, 0x20003
    s_mul_i32 s51, s51, 4224
    s_and_b32 s50, s50, 7
    s_lshl_b32 s50, s50, 6
    s_add_u32 s50, s50, s51
    v_add_u32 v35, s50, v34
    ds_write_b64 v35, v[136:137] offset:0
    s_waitcnt vmcnt(36)
    v_cvt_pk_bf16_f32 v140, v140, v141
    v_cvt_pk_bf16_f32 v141, v142, v143
    s_add_u32 s50, s60, 3
    s_bfe_u32 s51, s50, 0x20003
    s_mul_i32 s51, s51, 4224
    s_and_b32 s50, s50, 7
    s_lshl_b32 s50, s50, 6
    s_add_u32 s50, s50, s51
    v_add_u32 v35, s50, v34
    ds_write_b64 v35, v[140:141] offset:0
    s_waitcnt vmcnt(35)
    v_cvt_pk_bf16_f32 v144, v144, v145
    v_cvt_pk_bf16_f32 v145, v146, v147
    s_add_u32 s50, s60, 4
    s_bfe_u32 s51, s50, 0x20003
    s_mul_i32 s51, s51, 4224
    s_and_b32 s50, s50, 7
    s_lshl_b32 s50, s50, 6
    s_add_u32 s50, s50, s51
    v_add_u32 v35, s50, v34
    ds_write_b64 v35, v[144:145] offset:0
    s_waitcnt vmcnt(34)
    v_cvt_pk_bf16_f32 v148, v148, v149
    v_cvt_pk_bf16_f32 v149, v150, v151
    s_add_u32 s50, s60, 5
    s_bfe_u32 s51, s50, 0x20003
    s_mul_i32 s51, s51, 4224
    s_and_b32 s50, s50, 7
    s_lshl_b32 s50, s50, 6
    s_add_u32 s50, s50, s51
    v_add_u32 v35, s50, v34
    ds_write_b64 v35, v[148:149] offset:0
    s_waitcnt vmcnt(33)
    v_cvt_pk_bf16_f32 v152, v152, v153
    v_cvt_pk_bf16_f32 v153, v154, v155
    s_add_u32 s50, s60, 6
    s_bfe_u32 s51, s50, 0x20003
    s_mul_i32 s51, s51, 4224
    s_and_b32 s50, s50, 7
    s_lshl_b32 s50, s50, 6
    s_add_u32 s50, s50, s51
    v_add_u32 v35, s50, v34
    ds_write_b64 v35, v[152:153] offset:0
    s_waitcnt vmcnt(32)
    v_cvt_pk_bf16_f32 v156, v156, v157
    v_cvt_pk_bf16_f32 v157, v158, v159
    s_add_u32 s50, s60, 7
    s_bfe_u32 s51, s50, 0x20003
    s_mul_i32 s51, s51, 4224
    s_and_b32 s50, s50, 7
    s_lshl_b32 s50, s50, 6
    s_add_u32 s50, s50, s51
    v_add_u32 v35, s50, v34
    ds_write_b64 v35, v[156:157] offset:0
    s_add_u32 m0, s77, 110592
    s_add_u32 s50, s67, 57344
    buffer_load_dwordx4 v27, s[16:19], s50 offen lds
    s_waitcnt vmcnt(32)
    v_cvt_pk_bf16_f32 v160, v160, v161
    v_cvt_pk_bf16_f32 v161, v162, v163
    s_add_u32 s50, s60, 8
    s_bfe_u32 s51, s50, 0x20003
    s_mul_i32 s51, s51, 4224
    s_and_b32 s50, s50, 7
    s_lshl_b32 s50, s50, 6
    s_add_u32 s50, s50, s51
    v_add_u32 v35, s50, v34
    ds_write_b64 v35, v[160:161] offset:0
    s_add_u32 m0, s77, 111616
    s_add_u32 s50, s67, 64512
    buffer_load_dwordx4 v27, s[16:19], s50 offen lds
    s_waitcnt vmcnt(32)
    v_cvt_pk_bf16_f32 v164, v164, v165
    v_cvt_pk_bf16_f32 v165, v166, v167
    s_add_u32 s50, s60, 9
    s_bfe_u32 s51, s50, 0x20003
    s_mul_i32 s51, s51, 4224
    s_and_b32 s50, s50, 7
    s_lshl_b32 s50, s50, 6
    s_add_u32 s50, s50, s51
    v_add_u32 v35, s50, v34
    ds_write_b64 v35, v[164:165] offset:0
    s_add_u32 m0, s77, 112640
    s_add_u32 s50, s67, 71680
    buffer_load_dwordx4 v27, s[16:19], s50 offen lds
    s_waitcnt vmcnt(32)
    v_cvt_pk_bf16_f32 v168, v168, v169
    v_cvt_pk_bf16_f32 v169, v170, v171
    s_add_u32 s50, s60, 10
    s_bfe_u32 s51, s50, 0x20003
    s_mul_i32 s51, s51, 4224
    s_and_b32 s50, s50, 7
    s_lshl_b32 s50, s50, 6
    s_add_u32 s50, s50, s51
    v_add_u32 v35, s50, v34
    ds_write_b64 v35, v[168:169] offset:0
    s_add_u32 m0, s77, 113664
    s_add_u32 s50, s67, 78848
    buffer_load_dwordx4 v27, s[16:19], s50 offen lds
    s_waitcnt vmcnt(32)
    v_cvt_pk_bf16_f32 v172, v172, v173
    v_cvt_pk_bf16_f32 v173, v174, v175
    s_add_u32 s50, s60, 11
    s_bfe_u32 s51, s50, 0x20003
    s_mul_i32 s51, s51, 4224
    s_and_b32 s50, s50, 7
    s_lshl_b32 s50, s50, 6
    s_add_u32 s50, s50, s51
    v_add_u32 v35, s50, v34
    ds_write_b64 v35, v[172:173] offset:0
    s_add_u32 m0, s77, 114688
    s_add_u32 s50, s67, 86016
    buffer_load_dwordx4 v27, s[16:19], s50 offen lds
    s_waitcnt vmcnt(32)
    v_cvt_pk_bf16_f32 v176, v176, v177
    v_cvt_pk_bf16_f32 v177, v178, v179
    s_add_u32 s50, s60, 12
    s_bfe_u32 s51, s50, 0x20003
    s_mul_i32 s51, s51, 4224
    s_and_b32 s50, s50, 7
    s_lshl_b32 s50, s50, 6
    s_add_u32 s50, s50, s51
    v_add_u32 v35, s50, v34
    ds_write_b64 v35, v[176:177] offset:0
    s_add_u32 m0, s77, 115712
    s_add_u32 s50, s67, 93184
    buffer_load_dwordx4 v27, s[16:19], s50 offen lds
    s_waitcnt vmcnt(32)
    v_cvt_pk_bf16_f32 v180, v180, v181
    v_cvt_pk_bf16_f32 v181, v182, v183
    s_add_u32 s50, s60, 13
    s_bfe_u32 s51, s50, 0x20003
    s_mul_i32 s51, s51, 4224
    s_and_b32 s50, s50, 7
    s_lshl_b32 s50, s50, 6
    s_add_u32 s50, s50, s51
    v_add_u32 v35, s50, v34
    ds_write_b64 v35, v[180:181] offset:0
    s_mov_b32 m0, 159744
    s_mov_b32 s50, 401408
    buffer_load_dwordx4 v27, s[16:19], s50 offen lds
    s_waitcnt vmcnt(32)
    v_cvt_pk_bf16_f32 v184, v184, v185
    v_cvt_pk_bf16_f32 v185, v186, v187
    s_add_u32 s50, s60, 14
    s_bfe_u32 s51, s50, 0x20003
    s_mul_i32 s51, s51, 4224
    s_and_b32 s50, s50, 7
    s_lshl_b32 s50, s50, 6
    s_add_u32 s50, s50, s51
    v_add_u32 v35, s50, v34
    ds_write_b64 v35, v[184:185] offset:0
    s_add_u32 s50, s66, 0
    buffer_load_dwordx4 a[0:3], v11, s[32:35], s50 offen
    s_waitcnt vmcnt(32)
    v_cvt_pk_bf16_f32 v188, v188, v189
    v_cvt_pk_bf16_f32 v189, v190, v191
    s_add_u32 s50, s60, 15
    s_bfe_u32 s51, s50, 0x20003
    s_mul_i32 s51, s51, 4224
    s_and_b32 s50, s50, 7
    s_lshl_b32 s50, s50, 6
    s_add_u32 s50, s50, s51
    v_add_u32 v35, s50, v34
    ds_write_b64 v35, v[188:189] offset:0
    s_add_u32 s50, s66, 1024
    buffer_load_dwordx4 a[4:7], v11, s[32:35], s50 offen
    s_waitcnt vmcnt(32)
    v_cvt_pk_bf16_f32 v192, v192, v193
    v_cvt_pk_bf16_f32 v193, v194, v195
    s_add_u32 s50, s60, 16
    s_bfe_u32 s51, s50, 0x20003
    s_mul_i32 s51, s51, 4224
    s_and_b32 s50, s50, 7
    s_lshl_b32 s50, s50, 6
    s_add_u32 s50, s50, s51
    v_add_u32 v35, s50, v34
    ds_write_b64 v35, v[192:193] offset:0
    s_add_u32 s50, s66, 2048
    buffer_load_dwordx4 a[8:11], v11, s[32:35], s50 offen
    s_waitcnt vmcnt(32)
    v_cvt_pk_bf16_f32 v196, v196, v197
    v_cvt_pk_bf16_f32 v197, v198, v199
    s_add_u32 s50, s60, 17
    s_bfe_u32 s51, s50, 0x20003
    s_mul_i32 s51, s51, 4224
    s_and_b32 s50, s50, 7
    s_lshl_b32 s50, s50, 6
    s_add_u32 s50, s50, s51
    v_add_u32 v35, s50, v34
    ds_write_b64 v35, v[196:197] offset:0
    s_add_u32 s50, s66, 3072
    buffer_load_dwordx4 a[12:15], v11, s[32:35], s50 offen
    s_waitcnt vmcnt(32)
    v_cvt_pk_bf16_f32 v200, v200, v201
    v_cvt_pk_bf16_f32 v201, v202, v203
    s_add_u32 s50, s60, 18
    s_bfe_u32 s51, s50, 0x20003
    s_mul_i32 s51, s51, 4224
    s_and_b32 s50, s50, 7
    s_lshl_b32 s50, s50, 6
    s_add_u32 s50, s50, s51
    v_add_u32 v35, s50, v34
    ds_write_b64 v35, v[200:201] offset:0
    s_add_u32 s50, s66, 4096
    buffer_load_dwordx4 a[16:19], v11, s[32:35], s50 offen
    s_waitcnt vmcnt(32)
    v_cvt_pk_bf16_f32 v204, v204, v205
    v_cvt_pk_bf16_f32 v205, v206, v207
    s_add_u32 s50, s60, 19
    s_bfe_u32 s51, s50, 0x20003
    s_mul_i32 s51, s51, 4224
    s_and_b32 s50, s50, 7
    s_lshl_b32 s50, s50, 6
    s_add_u32 s50, s50, s51
    v_add_u32 v35, s50, v34
    ds_write_b64 v35, v[204:205] offset:0
    s_add_u32 s50, s66, 5120
    buffer_load_dwordx4 a[20:23], v11, s[32:35], s50 offen
    s_waitcnt vmcnt(32)
    v_cvt_pk_bf16_f32 v208, v208, v209
    v_cvt_pk_bf16_f32 v209, v210, v211
    s_add_u32 s50, s60, 20
    s_bfe_u32 s51, s50, 0x20003
    s_mul_i32 s51, s51, 4224
    s_and_b32 s50, s50, 7
    s_lshl_b32 s50, s50, 6
    s_add_u32 s50, s50, s51
    v_add_u32 v35, s50, v34
    ds_write_b64 v35, v[208:209] offset:0
    s_add_u32 s50, s66, 6144
    buffer_load_dwordx4 a[24:27], v11, s[32:35], s50 offen
    s_waitcnt vmcnt(32)
    v_cvt_pk_bf16_f32 v212, v212, v213
    v_cvt_pk_bf16_f32 v213, v214, v215
    s_add_u32 s50, s60, 21
    s_bfe_u32 s51, s50, 0x20003
    s_mul_i32 s51, s51, 4224
    s_and_b32 s50, s50, 7
    s_lshl_b32 s50, s50, 6
    s_add_u32 s50, s50, s51
    v_add_u32 v35, s50, v34
    ds_write_b64 v35, v[212:213] offset:0
    s_add_u32 s50, s66, 7168
    buffer_load_dwordx4 a[28:31], v11, s[32:35], s50 offen
    s_waitcnt vmcnt(32)
    v_cvt_pk_bf16_f32 v216, v216, v217
    v_cvt_pk_bf16_f32 v217, v218, v219
    s_add_u32 s50, s60, 22
    s_bfe_u32 s51, s50, 0x20003
    s_mul_i32 s51, s51, 4224
    s_and_b32 s50, s50, 7
    s_lshl_b32 s50, s50, 6
    s_add_u32 s50, s50, s51
    v_add_u32 v35, s50, v34
    ds_write_b64 v35, v[216:217] offset:0
    s_add_u32 s50, s66, 8192
    buffer_load_dwordx4 a[32:35], v11, s[32:35], s50 offen
    s_waitcnt vmcnt(32)
    v_cvt_pk_bf16_f32 v220, v220, v221
    v_cvt_pk_bf16_f32 v221, v222, v223
    s_add_u32 s50, s60, 23
    s_bfe_u32 s51, s50, 0x20003
    s_mul_i32 s51, s51, 4224
    s_and_b32 s50, s50, 7
    s_lshl_b32 s50, s50, 6
    s_add_u32 s50, s50, s51
    v_add_u32 v35, s50, v34
    ds_write_b64 v35, v[220:221] offset:0
    s_add_u32 s50, s66, 9216
    buffer_load_dwordx4 a[36:39], v11, s[32:35], s50 offen
    s_waitcnt vmcnt(32)
    v_cvt_pk_bf16_f32 v224, v224, v225
    v_cvt_pk_bf16_f32 v225, v226, v227
    s_add_u32 s50, s60, 24
    s_bfe_u32 s51, s50, 0x20003
    s_mul_i32 s51, s51, 4224
    s_and_b32 s50, s50, 7
    s_lshl_b32 s50, s50, 6
    s_add_u32 s50, s50, s51
    v_add_u32 v35, s50, v34
    ds_write_b64 v35, v[224:225] offset:0
    s_add_u32 s50, s66, 10240
    buffer_load_dwordx4 a[40:43], v11, s[32:35], s50 offen
    s_waitcnt vmcnt(32)
    v_cvt_pk_bf16_f32 v228, v228, v229
    v_cvt_pk_bf16_f32 v229, v230, v231
    s_add_u32 s50, s60, 25
    s_bfe_u32 s51, s50, 0x20003
    s_mul_i32 s51, s51, 4224
    s_and_b32 s50, s50, 7
    s_lshl_b32 s50, s50, 6
    s_add_u32 s50, s50, s51
    v_add_u32 v35, s50, v34
    ds_write_b64 v35, v[228:229] offset:0
    s_add_u32 s50, s66, 11264
    buffer_load_dwordx4 a[44:47], v11, s[32:35], s50 offen
    s_waitcnt vmcnt(32)
    v_cvt_pk_bf16_f32 v232, v232, v233
    v_cvt_pk_bf16_f32 v233, v234, v235
    s_add_u32 s50, s60, 26
    s_bfe_u32 s51, s50, 0x20003
    s_mul_i32 s51, s51, 4224
    s_and_b32 s50, s50, 7
    s_lshl_b32 s50, s50, 6
    s_add_u32 s50, s50, s51
    v_add_u32 v35, s50, v34
    ds_write_b64 v35, v[232:233] offset:0
    s_add_u32 s50, s66, 12288
    buffer_load_dwordx4 a[48:51], v11, s[32:35], s50 offen
    s_waitcnt vmcnt(32)
    v_cvt_pk_bf16_f32 v236, v236, v237
    v_cvt_pk_bf16_f32 v237, v238, v239
    s_add_u32 s50, s60, 27
    s_bfe_u32 s51, s50, 0x20003
    s_mul_i32 s51, s51, 4224
    s_and_b32 s50, s50, 7
    s_lshl_b32 s50, s50, 6
    s_add_u32 s50, s50, s51
    v_add_u32 v35, s50, v34
    ds_write_b64 v35, v[236:237] offset:0
    s_add_u32 s50, s66, 13312
    buffer_load_dwordx4 a[52:55], v11, s[32:35], s50 offen
    s_waitcnt vmcnt(32)
    v_cvt_pk_bf16_f32 v240, v240, v241
    v_cvt_pk_bf16_f32 v241, v242, v243
    s_add_u32 s50, s60, 28
    s_bfe_u32 s51, s50, 0x20003
    s_mul_i32 s51, s51, 4224
    s_and_b32 s50, s50, 7
    s_lshl_b32 s50, s50, 6
    s_add_u32 s50, s50, s51
    v_add_u32 v35, s50, v34
    ds_write_b64 v35, v[240:241] offset:0
    s_add_u32 s50, s66, 14336
    buffer_load_dwordx4 a[56:59], v11, s[32:35], s50 offen
    s_waitcnt vmcnt(32)
    v_cvt_pk_bf16_f32 v244, v244, v245
    v_cvt_pk_bf16_f32 v245, v246, v247
    s_add_u32 s50, s60, 29
    s_bfe_u32 s51, s50, 0x20003
    s_mul_i32 s51, s51, 4224
    s_and_b32 s50, s50, 7
    s_lshl_b32 s50, s50, 6
    s_add_u32 s50, s50, s51
    v_add_u32 v35, s50, v34
    ds_write_b64 v35, v[244:245] offset:0
    s_add_u32 s50, s66, 15360
    buffer_load_dwordx4 a[60:63], v11, s[32:35], s50 offen
    s_waitcnt vmcnt(32)
    v_cvt_pk_bf16_f32 v248, v248, v249
    v_cvt_pk_bf16_f32 v249, v250, v251
    s_add_u32 s50, s60, 30
    s_bfe_u32 s51, s50, 0x20003
    s_mul_i32 s51, s51, 4224
    s_and_b32 s50, s50, 7
    s_lshl_b32 s50, s50, 6
    s_add_u32 s50, s50, s51
    v_add_u32 v35, s50, v34
    ds_write_b64 v35, v[248:249] offset:0
    s_add_u32 s50, s66, 16384
    buffer_load_dwordx4 a[64:67], v11, s[32:35], s50 offen
    s_waitcnt vmcnt(32)
    v_cvt_pk_bf16_f32 v252, v252, v253
    v_cvt_pk_bf16_f32 v253, v254, v255
    s_add_u32 s50, s60, 31
    s_bfe_u32 s51, s50, 0x20003
    s_mul_i32 s51, s51, 4224
    s_and_b32 s50, s50, 7
    s_lshl_b32 s50, s50, 6
    s_add_u32 s50, s50, s51
    v_add_u32 v35, s50, v34
    ds_write_b64 v35, v[252:253] offset:0
    s_mul_i32 s50, s40, 33792
    v_mul_u32_u24 v7, 528, v3
    v_lshl_add_u32 v7, v2, 4, v7
    v_add_u32 v100, s50, v7
    s_mul_i32 s50, s40, 28672
    s_add_u32 s50, s50, 102400
    s_sub_u32 s50, s50, s78
    v_add_u32 v101, s50, v28
    v_xor_b32 v102, 64, v101
    s_lshl_b32 s50, s39, 5
    v_add_u32 v7, s50, v2
    v_mul_u32_u24 v7, 272, v7
    v_lshl_add_u32 v7, v3, 4, v7
    s_mul_i32 s50, s40, 17408
    s_add_u32 s50, s50, 65536
    v_add_u32 v103, s50, v7
    v_add_u32 v104, 65536, v31
    v_lshrrev_b32 v35, 3, v1
    v_lshlrev_b32 v35, 3, v35
    s_waitcnt vmcnt(17)
    s_waitcnt lgkmcnt(0)
    s_barrier
    ds_read_b128 v[128:131], v100 offset:0
    ds_read_b128 v[132:135], v100 offset:1056
    ds_read_b128 v[136:139], v100 offset:2112
    ds_read_b128 v[140:143], v100 offset:3168
    ds_read_b128 v[144:147], v100 offset:4224
    ds_read_b128 v[148:151], v100 offset:5280
    ds_read_b128 v[152:155], v100 offset:6336
    ds_read_b128 v[156:159], v100 offset:7392
    ds_read_b128 v[160:163], v100 offset:8448
    ds_read_b128 v[164:167], v100 offset:9504
    ds_read_b128 v[168:171], v100 offset:10560
    ds_read_b128 v[172:175], v100 offset:11616
    ds_read_b128 v[176:179], v100 offset:12672
    ds_read_b128 v[180:183], v100 offset:13728
    ds_read_b128 v[184:187], v100 offset:14784
    ds_read_b128 v[188:191], v100 offset:15840
    ds_read_b128 v[192:195], v100 offset:16896
    ds_read_b128 v[196:199], v100 offset:17952
    ds_read_b128 v[200:203], v100 offset:19008
    ds_read_b128 v[204:207], v100 offset:20064
    ds_read_b128 v[208:211], v100 offset:21120
    ds_read_b128 v[212:215], v100 offset:22176
    ds_read_b128 v[216:219], v100 offset:23232
    ds_read_b128 v[220:223], v100 offset:24288
    ds_read_b128 v[224:227], v100 offset:25344
    ds_read_b128 v[228:231], v100 offset:26400
    ds_read_b128 v[232:235], v100 offset:27456
    ds_read_b128 v[236:239], v100 offset:28512
    ds_read_b128 v[240:243], v100 offset:29568
    ds_read_b128 v[244:247], v100 offset:30624
    ds_read_b128 v[248:251], v100 offset:31680
    ds_read_b128 v[252:255], v100 offset:32736
    s_add_u32 s50, s66, 17408
    buffer_load_dwordx4 a[68:71], v11, s[32:35], s50 offen
    s_add_u32 s50, s66, 18432
    buffer_load_dwordx4 a[72:75], v11, s[32:35], s50 offen
    s_add_u32 s50, s66, 19456
    buffer_load_dwordx4 a[76:79], v11, s[32:35], s50 offen
    s_add_u32 s50, s66, 20480
    buffer_load_dwordx4 a[80:83], v11, s[32:35], s50 offen
    s_waitcnt lgkmcnt(0)
    s_barrier
    s_waitcnt vmcnt(17)
    v_mfma_f32_32x32x16_bf16 v[36:51], v[128:131], a[0:3], 0
    v_mfma_f32_32x32x16_bf16 v[36:51], v[132:135], a[4:7], v[36:51]
    v_mfma_f32_32x32x16_bf16 v[36:51], v[136:139], a[8:11], v[36:51]
    v_mfma_f32_32x32x16_bf16 v[36:51], v[140:143], a[12:15], v[36:51]
    ds_read_b64_tr_b16 v[68:69], v101 offset:0
    ds_read_b64_tr_b16 v[70:71], v101 offset:1024
    ds_read_b64_tr_b16 v[72:73], v102 offset:0
    ds_read_b64_tr_b16 v[74:75], v102 offset:1024
    ds_read_b64_tr_b16 v[76:77], v101 offset:2048
    ds_read_b64_tr_b16 v[78:79], v101 offset:3072
    ds_read_b64_tr_b16 v[80:81], v102 offset:2048
    ds_read_b64_tr_b16 v[82:83], v102 offset:3072
    s_add_u32 s50, s66, 21504
    buffer_load_dwordx4 a[84:87], v11, s[32:35], s50 offen
    s_add_u32 s50, s66, 22528
    buffer_load_dwordx4 a[88:91], v11, s[32:35], s50 offen
    s_add_u32 s50, s66, 23552
    buffer_load_dwordx4 a[92:95], v11, s[32:35], s50 offen
    s_waitcnt vmcnt(16)
    v_mfma_f32_32x32x16_bf16 v[52:67], v[144:147], a[16:19], 0
    v_mov_b32 v105, v48
    v_mov_b32 v106, v48
    s_nop 1
    v_permlane32_swap_b32 v105, v106
    v_cvt_pk_bf16_f32 v106, v106, v106
    v_and_b32 v106, 0xffff0000, v106
    v_add_f32 v106, 0x358637bd, v106
    v_cvt_pk_bf16_f32 v106, v106, v106
    v_and_b32 v106, 0xffff0000, v106
    v_rcp_f32 v106, v106
    v_mfma_f32_32x32x16_bf16 v[52:67], v[148:151], a[20:23], v[52:67]
    v_mul_f32 v36, v36, v106
    v_mul_f32 v37, v37, v106
    v_cvt_pk_bf16_f32 v128, v36, v37
    v_mul_f32 v38, v38, v106
    v_mul_f32 v39, v39, v106
    v_cvt_pk_bf16_f32 v129, v38, v39
    v_mul_f32 v40, v40, v106
    v_mul_f32 v41, v41, v106
    v_cvt_pk_bf16_f32 v130, v40, v41
    v_mfma_f32_32x32x16_bf16 v[52:67], v[152:155], a[24:27], v[52:67]
    v_mul_f32 v42, v42, v106
    v_mul_f32 v43, v43, v106
    v_cvt_pk_bf16_f32 v131, v42, v43
    v_mul_f32 v44, v44, v106
    v_mul_f32 v45, v45, v106
    v_cvt_pk_bf16_f32 v132, v44, v45
    v_mul_f32 v46, v46, v106
    v_mul_f32 v47, v47, v106
    v_cvt_pk_bf16_f32 v133, v46, v47
    v_mfma_f32_32x32x16_bf16 v[52:67], v[156:159], a[28:31], v[52:67]
    v_mul_f32 v48, v48, v106
    v_mul_f32 v49, v49, v106
    v_cvt_pk_bf16_f32 v134, v48, v49
    v_mul_f32 v50, v50, v106
    v_mul_f32 v51, v51, v106
    v_cvt_pk_bf16_f32 v135, v50, v51
    v_cndmask_b32 v134, v134, 0, s[44:45]
    v_cndmask_b32 v135, v135, 0, s[44:45]
    ds_read_b64_tr_b16 v[84:85], v101 offset:3584
    ds_read_b64_tr_b16 v[86:87], v101 offset:4608
    ds_read_b64_tr_b16 v[88:89], v102 offset:3584
    ds_read_b64_tr_b16 v[90:91], v102 offset:4608
    ds_read_b64_tr_b16 v[92:93], v101 offset:5632
    ds_read_b64_tr_b16 v[94:95], v101 offset:6656
    ds_read_b64_tr_b16 v[96:97], v102 offset:5632
    ds_read_b64_tr_b16 v[98:99], v102 offset:6656
    s_add_u32 s50, s66, 24576
    buffer_load_dwordx4 a[96:99], v11, s[32:35], s50 offen
    s_add_u32 s50, s66, 25600
    buffer_load_dwordx4 a[100:103], v11, s[32:35], s50 offen
    s_add_u32 s50, s66, 26624
    buffer_load_dwordx4 a[104:107], v11, s[32:35], s50 offen
    s_waitcnt lgkmcnt(8)
    s_waitcnt vmcnt(15)
    v_mfma_f32_32x32x16_bf16 v[36:51], v[160:163], a[32:35], 0
    v_mov_b32 v105, v64
    v_mov_b32 v106, v64
    s_nop 1
    v_permlane32_swap_b32 v105, v106
    v_cvt_pk_bf16_f32 v106, v106, v106
    v_and_b32 v106, 0xffff0000, v106
    v_mfma_f32_32x32x16_bf16 v[36:51], v[164:167], a[36:39], v[36:51]
    v_add_f32 v106, 0x358637bd, v106
    v_cvt_pk_bf16_f32 v106, v106, v106
    v_and_b32 v106, 0xffff0000, v106
    v_rcp_f32 v106, v106
    s_nop 0
    v_mul_f32 v52, v52, v106
    v_mfma_f32_32x32x16_bf16 a[130:145], v[68:71], v[128:131], 0
    v_mul_f32 v53, v53, v106
    v_cvt_pk_bf16_f32 v144, v52, v53
    v_mul_f32 v54, v54, v106
    v_mul_f32 v55, v55, v106
    v_cvt_pk_bf16_f32 v145, v54, v55
    v_mfma_f32_32x32x16_bf16 a[146:161], v[72:75], v[128:131], 0
    v_mul_f32 v56, v56, v106
    v_mul_f32 v57, v57, v106
    v_cvt_pk_bf16_f32 v146, v56, v57
    v_mul_f32 v58, v58, v106
    v_mul_f32 v59, v59, v106
    v_mfma_f32_32x32x16_bf16 v[36:51], v[168:171], a[40:43], v[36:51]
    v_cvt_pk_bf16_f32 v147, v58, v59
    v_mul_f32 v60, v60, v106
    v_mul_f32 v61, v61, v106
    v_cvt_pk_bf16_f32 v148, v60, v61
    v_mul_f32 v62, v62, v106
    v_mfma_f32_32x32x16_bf16 v[36:51], v[172:175], a[44:47], v[36:51]
    v_mul_f32 v63, v63, v106
    v_cvt_pk_bf16_f32 v149, v62, v63
    v_mul_f32 v64, v64, v106
    v_mul_f32 v65, v65, v106
    v_cvt_pk_bf16_f32 v150, v64, v65
    v_mfma_f32_32x32x16_bf16 a[130:145], v[76:79], v[132:135], a[130:145]
    v_mul_f32 v66, v66, v106
    v_mul_f32 v67, v67, v106
    v_cvt_pk_bf16_f32 v151, v66, v67
    v_cndmask_b32 v150, v150, 0, s[44:45]
    v_cndmask_b32 v151, v151, 0, s[44:45]
    v_mfma_f32_32x32x16_bf16 a[146:161], v[80:83], v[132:135], a[146:161]
    ds_read_b64_tr_b16 v[68:69], v101 offset:7168
    ds_read_b64_tr_b16 v[70:71], v101 offset:8192
    ds_read_b64_tr_b16 v[72:73], v102 offset:7168
    ds_read_b64_tr_b16 v[74:75], v102 offset:8192
    ds_read_b64_tr_b16 v[76:77], v101 offset:9216
    ds_read_b64_tr_b16 v[78:79], v101 offset:10240
    ds_read_b64_tr_b16 v[80:81], v102 offset:9216
    ds_read_b64_tr_b16 v[82:83], v102 offset:10240
    s_add_u32 s50, s66, 27648
    buffer_load_dwordx4 a[108:111], v11, s[32:35], s50 offen
    s_add_u32 s50, s66, 28672
    buffer_load_dwordx4 a[112:115], v11, s[32:35], s50 offen
    s_add_u32 s50, s66, 29696
    buffer_load_dwordx4 a[116:119], v11, s[32:35], s50 offen
    s_waitcnt lgkmcnt(8)
    s_waitcnt vmcnt(14)
    v_mfma_f32_32x32x16_bf16 v[52:67], v[176:179], a[48:51], 0
    v_mov_b32 v105, v48
    v_mov_b32 v106, v48
    s_nop 1
    v_permlane32_swap_b32 v105, v106
    v_cvt_pk_bf16_f32 v106, v106, v106
    v_and_b32 v106, 0xffff0000, v106
    v_mfma_f32_32x32x16_bf16 v[52:67], v[180:183], a[52:55], v[52:67]
    v_add_f32 v106, 0x358637bd, v106
    v_cvt_pk_bf16_f32 v106, v106, v106
    v_and_b32 v106, 0xffff0000, v106
    v_rcp_f32 v106, v106
    s_nop 0
    v_mul_f32 v36, v36, v106
    v_mfma_f32_32x32x16_bf16 a[130:145], v[84:87], v[144:147], a[130:145]
    v_mul_f32 v37, v37, v106
    v_cvt_pk_bf16_f32 v160, v36, v37
    v_mul_f32 v38, v38, v106
    v_mul_f32 v39, v39, v106
    v_cvt_pk_bf16_f32 v161, v38, v39
    v_mfma_f32_32x32x16_bf16 a[146:161], v[88:91], v[144:147], a[146:161]
    v_mul_f32 v40, v40, v106
    v_mul_f32 v41, v41, v106
    v_cvt_pk_bf16_f32 v162, v40, v41
    v_mul_f32 v42, v42, v106
    v_mul_f32 v43, v43, v106
    v_mfma_f32_32x32x16_bf16 v[52:67], v[184:187], a[56:59], v[52:67]
    v_cvt_pk_bf16_f32 v163, v42, v43
    v_mul_f32 v44, v44, v106
    v_mul_f32 v45, v45, v106
    v_cvt_pk_bf16_f32 v164, v44, v45
    v_mul_f32 v46, v46, v106
    v_mfma_f32_32x32x16_bf16 v[52:67], v[188:191], a[60:63], v[52:67]
    v_mul_f32 v47, v47, v106
    v_cvt_pk_bf16_f32 v165, v46, v47
    v_mul_f32 v48, v48, v106
    v_mul_f32 v49, v49, v106
    v_cvt_pk_bf16_f32 v166, v48, v49
    v_mfma_f32_32x32x16_bf16 a[130:145], v[92:95], v[148:151], a[130:145]
    v_mul_f32 v50, v50, v106
    v_mul_f32 v51, v51, v106
    v_cvt_pk_bf16_f32 v167, v50, v51
    v_cndmask_b32 v166, v166, 0, s[44:45]
    v_cndmask_b32 v167, v167, 0, s[44:45]
    v_mfma_f32_32x32x16_bf16 a[146:161], v[96:99], v[148:151], a[146:161]
    ds_read_b64_tr_b16 v[84:85], v101 offset:10752
    ds_read_b64_tr_b16 v[86:87], v101 offset:11776
    ds_read_b64_tr_b16 v[88:89], v102 offset:10752
    ds_read_b64_tr_b16 v[90:91], v102 offset:11776
    ds_read_b64_tr_b16 v[92:93], v101 offset:12800
    ds_read_b64_tr_b16 v[94:95], v101 offset:13824
    ds_read_b64_tr_b16 v[96:97], v102 offset:12800
    ds_read_b64_tr_b16 v[98:99], v102 offset:13824
    s_add_u32 s50, s66, 30720
    buffer_load_dwordx4 a[120:123], v11, s[32:35], s50 offen
    s_add_u32 s50, s66, 31744
    buffer_load_dwordx4 a[124:127], v11, s[32:35], s50 offen
    buffer_load_dwordx4 v[120:123], v32, s[28:31], s76 offen
    s_waitcnt lgkmcnt(8)
    s_waitcnt vmcnt(13)
    v_mfma_f32_32x32x16_bf16 v[36:51], v[192:195], a[64:67], 0
    v_mov_b32 v105, v64
    v_mov_b32 v106, v64
    s_nop 1
    v_permlane32_swap_b32 v105, v106
    v_cvt_pk_bf16_f32 v106, v106, v106
    v_and_b32 v106, 0xffff0000, v106
    v_mfma_f32_32x32x16_bf16 v[36:51], v[196:199], a[68:71], v[36:51]
    v_add_f32 v106, 0x358637bd, v106
    v_cvt_pk_bf16_f32 v106, v106, v106
    v_and_b32 v106, 0xffff0000, v106
    v_rcp_f32 v106, v106
    s_nop 0
    v_mul_f32 v52, v52, v106
    v_mfma_f32_32x32x16_bf16 a[130:145], v[68:71], v[160:163], a[130:145]
    v_mul_f32 v53, v53, v106
    v_cvt_pk_bf16_f32 v176, v52, v53
    v_mul_f32 v54, v54, v106
    v_mul_f32 v55, v55, v106
    v_cvt_pk_bf16_f32 v177, v54, v55
    v_mfma_f32_32x32x16_bf16 a[146:161], v[72:75], v[160:163], a[146:161]
    v_mul_f32 v56, v56, v106
    v_mul_f32 v57, v57, v106
    v_cvt_pk_bf16_f32 v178, v56, v57
    v_mul_f32 v58, v58, v106
    v_mul_f32 v59, v59, v106
    v_mfma_f32_32x32x16_bf16 v[36:51], v[200:203], a[72:75], v[36:51]
    v_cvt_pk_bf16_f32 v179, v58, v59
    v_mul_f32 v60, v60, v106
    v_mul_f32 v61, v61, v106
    v_cvt_pk_bf16_f32 v180, v60, v61
    v_mul_f32 v62, v62, v106
    v_mfma_f32_32x32x16_bf16 v[36:51], v[204:207], a[76:79], v[36:51]
    v_mul_f32 v63, v63, v106
    v_cvt_pk_bf16_f32 v181, v62, v63
    v_mul_f32 v64, v64, v106
    v_mul_f32 v65, v65, v106
    v_cvt_pk_bf16_f32 v182, v64, v65
    v_mfma_f32_32x32x16_bf16 a[130:145], v[76:79], v[164:167], a[130:145]
    v_mul_f32 v66, v66, v106
    v_mul_f32 v67, v67, v106
    v_cvt_pk_bf16_f32 v183, v66, v67
    v_cndmask_b32 v182, v182, 0, s[44:45]
    v_cndmask_b32 v183, v183, 0, s[44:45]
    v_mfma_f32_32x32x16_bf16 a[146:161], v[80:83], v[164:167], a[146:161]
    ds_read_b64_tr_b16 v[68:69], v101 offset:14336
    ds_read_b64_tr_b16 v[70:71], v101 offset:15360
    ds_read_b64_tr_b16 v[72:73], v102 offset:14336
    ds_read_b64_tr_b16 v[74:75], v102 offset:15360
    ds_read_b64_tr_b16 v[76:77], v101 offset:16384
    ds_read_b64_tr_b16 v[78:79], v101 offset:17408
    ds_read_b64_tr_b16 v[80:81], v102 offset:16384
    ds_read_b64_tr_b16 v[82:83], v102 offset:17408
    s_add_u32 s50, s76, 7168
    buffer_load_dwordx4 v[124:127], v32, s[28:31], s50 offen
    s_add_u32 m0, s47, 0
    s_add_u32 s50, s46, 0
    buffer_load_dwordx4 v10, s[20:23], s50 offen lds
    s_add_u32 m0, s47, 1024
    s_add_u32 s50, s46, 28672
    buffer_load_dwordx4 v10, s[20:23], s50 offen lds
    s_waitcnt lgkmcnt(8)
    s_waitcnt vmcnt(12)
    v_mfma_f32_32x32x16_bf16 v[52:67], v[208:211], a[80:83], 0
    v_mov_b32 v105, v48
    v_mov_b32 v106, v48
    s_nop 1
    v_permlane32_swap_b32 v105, v106
    v_cvt_pk_bf16_f32 v106, v106, v106
    v_and_b32 v106, 0xffff0000, v106
    v_mfma_f32_32x32x16_bf16 v[52:67], v[212:215], a[84:87], v[52:67]
    v_add_f32 v106, 0x358637bd, v106
    v_cvt_pk_bf16_f32 v106, v106, v106
    v_and_b32 v106, 0xffff0000, v106
    v_rcp_f32 v106, v106
    s_nop 0
    v_mul_f32 v36, v36, v106
    v_mfma_f32_32x32x16_bf16 a[130:145], v[84:87], v[176:179], a[130:145]
    v_mul_f32 v37, v37, v106
    v_cvt_pk_bf16_f32 v192, v36, v37
    v_mul_f32 v38, v38, v106
    v_mul_f32 v39, v39, v106
    v_cvt_pk_bf16_f32 v193, v38, v39
    v_mfma_f32_32x32x16_bf16 a[146:161], v[88:91], v[176:179], a[146:161]
    v_mul_f32 v40, v40, v106
    v_mul_f32 v41, v41, v106
    v_cvt_pk_bf16_f32 v194, v40, v41
    v_mul_f32 v42, v42, v106
    v_mul_f32 v43, v43, v106
    v_mfma_f32_32x32x16_bf16 v[52:67], v[216:219], a[88:91], v[52:67]
    v_cvt_pk_bf16_f32 v195, v42, v43
    v_mul_f32 v44, v44, v106
    v_mul_f32 v45, v45, v106
    v_cvt_pk_bf16_f32 v196, v44, v45
    v_mul_f32 v46, v46, v106
    v_mfma_f32_32x32x16_bf16 v[52:67], v[220:223], a[92:95], v[52:67]
    v_mul_f32 v47, v47, v106
    v_cvt_pk_bf16_f32 v197, v46, v47
    v_mul_f32 v48, v48, v106
    v_mul_f32 v49, v49, v106
    v_cvt_pk_bf16_f32 v198, v48, v49
    v_mfma_f32_32x32x16_bf16 a[130:145], v[92:95], v[180:183], a[130:145]
    v_mul_f32 v50, v50, v106
    v_mul_f32 v51, v51, v106
    v_cvt_pk_bf16_f32 v199, v50, v51
    v_cndmask_b32 v198, v198, 0, s[44:45]
    v_cndmask_b32 v199, v199, 0, s[44:45]
    v_mfma_f32_32x32x16_bf16 a[146:161], v[96:99], v[180:183], a[146:161]
    ds_read_b64_tr_b16 v[84:85], v101 offset:17920
    ds_read_b64_tr_b16 v[86:87], v101 offset:18944
    ds_read_b64_tr_b16 v[88:89], v102 offset:17920
    ds_read_b64_tr_b16 v[90:91], v102 offset:18944
    ds_read_b64_tr_b16 v[92:93], v101 offset:19968
    ds_read_b64_tr_b16 v[94:95], v101 offset:20992
    ds_read_b64_tr_b16 v[96:97], v102 offset:19968
    ds_read_b64_tr_b16 v[98:99], v102 offset:20992
    s_add_u32 m0, s47, 2048
    s_add_u32 s50, s46, 57344
    buffer_load_dwordx4 v10, s[20:23], s50 offen lds
    s_add_u32 m0, s47, 3072
    s_add_u32 s50, s46, 86016
    buffer_load_dwordx4 v10, s[20:23], s50 offen lds
    s_waitcnt lgkmcnt(8)
    s_waitcnt vmcnt(10)
    v_mfma_f32_32x32x16_bf16 v[36:51], v[224:227], a[96:99], 0
    v_mov_b32 v105, v64
    v_mov_b32 v106, v64
    s_nop 1
    v_permlane32_swap_b32 v105, v106
    v_cvt_pk_bf16_f32 v106, v106, v106
    v_and_b32 v106, 0xffff0000, v106
    v_mfma_f32_32x32x16_bf16 v[36:51], v[228:231], a[100:103], v[36:51]
    v_add_f32 v106, 0x358637bd, v106
    v_cvt_pk_bf16_f32 v106, v106, v106
    v_and_b32 v106, 0xffff0000, v106
    v_rcp_f32 v106, v106
    s_nop 0
    v_mul_f32 v52, v52, v106
    v_mfma_f32_32x32x16_bf16 a[130:145], v[68:71], v[192:195], a[130:145]
    v_mul_f32 v53, v53, v106
    v_cvt_pk_bf16_f32 v208, v52, v53
    v_mul_f32 v54, v54, v106
    v_mul_f32 v55, v55, v106
    v_cvt_pk_bf16_f32 v209, v54, v55
    v_mfma_f32_32x32x16_bf16 a[146:161], v[72:75], v[192:195], a[146:161]
    v_mul_f32 v56, v56, v106
    v_mul_f32 v57, v57, v106
    v_cvt_pk_bf16_f32 v210, v56, v57
    v_mul_f32 v58, v58, v106
    v_mul_f32 v59, v59, v106
    v_mfma_f32_32x32x16_bf16 v[36:51], v[232:235], a[104:107], v[36:51]
    v_cvt_pk_bf16_f32 v211, v58, v59
    v_mul_f32 v60, v60, v106
    v_mul_f32 v61, v61, v106
    v_cvt_pk_bf16_f32 v212, v60, v61
    v_mul_f32 v62, v62, v106
    v_mfma_f32_32x32x16_bf16 v[36:51], v[236:239], a[108:111], v[36:51]
    v_mul_f32 v63, v63, v106
    v_cvt_pk_bf16_f32 v213, v62, v63
    v_mul_f32 v64, v64, v106
    v_mul_f32 v65, v65, v106
    v_cvt_pk_bf16_f32 v214, v64, v65
    v_mfma_f32_32x32x16_bf16 a[130:145], v[76:79], v[196:199], a[130:145]
    v_mul_f32 v66, v66, v106
    v_mul_f32 v67, v67, v106
    v_cvt_pk_bf16_f32 v215, v66, v67
    v_cndmask_b32 v214, v214, 0, s[44:45]
    v_cndmask_b32 v215, v215, 0, s[44:45]
    v_mfma_f32_32x32x16_bf16 a[146:161], v[80:83], v[196:199], a[146:161]
    ds_read_b64_tr_b16 v[68:69], v101 offset:21504
    ds_read_b64_tr_b16 v[70:71], v101 offset:22528
    ds_read_b64_tr_b16 v[72:73], v102 offset:21504
    ds_read_b64_tr_b16 v[74:75], v102 offset:22528
    ds_read_b64_tr_b16 v[76:77], v101 offset:23552
    ds_read_b64_tr_b16 v[78:79], v101 offset:24576
    ds_read_b64_tr_b16 v[80:81], v102 offset:23552
    ds_read_b64_tr_b16 v[82:83], v102 offset:24576
    s_add_u32 m0, s47, 16384
    s_add_u32 s50, s46, 229376
    buffer_load_dwordx4 v10, s[20:23], s50 offen lds
    s_add_u32 m0, s47, 17408
    s_add_u32 s50, s46, 258048
    buffer_load_dwordx4 v10, s[20:23], s50 offen lds
    s_waitcnt lgkmcnt(8)
    s_waitcnt vmcnt(8)
    v_mfma_f32_32x32x16_bf16 v[52:67], v[240:243], a[112:115], 0
    v_mov_b32 v105, v48
    v_mov_b32 v106, v48
    s_nop 1
    v_permlane32_swap_b32 v105, v106
    v_cvt_pk_bf16_f32 v106, v106, v106
    v_and_b32 v106, 0xffff0000, v106
    v_mfma_f32_32x32x16_bf16 v[52:67], v[244:247], a[116:119], v[52:67]
    v_add_f32 v106, 0x358637bd, v106
    v_cvt_pk_bf16_f32 v106, v106, v106
    v_and_b32 v106, 0xffff0000, v106
    v_rcp_f32 v106, v106
    s_nop 0
    v_mul_f32 v36, v36, v106
    v_mfma_f32_32x32x16_bf16 a[130:145], v[84:87], v[208:211], a[130:145]
    v_mul_f32 v37, v37, v106
    v_cvt_pk_bf16_f32 v224, v36, v37
    v_mul_f32 v38, v38, v106
    v_mul_f32 v39, v39, v106
    v_cvt_pk_bf16_f32 v225, v38, v39
    v_mfma_f32_32x32x16_bf16 a[146:161], v[88:91], v[208:211], a[146:161]
    v_mul_f32 v40, v40, v106
    v_mul_f32 v41, v41, v106
    v_cvt_pk_bf16_f32 v226, v40, v41
    v_mul_f32 v42, v42, v106
    v_mul_f32 v43, v43, v106
    v_mfma_f32_32x32x16_bf16 v[52:67], v[248:251], a[120:123], v[52:67]
    v_cvt_pk_bf16_f32 v227, v42, v43
    v_mul_f32 v44, v44, v106
    v_mul_f32 v45, v45, v106
    v_cvt_pk_bf16_f32 v228, v44, v45
    v_mul_f32 v46, v46, v106
    v_mfma_f32_32x32x16_bf16 v[52:67], v[252:255], a[124:127], v[52:67]
    v_mul_f32 v47, v47, v106
    v_cvt_pk_bf16_f32 v229, v46, v47
    v_mul_f32 v48, v48, v106
    v_mul_f32 v49, v49, v106
    v_cvt_pk_bf16_f32 v230, v48, v49
    v_mfma_f32_32x32x16_bf16 a[130:145], v[92:95], v[212:215], a[130:145]
    v_mul_f32 v50, v50, v106
    v_mul_f32 v51, v51, v106
    v_cvt_pk_bf16_f32 v231, v50, v51
    v_cndmask_b32 v230, v230, 0, s[44:45]
    v_cndmask_b32 v231, v231, 0, s[44:45]
    v_mfma_f32_32x32x16_bf16 a[146:161], v[96:99], v[212:215], a[146:161]
    ds_read_b64_tr_b16 v[84:85], v101 offset:25088
    ds_read_b64_tr_b16 v[86:87], v101 offset:26112
    ds_read_b64_tr_b16 v[88:89], v102 offset:25088
    ds_read_b64_tr_b16 v[90:91], v102 offset:26112
    ds_read_b64_tr_b16 v[92:93], v101 offset:27136
    ds_read_b64_tr_b16 v[94:95], v101 offset:28160
    ds_read_b64_tr_b16 v[96:97], v102 offset:27136
    ds_read_b64_tr_b16 v[98:99], v102 offset:28160
    s_add_u32 m0, s47, 18432
    s_add_u32 s50, s46, 286720
    buffer_load_dwordx4 v10, s[20:23], s50 offen lds
    s_add_u32 m0, s47, 19456
    s_add_u32 s50, s46, 315392
    buffer_load_dwordx4 v10, s[20:23], s50 offen lds
    s_waitcnt lgkmcnt(8)
    v_mfma_f32_32x32x16_bf16 a[130:145], v[68:71], v[224:227], a[130:145]
    v_mov_b32 v105, v64
    v_mov_b32 v106, v64
    s_nop 1
    v_permlane32_swap_b32 v105, v106
    v_cvt_pk_bf16_f32 v106, v106, v106
    v_and_b32 v106, 0xffff0000, v106
    v_add_f32 v106, 0x358637bd, v106
    v_cvt_pk_bf16_f32 v106, v106, v106
    v_and_b32 v106, 0xffff0000, v106
    v_rcp_f32 v106, v106
    v_mfma_f32_32x32x16_bf16 a[146:161], v[72:75], v[224:227], a[146:161]
    v_mul_f32 v52, v52, v106
    v_mul_f32 v53, v53, v106
    v_cvt_pk_bf16_f32 v240, v52, v53
    v_mul_f32 v54, v54, v106
    v_mul_f32 v55, v55, v106
    v_cvt_pk_bf16_f32 v241, v54, v55
    v_mul_f32 v56, v56, v106
    v_mul_f32 v57, v57, v106
    v_cvt_pk_bf16_f32 v242, v56, v57
    v_mfma_f32_32x32x16_bf16 a[130:145], v[76:79], v[228:231], a[130:145]
    v_mul_f32 v58, v58, v106
    v_mul_f32 v59, v59, v106
    v_cvt_pk_bf16_f32 v243, v58, v59
    v_mul_f32 v60, v60, v106
    v_mul_f32 v61, v61, v106
    v_cvt_pk_bf16_f32 v244, v60, v61
    v_mul_f32 v62, v62, v106
    v_mul_f32 v63, v63, v106
    v_cvt_pk_bf16_f32 v245, v62, v63
    v_mfma_f32_32x32x16_bf16 a[146:161], v[80:83], v[228:231], a[146:161]
    v_mul_f32 v64, v64, v106
    v_mul_f32 v65, v65, v106
    v_cvt_pk_bf16_f32 v246, v64, v65
    v_mul_f32 v66, v66, v106
    v_mul_f32 v67, v67, v106
    v_cvt_pk_bf16_f32 v247, v66, v67
    v_cndmask_b32 v246, v246, 0, s[44:45]
    v_cndmask_b32 v247, v247, 0, s[44:45]
    s_waitcnt lgkmcnt(0)
    v_mfma_f32_32x32x16_bf16 a[130:145], v[84:87], v[240:243], a[130:145]
    v_mfma_f32_32x32x16_bf16 a[146:161], v[88:91], v[240:243], a[146:161]
    v_mfma_f32_32x32x16_bf16 a[130:145], v[92:95], v[244:247], a[130:145]
    v_mfma_f32_32x32x16_bf16 a[146:161], v[96:99], v[244:247], a[146:161]
    s_nop 10
    ds_write_b128 v103, a[130:133] offset:0
    ds_write_b128 v103, a[134:137] offset:32
    ds_write_b128 v103, a[138:141] offset:64
    ds_write_b128 v103, a[142:145] offset:96
    ds_write_b128 v103, a[146:149] offset:128
    ds_write_b128 v103, a[150:153] offset:160
    ds_write_b128 v103, a[154:157] offset:192
    ds_write_b128 v103, a[158:161] offset:224
    s_lshl_b32 s61, s64, 6
    s_lshl_b32 s50, s38, 4
    s_add_u32 s61, s61, s50
    s_lshl_b32 s61, s61, 3
    s_lshl_b32 s50, s65, 14
    s_add_u32 s61, s61, s50
    s_add_u32 s61, s61, 655360
    s_lshl_b32 s60, s2, 7
    s_lshl_b32 s50, s38, 2
    s_add_u32 s60, s60, s50
    s_add_u32 s60, s60, 786448
    v_lshrrev_b32 v7, 1, v1
    v_lshlrev_b32 v105, 12, v7
    s_lshl_b32 s50, s40, 11
    s_and_b32 s51, s2, 15
    s_lshl_b32 s51, s51, 7
    s_add_u32 s50, s50, s51
    s_lshl_b32 s51, s39, 3
    s_add_u32 s50, s50, s51
    s_add_u32 s50, s50, 16
    v_add_u32 v105, s50, v105
    v_min_u32 v7, 8, v7
    v_subrev_u32 v7, 7, v7
    v_mul_u32_u24 v7, 1792, v7
    s_add_u32 s50, s37, 224
    s_lshl_b32 s50, s50, 7
    v_add_u32 v7, s50, v7
    v_cmp_gt_u32 vcc, 14, v1
    s_nop 1
    v_cndmask_b32 v105, v7, v105, vcc
    v_and_b32 v7, 1, v1
    v_lshl_add_u32 v105, v7, 2, v105
    s_waitcnt lgkmcnt(0)
    s_barrier
    ds_read_b128 v[36:39], v104 offset:0
    ds_read_b128 v[40:43], v104 offset:16
    ds_read_b128 v[44:47], v104 offset:17408
    ds_read_b128 v[48:51], v104 offset:17424
    ds_read_b128 v[52:55], v104 offset:2176
    ds_read_b128 v[56:59], v104 offset:2192
    ds_read_b128 v[60:63], v104 offset:19584
    ds_read_b128 v[64:67], v104 offset:19600
    s_waitcnt vmcnt(8)
    s_mov_b32 s50, 0x01010101
    s_mov_b32 s51, 0x01010101
    s_waitcnt lgkmcnt(4)
    v_add_f32 v36, v36, v44
    v_add_f32 v37, v37, v45
    v_add_f32 v38, v38, v46
    v_add_f32 v39, v39, v47
    v_add_f32 v40, v40, v48
    v_add_f32 v41, v41, v49
    v_add_f32 v42, v42, v50
    v_add_f32 v43, v43, v51
    v_cvt_pk_bf16_f32 v44, v36, v37
    v_cvt_pk_bf16_f32 v45, v38, v39
    v_cvt_pk_bf16_f32 v46, v40, v41
    v_cvt_pk_bf16_f32 v47, v42, v43
    v_lshlrev_b32 v36, 16, v44
    v_and_b32 v37, s41, v44
    v_lshlrev_b32 v68, 16, v120
    v_and_b32 v69, s41, v120
    v_lshlrev_b32 v38, 16, v45
    v_and_b32 v39, s41, v45
    v_lshlrev_b32 v70, 16, v121
    v_and_b32 v71, s41, v121
    v_lshlrev_b32 v40, 16, v46
    v_and_b32 v41, s41, v46
    v_lshlrev_b32 v72, 16, v122
    v_and_b32 v73, s41, v122
    v_lshlrev_b32 v42, 16, v47
    v_and_b32 v43, s41, v47
    v_lshlrev_b32 v74, 16, v123
    v_and_b32 v75, s41, v123
    v_add_f32 v36, v36, v68
    v_add_f32 v37, v37, v69
    v_add_f32 v38, v38, v70
    v_add_f32 v39, v39, v71
    v_add_f32 v40, v40, v72
    v_add_f32 v41, v41, v73
    v_add_f32 v42, v42, v74
    v_add_f32 v43, v43, v75
    v_cvt_pk_bf16_f32 v44, v36, v37
    v_cvt_pk_bf16_f32 v45, v38, v39
    v_cvt_pk_bf16_f32 v46, v40, v41
    v_cvt_pk_bf16_f32 v47, v42, v43
    buffer_store_dwordx4 v[44:47], v26, s[32:35], s63 offen offset:0 sc1
    v_add_f32 v68, v36, v37
    v_mul_f32 v69, v36, v36
    v_add_f32 v70, v38, v39
    v_mul_f32 v71, v37, v37
    v_add_f32 v68, v68, v40
    v_add_f32 v70, v70, v41
    v_add_f32 v68, v68, v42
    v_add_f32 v70, v70, v43
    v_fmac_f32 v69, v38, v38
    v_fmac_f32 v71, v39, v39
    v_fmac_f32 v69, v40, v40
    v_fmac_f32 v71, v41, v41
    v_fmac_f32 v69, v42, v42
    v_fmac_f32 v71, v43, v43
    v_add_f32 v68, v68, v70
    v_add_f32 v69, v69, v71
    s_nop 0
    v_add_f32_dpp v68, v68, v68 quad_perm:[1,0,3,2] row_mask:0xf bank_mask:0xf
    v_add_f32_dpp v69, v69, v69 quad_perm:[1,0,3,2] row_mask:0xf bank_mask:0xf
    s_nop 0
    v_add_f32_dpp v68, v68, v68 quad_perm:[2,3,0,1] row_mask:0xf bank_mask:0xf
    v_add_f32_dpp v69, v69, v69 quad_perm:[2,3,0,1] row_mask:0xf bank_mask:0xf
    s_nop 0
    v_add_f32_dpp v68, v68, v68 row_half_mirror row_mask:0xf bank_mask:0xf
    v_add_f32_dpp v69, v69, v69 row_half_mirror row_mask:0xf bank_mask:0xf
    s_mov_b64 exec, s[50:51]
    buffer_store_dwordx2 v[68:69], v35, s[32:35], s61 offen offset:0 sc1
    s_mov_b64 exec, -1
    s_waitcnt lgkmcnt(0)
    v_add_f32 v52, v52, v60
    v_add_f32 v53, v53, v61
    v_add_f32 v54, v54, v62
    v_add_f32 v55, v55, v63
    v_add_f32 v56, v56, v64
    v_add_f32 v57, v57, v65
    v_add_f32 v58, v58, v66
    v_add_f32 v59, v59, v67
    v_cvt_pk_bf16_f32 v60, v52, v53
    v_cvt_pk_bf16_f32 v61, v54, v55
    v_cvt_pk_bf16_f32 v62, v56, v57
    v_cvt_pk_bf16_f32 v63, v58, v59
    v_lshlrev_b32 v52, 16, v60
    v_and_b32 v53, s41, v60
    v_lshlrev_b32 v84, 16, v124
    v_and_b32 v85, s41, v124
    v_lshlrev_b32 v54, 16, v61
    v_and_b32 v55, s41, v61
    v_lshlrev_b32 v86, 16, v125
    v_and_b32 v87, s41, v125
    v_lshlrev_b32 v56, 16, v62
    v_and_b32 v57, s41, v62
    v_lshlrev_b32 v88, 16, v126
    v_and_b32 v89, s41, v126
    v_lshlrev_b32 v58, 16, v63
    v_and_b32 v59, s41, v63
    v_lshlrev_b32 v90, 16, v127
    v_and_b32 v91, s41, v127
    v_add_f32 v52, v52, v84
    v_add_f32 v53, v53, v85
    v_add_f32 v54, v54, v86
    v_add_f32 v55, v55, v87
    v_add_f32 v56, v56, v88
    v_add_f32 v57, v57, v89
    v_add_f32 v58, v58, v90
    v_add_f32 v59, v59, v91
    v_cvt_pk_bf16_f32 v60, v52, v53
    v_cvt_pk_bf16_f32 v61, v54, v55
    v_cvt_pk_bf16_f32 v62, v56, v57
    v_cvt_pk_bf16_f32 v63, v58, v59
    buffer_store_dwordx4 v[60:63], v26, s[32:35], s63 offen offset:128 sc1
    v_add_f32 v84, v52, v53
    v_mul_f32 v85, v52, v52
    v_add_f32 v86, v54, v55
    v_mul_f32 v87, v53, v53
    v_add_f32 v84, v84, v56
    v_add_f32 v86, v86, v57
    v_add_f32 v84, v84, v58
    v_add_f32 v86, v86, v59
    v_fmac_f32 v85, v54, v54
    v_fmac_f32 v87, v55, v55
    v_fmac_f32 v85, v56, v56
    v_fmac_f32 v87, v57, v57
    v_fmac_f32 v85, v58, v58
    v_fmac_f32 v87, v59, v59
    v_add_f32 v84, v84, v86
    v_add_f32 v85, v85, v87
    s_nop 0
    v_add_f32_dpp v84, v84, v84 quad_perm:[1,0,3,2] row_mask:0xf bank_mask:0xf
    v_add_f32_dpp v85, v85, v85 quad_perm:[1,0,3,2] row_mask:0xf bank_mask:0xf
    s_nop 0
    v_add_f32_dpp v84, v84, v84 quad_perm:[2,3,0,1] row_mask:0xf bank_mask:0xf
    v_add_f32_dpp v85, v85, v85 quad_perm:[2,3,0,1] row_mask:0xf bank_mask:0xf
    s_nop 0
    v_add_f32_dpp v84, v84, v84 row_half_mirror row_mask:0xf bank_mask:0xf
    v_add_f32_dpp v85, v85, v85 row_half_mirror row_mask:0xf bank_mask:0xf
    s_mov_b64 exec, s[50:51]
    buffer_store_dwordx2 v[84:85], v35, s[32:35], s61 offen offset:64 sc1
    s_mov_b64 exec, -1
    v_mov_b32 v106, 1
    v_mov_b32 v107, 0
    s_mov_b32 s16, s4
    s_mov_b32 s17, s5
    s_mov_b32 s18, 1605632
    s_mov_b32 s19, 0x00020000
    s_waitcnt vmcnt(0)
    s_mov_b64 exec, 1
    buffer_store_dword v106, v107, s[32:35], s60 offen sc1
    s_mov_b64 exec, -1
    s_add_u32 m0, s47, 32768
    s_add_u32 s50, s46, 458752
    buffer_load_dwordx4 v10, s[20:23], s50 offen lds
    s_add_u32 m0, s47, 33792
    s_add_u32 s50, s46, 487424
    buffer_load_dwordx4 v10, s[20:23], s50 offen lds
    s_add_u32 m0, s47, 34816
    s_add_u32 s50, s46, 516096
    buffer_load_dwordx4 v10, s[20:23], s50 offen lds
    s_add_u32 m0, s47, 35840
    s_add_u32 s50, s46, 544768
    buffer_load_dwordx4 v10, s[20:23], s50 offen lds
    s_add_u32 m0, s47, 49152
    s_add_u32 s50, s46, 688128
    buffer_load_dwordx4 v10, s[20:23], s50 offen lds
    s_add_u32 m0, s47, 50176
    s_add_u32 s50, s46, 716800
    buffer_load_dwordx4 v10, s[20:23], s50 offen lds
    s_add_u32 m0, s47, 51200
    s_add_u32 s50, s46, 745472
    buffer_load_dwordx4 v10, s[20:23], s50 offen lds
    s_add_u32 m0, s47, 52224
    s_add_u32 s50, s46, 774144
    buffer_load_dwordx4 v10, s[20:23], s50 offen lds
    s_lshl_b32 s66, s65, 1
    s_and_b32 s67, s64, 3
    s_mul_i32 s67, s67, 3
    s_add_u32 s66, s66, s67
    s_cmp_ge_u32 s66, 14
    s_cselect_b32 s67, 14, 0
    s_sub_u32 s66, s66, s67
    s_mul_i32 s77, s38, 14
    s_add_u32 s67, s66, s77
    s_lshr_b32 s50, s67, 2
    s_lshl_b32 s50, s50, 3
    s_and_b32 s67, s67, 3
    s_add_u32 s50, s50, s67
    s_lshl_b32 s68, s50, 10
    s_add_u32 s66, s66, 1
    s_cmp_ge_u32 s66, 14
    s_cselect_b32 s66, 0, s66
    s_add_u32 s67, s66, s77
    s_lshr_b32 s50, s67, 2
    s_lshl_b32 s50, s50, 3
    s_and_b32 s67, s67, 3
    s_add_u32 s50, s50, s67
    s_lshl_b32 s69, s50, 10
    s_add_u32 s66, s66, 1
    s_cmp_ge_u32 s66, 14
    s_cselect_b32 s66, 0, s66
    s_add_u32 s67, s66, s77
    s_lshr_b32 s50, s67, 2
    s_lshl_b32 s50, s50, 3
    s_and_b32 s67, s67, 3
    s_add_u32 s50, s50, s67
    s_lshl_b32 s70, s50, 10
    s_add_u32 s66, s66, 1
    s_cmp_ge_u32 s66, 14
    s_cselect_b32 s66, 0, s66
    s_add_u32 s67, s66, s77
    s_lshr_b32 s50, s67, 2
    s_lshl_b32 s50, s50, 3
    s_and_b32 s67, s67, 3
    s_add_u32 s50, s50, s67
    s_lshl_b32 s71, s50, 10
    s_add_u32 s66, s66, 1
    s_cmp_ge_u32 s66, 14
    s_cselect_b32 s66, 0, s66
    s_add_u32 s67, s66, s77
    s_lshr_b32 s50, s67, 2
    s_lshl_b32 s50, s50, 3
    s_and_b32 s67, s67, 3
    s_add_u32 s50, s50, s67
    s_lshl_b32 s72, s50, 10
    s_add_u32 s66, s66, 1
    s_cmp_ge_u32 s66, 14
    s_cselect_b32 s66, 0, s66
    s_add_u32 s67, s66, s77
    s_lshr_b32 s50, s67, 2
    s_lshl_b32 s50, s50, 3
    s_and_b32 s67, s67, 3
    s_add_u32 s50, s50, s67
    s_lshl_b32 s73, s50, 10
    s_add_u32 s66, s66, 1
    s_cmp_ge_u32 s66, 14
    s_cselect_b32 s66, 0, s66
    s_add_u32 s67, s66, s77
    s_lshr_b32 s50, s67, 2
    s_lshl_b32 s50, s50, 3
    s_and_b32 s67, s67, 3
    s_add_u32 s50, s50, s67
    s_lshl_b32 s74, s50, 10
    s_add_u32 s66, s66, 1
    s_cmp_ge_u32 s66, 14
    s_cselect_b32 s66, 0, s66
    s_add_u32 s67, s66, s77
    s_lshr_b32 s50, s67, 2
    s_lshl_b32 s50, s50, 3
    s_and_b32 s67, s67, 3
    s_add_u32 s50, s50, s67
    s_lshl_b32 s75, s50, 10
    s_add_u32 s66, s66, 1
    s_cmp_ge_u32 s66, 14
    s_cselect_b32 s66, 0, s66
    s_add_u32 s67, s66, s77
    s_lshr_b32 s50, s67, 2
    s_lshl_b32 s50, s50, 3
    s_and_b32 s67, s67, 3
    s_add_u32 s50, s50, s67
    s_lshl_b32 s8, s50, 10
    s_add_u32 s66, s66, 1
    s_cmp_ge_u32 s66, 14
    s_cselect_b32 s66, 0, s66
    s_add_u32 s67, s66, s77
    s_lshr_b32 s50, s67, 2
    s_lshl_b32 s50, s50, 3
    s_and_b32 s67, s67, 3
    s_add_u32 s50, s50, s67
    s_lshl_b32 s9, s50, 10
    s_add_u32 s66, s66, 1
    s_cmp_ge_u32 s66, 14
    s_cselect_b32 s66, 0, s66
    s_add_u32 s67, s66, s77
    s_lshr_b32 s50, s67, 2
    s_lshl_b32 s50, s50, 3
    s_and_b32 s67, s67, 3
    s_add_u32 s50, s50, s67
    s_lshl_b32 s10, s50, 10
    s_add_u32 s66, s66, 1
    s_cmp_ge_u32 s66, 14
    s_cselect_b32 s66, 0, s66
    s_add_u32 s67, s66, s77
    s_lshr_b32 s50, s67, 2
    s_lshl_b32 s50, s50, 3
    s_and_b32 s67, s67, 3
    s_add_u32 s50, s50, s67
    s_lshl_b32 s11, s50, 10
    s_add_u32 s66, s66, 1
    s_cmp_ge_u32 s66, 14
    s_cselect_b32 s66, 0, s66
    s_add_u32 s67, s66, s77
    s_lshr_b32 s50, s67, 2
    s_lshl_b32 s50, s50, 3
    s_and_b32 s67, s67, 3
    s_add_u32 s50, s50, s67
    s_lshl_b32 s12, s50, 10
    s_add_u32 s66, s66, 1
    s_cmp_ge_u32 s66, 14
    s_cselect_b32 s66, 0, s66
    s_add_u32 s67, s66, s77
    s_lshr_b32 s50, s67, 2
    s_lshl_b32 s50, s50, 3
    s_and_b32 s67, s67, 3
    s_add_u32 s50, s50, s67
    s_lshl_b32 s13, s50, 10
    s_add_u32 s66, s66, 1
    s_cmp_ge_u32 s66, 14
    s_cselect_b32 s66, 0, s66
    s_lshl_b32 s50, s65, 7
    s_mul_i32 s42, s57, 57344
    s_sub_u32 s43, 57344, s42
    s_add_u32 s42, s42, s50
    s_add_u32 s43, s43, s50
    s_mul_i32 s50, s64, 229376
    s_add_u32 s50, s50, 16777216
    s_lshl_b32 s66, s57, 12
    s_sub_u32 s67, 4096, s66
    s_add_u32 s66, s66, s50
    s_add_u32 s67, s67, s50
    v_add_u32 v34, 7168, v27
    s_sub_u32 s60, s60, 16
    s_and_b32 s61, s2, 15
    s_lshl_b32 s61, s61, 7
    s_and_b32 s50, s64, 1
    s_lshl_b32 s50, s50, 3
    s_add_u32 s61, s61, s50
    s_add_u32 s61, s61, 786432
    v_lshrrev_b32 v110, 1, v1
    v_min_u32 v110, 13, v110
    v_lshlrev_b32 v110, 11, v110
    v_and_b32 v111, 1, v1
    v_lshl_add_u32 v110, v111, 2, v110
    v_mov_b32 v111, 1
    v_mov_b32 v112, 0
    s_mov_b32 s51, 786432
    s_mov_b32 s50, 0
    buffer_load_dword v107, v105, s[32:35], s51 offen sc1
    s_sleep 4
    buffer_load_dword v108, v105, s[32:35], s51 offen sc1
    s_sleep 4
K3_POLLB:
    buffer_load_dword v109, v105, s[32:35], s51 offen sc1
    s_waitcnt vmcnt(2)
    v_cmp_ne_u32 vcc, 1, v107
    s_cmp_eq_u64 vcc, 0
    s_cbranch_scc1 K3_POLLBX
    buffer_load_dword v107, v105, s[32:35], s51 offen sc1
    s_waitcnt vmcnt(2)
    v_cmp_ne_u32 vcc, 1, v108
    s_cmp_eq_u64 vcc, 0
    s_cbranch_scc1 K3_POLLBX
    buffer_load_dword v108, v105, s[32:35], s51 offen sc1
    s_waitcnt vmcnt(2)
    v_cmp_ne_u32 vcc, 1, v109
    s_cmp_eq_u64 vcc, 0
    s_cbranch_scc1 K3_POLLBX
    s_add_u32 s50, s50, 1
    s_cmp_lt_u32 s50, 0x200000
    s_cbranch_scc1 K3_POLLB
K3_POLLBX:
    s_add_u32 s50, s49, 0
    buffer_load_dwordx4 a[0:3], v11, s[32:35], s50 offen sc1
    s_add_u32 s50, s49, 1024
    buffer_load_dwordx4 a[4:7], v11, s[32:35], s50 offen sc1
    s_add_u32 s50, s49, 2048
    buffer_load_dwordx4 a[8:11], v11, s[32:35], s50 offen sc1
    s_add_u32 s50, s49, 3072
    buffer_load_dwordx4 a[12:15], v11, s[32:35], s50 offen sc1
    s_add_u32 s50, s49, 4096
    buffer_load_dwordx4 a[16:19], v11, s[32:35], s50 offen sc1
    s_add_u32 s50, s49, 5120
    buffer_load_dwordx4 a[20:23], v11, s[32:35], s50 offen sc1
    s_add_u32 s50, s49, 6144
    buffer_load_dwordx4 a[24:27], v11, s[32:35], s50 offen sc1
    s_add_u32 s50, s49, 7168
    buffer_load_dwordx4 a[28:31], v11, s[32:35], s50 offen sc1
    s_add_u32 s50, s49, 8192
    buffer_load_dwordx4 a[32:35], v11, s[32:35], s50 offen sc1
    s_add_u32 s50, s49, 9216
    buffer_load_dwordx4 a[36:39], v11, s[32:35], s50 offen sc1
    s_add_u32 s50, s49, 10240
    buffer_load_dwordx4 a[40:43], v11, s[32:35], s50 offen sc1
    s_add_u32 s50, s49, 11264
    buffer_load_dwordx4 a[44:47], v11, s[32:35], s50 offen sc1
    s_waitcnt vmcnt(8)
    s_barrier
    ds_read_b64_tr_b16 v[36:37], v12 offset:0
    ds_read_b64_tr_b16 v[38:39], v12 offset:512
    ds_read_b64_tr_b16 v[40:41], v13 offset:0
    ds_read_b64_tr_b16 v[42:43], v13 offset:512
    ds_read_b64_tr_b16 v[44:45], v14 offset:0
    ds_read_b64_tr_b16 v[46:47], v14 offset:512
    ds_read_b64_tr_b16 v[48:49], v15 offset:0
    ds_read_b64_tr_b16 v[50:51], v15 offset:512
    ds_read_b64_tr_b16 v[52:53], v12 offset:2048
    ds_read_b64_tr_b16 v[54:55], v12 offset:2560
    ds_read_b64_tr_b16 v[56:57], v13 offset:2048
    ds_read_b64_tr_b16 v[58:59], v13 offset:2560
    ds_read_b64_tr_b16 v[60:61], v14 offset:2048
    ds_read_b64_tr_b16 v[62:63], v14 offset:2560
    ds_read_b64_tr_b16 v[64:65], v15 offset:2048
    ds_read_b64_tr_b16 v[66:67], v15 offset:2560
    s_waitcnt lgkmcnt(12)
    v_mfma_f32_32x32x16_bf16 v[128:143], v[36:39], a[0:3], 0
    s_add_u32 s50, s49, 12288
    buffer_load_dwordx4 a[48:51], v11, s[32:35], s50 offen sc1
    ds_read_b64_tr_b16 v[68:69], v12 offset:4096
    ds_read_b64_tr_b16 v[70:71], v12 offset:4608
    v_mfma_f32_32x32x16_bf16 v[144:159], v[40:43], a[0:3], 0
    s_add_u32 s50, s49, 13312
    buffer_load_dwordx4 a[52:55], v11, s[32:35], s50 offen sc1
    ds_read_b64_tr_b16 v[72:73], v13 offset:4096
    ds_read_b64_tr_b16 v[74:75], v13 offset:4608
    s_waitcnt lgkmcnt(12)
    v_mfma_f32_32x32x16_bf16 v[160:175], v[44:47], a[0:3], 0
    s_add_u32 s50, s49, 14336
    buffer_load_dwordx4 a[56:59], v11, s[32:35], s50 offen sc1
    ds_read_b64_tr_b16 v[76:77], v14 offset:4096
    ds_read_b64_tr_b16 v[78:79], v14 offset:4608
    v_mfma_f32_32x32x16_bf16 v[176:191], v[48:51], a[0:3], 0
    s_add_u32 s50, s49, 15360
    buffer_load_dwordx4 a[60:63], v11, s[32:35], s50 offen sc1
    ds_read_b64_tr_b16 v[80:81], v15 offset:4096
    ds_read_b64_tr_b16 v[82:83], v15 offset:4608
    s_waitcnt lgkmcnt(12)
    v_mfma_f32_32x32x16_bf16 v[128:143], v[52:55], a[4:7], v[128:143]
    s_add_u32 m0, s47, 65536
    s_add_u32 s50, s46, 917504
    buffer_load_dwordx4 v10, s[20:23], s50 offen lds
    ds_read_b64_tr_b16 v[84:85], v12 offset:6144
    ds_read_b64_tr_b16 v[86:87], v12 offset:6656
    v_mfma_f32_32x32x16_bf16 v[144:159], v[56:59], a[4:7], v[144:159]
    s_add_u32 s50, s49, 16384
    buffer_load_dwordx4 a[64:67], v11, s[32:35], s50 offen sc1
    ds_read_b64_tr_b16 v[88:89], v13 offset:6144
    ds_read_b64_tr_b16 v[90:91], v13 offset:6656
    s_waitcnt lgkmcnt(12)
    v_mfma_f32_32x32x16_bf16 v[160:175], v[60:63], a[4:7], v[160:175]
    s_add_u32 m0, s47, 66560
    s_add_u32 s50, s46, 946176
    buffer_load_dwordx4 v10, s[20:23], s50 offen lds
    ds_read_b64_tr_b16 v[92:93], v14 offset:6144
    ds_read_b64_tr_b16 v[94:95], v14 offset:6656
    v_mfma_f32_32x32x16_bf16 v[176:191], v[64:67], a[4:7], v[176:191]
    s_add_u32 s50, s49, 17408
    buffer_load_dwordx4 a[68:71], v11, s[32:35], s50 offen sc1
    ds_read_b64_tr_b16 v[96:97], v15 offset:6144
    ds_read_b64_tr_b16 v[98:99], v15 offset:6656
    s_waitcnt lgkmcnt(12)
    v_mfma_f32_32x32x16_bf16 v[128:143], v[68:71], a[8:11], v[128:143]
    s_add_u32 m0, s47, 67584
    s_add_u32 s50, s46, 974848
    buffer_load_dwordx4 v10, s[20:23], s50 offen lds
    s_waitcnt vmcnt(13)
    s_barrier
    ds_read_b64_tr_b16 v[36:37], v12 offset:16384
    ds_read_b64_tr_b16 v[38:39], v12 offset:16896
    v_mfma_f32_32x32x16_bf16 v[144:159], v[72:75], a[8:11], v[144:159]
    s_add_u32 s50, s49, 18432
    buffer_load_dwordx4 a[72:75], v11, s[32:35], s50 offen sc1
    ds_read_b64_tr_b16 v[40:41], v13 offset:16384
    ds_read_b64_tr_b16 v[42:43], v13 offset:16896
    s_waitcnt lgkmcnt(12)
    v_mfma_f32_32x32x16_bf16 v[160:175], v[76:79], a[8:11], v[160:175]
    s_add_u32 m0, s47, 68608
    s_add_u32 s50, s46, 1003520
    buffer_load_dwordx4 v10, s[20:23], s50 offen lds
    ds_read_b64_tr_b16 v[44:45], v14 offset:16384
    ds_read_b64_tr_b16 v[46:47], v14 offset:16896
    v_mfma_f32_32x32x16_bf16 v[176:191], v[80:83], a[8:11], v[176:191]
    s_add_u32 s50, s49, 19456
    buffer_load_dwordx4 a[76:79], v11, s[32:35], s50 offen sc1
    ds_read_b64_tr_b16 v[48:49], v15 offset:16384
    ds_read_b64_tr_b16 v[50:51], v15 offset:16896
    s_waitcnt lgkmcnt(12)
    v_mfma_f32_32x32x16_bf16 v[128:143], v[84:87], a[12:15], v[128:143]
    s_add_u32 m0, s47, 81920
    s_add_u32 s50, s46, 1146880
    buffer_load_dwordx4 v10, s[20:23], s50 offen lds
    ds_read_b64_tr_b16 v[52:53], v12 offset:18432
    ds_read_b64_tr_b16 v[54:55], v12 offset:18944
    v_mfma_f32_32x32x16_bf16 v[144:159], v[88:91], a[12:15], v[144:159]
    ds_read_b64_tr_b16 v[56:57], v13 offset:18432
    ds_read_b64_tr_b16 v[58:59], v13 offset:18944
    s_waitcnt lgkmcnt(12)
    v_mfma_f32_32x32x16_bf16 v[160:175], v[92:95], a[12:15], v[160:175]
    s_add_u32 s50, s49, 20480
    buffer_load_dwordx4 a[80:83], v11, s[32:35], s50 offen sc1
    ds_read_b64_tr_b16 v[60:61], v14 offset:18432
    ds_read_b64_tr_b16 v[62:63], v14 offset:18944
    v_mfma_f32_32x32x16_bf16 v[176:191], v[96:99], a[12:15], v[176:191]
    ds_read_b64_tr_b16 v[64:65], v15 offset:18432
    ds_read_b64_tr_b16 v[66:67], v15 offset:18944
    s_waitcnt lgkmcnt(12)
    v_mfma_f32_32x32x16_bf16 v[128:143], v[36:39], a[16:19], v[128:143]
    s_add_u32 m0, s47, 82944
    s_add_u32 s50, s46, 1175552
    buffer_load_dwordx4 v10, s[20:23], s50 offen lds
    ds_read_b64_tr_b16 v[68:69], v12 offset:20480
    ds_read_b64_tr_b16 v[70:71], v12 offset:20992
    v_mfma_f32_32x32x16_bf16 v[144:159], v[40:43], a[16:19], v[144:159]
    ds_read_b64_tr_b16 v[72:73], v13 offset:20480
    ds_read_b64_tr_b16 v[74:75], v13 offset:20992
    s_waitcnt lgkmcnt(12)
    v_mfma_f32_32x32x16_bf16 v[160:175], v[44:47], a[16:19], v[160:175]
    s_add_u32 s50, s49, 21504
    buffer_load_dwordx4 a[84:87], v11, s[32:35], s50 offen sc1
    ds_read_b64_tr_b16 v[76:77], v14 offset:20480
    ds_read_b64_tr_b16 v[78:79], v14 offset:20992
    v_mfma_f32_32x32x16_bf16 v[176:191], v[48:51], a[16:19], v[176:191]
    ds_read_b64_tr_b16 v[80:81], v15 offset:20480
    ds_read_b64_tr_b16 v[82:83], v15 offset:20992
    s_waitcnt lgkmcnt(12)
    v_mfma_f32_32x32x16_bf16 v[128:143], v[52:55], a[20:23], v[128:143]
    s_add_u32 m0, s47, 83968
    s_add_u32 s50, s46, 1204224
    buffer_load_dwordx4 v10, s[20:23], s50 offen lds
    ds_read_b64_tr_b16 v[84:85], v12 offset:22528
    ds_read_b64_tr_b16 v[86:87], v12 offset:23040
    v_mfma_f32_32x32x16_bf16 v[144:159], v[56:59], a[20:23], v[144:159]
    ds_read_b64_tr_b16 v[88:89], v13 offset:22528
    ds_read_b64_tr_b16 v[90:91], v13 offset:23040
    s_waitcnt lgkmcnt(12)
    v_mfma_f32_32x32x16_bf16 v[160:175], v[60:63], a[20:23], v[160:175]
    s_add_u32 s50, s49, 22528
    buffer_load_dwordx4 a[88:91], v11, s[32:35], s50 offen sc1
    ds_read_b64_tr_b16 v[92:93], v14 offset:22528
    ds_read_b64_tr_b16 v[94:95], v14 offset:23040
    v_mfma_f32_32x32x16_bf16 v[176:191], v[64:67], a[20:23], v[176:191]
    ds_read_b64_tr_b16 v[96:97], v15 offset:22528
    ds_read_b64_tr_b16 v[98:99], v15 offset:23040
    s_waitcnt lgkmcnt(12)
    v_mfma_f32_32x32x16_bf16 v[128:143], v[68:71], a[24:27], v[128:143]
    s_add_u32 m0, s47, 84992
    s_add_u32 s50, s46, 1232896
    buffer_load_dwordx4 v10, s[20:23], s50 offen lds
    s_waitcnt vmcnt(19)
    s_barrier
    ds_read_b64_tr_b16 v[36:37], v12 offset:32768
    ds_read_b64_tr_b16 v[38:39], v12 offset:33280
    v_mfma_f32_32x32x16_bf16 v[144:159], v[72:75], a[24:27], v[144:159]
    ds_read_b64_tr_b16 v[40:41], v13 offset:32768
    ds_read_b64_tr_b16 v[42:43], v13 offset:33280
    s_waitcnt lgkmcnt(12)
    v_mfma_f32_32x32x16_bf16 v[160:175], v[76:79], a[24:27], v[160:175]
    s_add_u32 s50, s49, 23552
    buffer_load_dwordx4 a[92:95], v11, s[32:35], s50 offen sc1
    ds_read_b64_tr_b16 v[44:45], v14 offset:32768
    ds_read_b64_tr_b16 v[46:47], v14 offset:33280
    v_mfma_f32_32x32x16_bf16 v[176:191], v[80:83], a[24:27], v[176:191]
    ds_read_b64_tr_b16 v[48:49], v15 offset:32768
    ds_read_b64_tr_b16 v[50:51], v15 offset:33280
    s_waitcnt lgkmcnt(12)
    v_mfma_f32_32x32x16_bf16 v[128:143], v[84:87], a[28:31], v[128:143]
    s_add_u32 m0, s47, 0
    s_add_u32 s50, s46, 1376256
    buffer_load_dwordx4 v10, s[20:23], s50 offen lds
    ds_read_b64_tr_b16 v[52:53], v12 offset:34816
    ds_read_b64_tr_b16 v[54:55], v12 offset:35328
    v_mfma_f32_32x32x16_bf16 v[144:159], v[88:91], a[28:31], v[144:159]
    ds_read_b64_tr_b16 v[56:57], v13 offset:34816
    ds_read_b64_tr_b16 v[58:59], v13 offset:35328
    s_waitcnt lgkmcnt(12)
    v_mfma_f32_32x32x16_bf16 v[160:175], v[92:95], a[28:31], v[160:175]
    s_add_u32 s50, s49, 24576
    buffer_load_dwordx4 a[96:99], v11, s[32:35], s50 offen sc1
    ds_read_b64_tr_b16 v[60:61], v14 offset:34816
    ds_read_b64_tr_b16 v[62:63], v14 offset:35328
    v_mfma_f32_32x32x16_bf16 v[176:191], v[96:99], a[28:31], v[176:191]
    ds_read_b64_tr_b16 v[64:65], v15 offset:34816
    ds_read_b64_tr_b16 v[66:67], v15 offset:35328
    s_waitcnt lgkmcnt(12)
    v_mfma_f32_32x32x16_bf16 v[128:143], v[36:39], a[32:35], v[128:143]
    s_add_u32 m0, s47, 1024
    s_add_u32 s50, s46, 1404928
    buffer_load_dwordx4 v10, s[20:23], s50 offen lds
    ds_read_b64_tr_b16 v[68:69], v12 offset:36864
    ds_read_b64_tr_b16 v[70:71], v12 offset:37376
    v_mfma_f32_32x32x16_bf16 v[144:159], v[40:43], a[32:35], v[144:159]
    ds_read_b64_tr_b16 v[72:73], v13 offset:36864
    ds_read_b64_tr_b16 v[74:75], v13 offset:37376
    s_waitcnt lgkmcnt(12)
    v_mfma_f32_32x32x16_bf16 v[160:175], v[44:47], a[32:35], v[160:175]
    s_add_u32 s50, s49, 25600
    buffer_load_dwordx4 a[100:103], v11, s[32:35], s50 offen sc1
    ds_read_b64_tr_b16 v[76:77], v14 offset:36864
    ds_read_b64_tr_b16 v[78:79], v14 offset:37376
    v_mfma_f32_32x32x16_bf16 v[176:191], v[48:51], a[32:35], v[176:191]
    ds_read_b64_tr_b16 v[80:81], v15 offset:36864
    ds_read_b64_tr_b16 v[82:83], v15 offset:37376
    s_waitcnt lgkmcnt(12)
    v_mfma_f32_32x32x16_bf16 v[128:143], v[52:55], a[36:39], v[128:143]
    s_add_u32 m0, s47, 2048
    s_add_u32 s50, s46, 1433600
    buffer_load_dwordx4 v10, s[20:23], s50 offen lds
    ds_read_b64_tr_b16 v[84:85], v12 offset:38912
    ds_read_b64_tr_b16 v[86:87], v12 offset:39424
    v_mfma_f32_32x32x16_bf16 v[144:159], v[56:59], a[36:39], v[144:159]
    ds_read_b64_tr_b16 v[88:89], v13 offset:38912
    ds_read_b64_tr_b16 v[90:91], v13 offset:39424
    s_waitcnt lgkmcnt(12)
    v_mfma_f32_32x32x16_bf16 v[160:175], v[60:63], a[36:39], v[160:175]
    s_add_u32 s50, s49, 26624
    buffer_load_dwordx4 a[104:107], v11, s[32:35], s50 offen sc1
    ds_read_b64_tr_b16 v[92:93], v14 offset:38912
    ds_read_b64_tr_b16 v[94:95], v14 offset:39424
    v_mfma_f32_32x32x16_bf16 v[176:191], v[64:67], a[36:39], v[176:191]
    ds_read_b64_tr_b16 v[96:97], v15 offset:38912
    ds_read_b64_tr_b16 v[98:99], v15 offset:39424
    s_waitcnt lgkmcnt(12)
    v_mfma_f32_32x32x16_bf16 v[128:143], v[68:71], a[40:43], v[128:143]
    s_add_u32 m0, s47, 3072
    s_add_u32 s50, s46, 1462272
    buffer_load_dwordx4 v10, s[20:23], s50 offen lds
    s_waitcnt vmcnt(23)
    s_barrier
    ds_read_b64_tr_b16 v[36:37], v12 offset:49152
    ds_read_b64_tr_b16 v[38:39], v12 offset:49664
    v_mfma_f32_32x32x16_bf16 v[144:159], v[72:75], a[40:43], v[144:159]
    ds_read_b64_tr_b16 v[40:41], v13 offset:49152
    ds_read_b64_tr_b16 v[42:43], v13 offset:49664
    s_waitcnt lgkmcnt(12)
    v_mfma_f32_32x32x16_bf16 v[160:175], v[76:79], a[40:43], v[160:175]
    s_add_u32 s50, s49, 27648
    buffer_load_dwordx4 a[108:111], v11, s[32:35], s50 offen sc1
    ds_read_b64_tr_b16 v[44:45], v14 offset:49152
    ds_read_b64_tr_b16 v[46:47], v14 offset:49664
    v_mfma_f32_32x32x16_bf16 v[176:191], v[80:83], a[40:43], v[176:191]
    ds_read_b64_tr_b16 v[48:49], v15 offset:49152
    ds_read_b64_tr_b16 v[50:51], v15 offset:49664
    s_waitcnt lgkmcnt(12)
    v_mfma_f32_32x32x16_bf16 v[128:143], v[84:87], a[44:47], v[128:143]
    s_add_u32 s50, s52, 0
    buffer_load_dwordx2 v[100:101], v118, s[32:35], s50 offen sc1
    ds_read_b64_tr_b16 v[52:53], v12 offset:51200
    ds_read_b64_tr_b16 v[54:55], v12 offset:51712
    v_mfma_f32_32x32x16_bf16 v[144:159], v[88:91], a[44:47], v[144:159]
    ds_read_b64_tr_b16 v[56:57], v13 offset:51200
    ds_read_b64_tr_b16 v[58:59], v13 offset:51712
    s_waitcnt lgkmcnt(12)
    v_mfma_f32_32x32x16_bf16 v[160:175], v[92:95], a[44:47], v[160:175]
    s_add_u32 s50, s52, 32768
    buffer_load_dwordx2 v[102:103], v118, s[32:35], s50 offen sc1
    ds_read_b64_tr_b16 v[60:61], v14 offset:51200
    ds_read_b64_tr_b16 v[62:63], v14 offset:51712
    v_mfma_f32_32x32x16_bf16 v[176:191], v[96:99], a[44:47], v[176:191]
    ds_read_b64_tr_b16 v[64:65], v15 offset:51200
    ds_read_b64_tr_b16 v[66:67], v15 offset:51712
    s_waitcnt lgkmcnt(12)
    v_mfma_f32_32x32x16_bf16 v[128:143], v[36:39], a[48:51], v[128:143]
    s_add_u32 s50, s52, 65536
    buffer_load_dwordx2 v[104:105], v118, s[32:35], s50 offen sc1
    ds_read_b64_tr_b16 v[68:69], v12 offset:53248
    ds_read_b64_tr_b16 v[70:71], v12 offset:53760
    v_mfma_f32_32x32x16_bf16 v[144:159], v[40:43], a[48:51], v[144:159]
    ds_read_b64_tr_b16 v[72:73], v13 offset:53248
    ds_read_b64_tr_b16 v[74:75], v13 offset:53760
    s_waitcnt lgkmcnt(12)
    v_mfma_f32_32x32x16_bf16 v[160:175], v[44:47], a[48:51], v[160:175]
    s_add_u32 s50, s52, 98304
    buffer_load_dwordx2 v[106:107], v118, s[32:35], s50 offen sc1
    ds_read_b64_tr_b16 v[76:77], v14 offset:53248
    ds_read_b64_tr_b16 v[78:79], v14 offset:53760
    v_mfma_f32_32x32x16_bf16 v[176:191], v[48:51], a[48:51], v[176:191]
    ds_read_b64_tr_b16 v[80:81], v15 offset:53248
    ds_read_b64_tr_b16 v[82:83], v15 offset:53760
    s_waitcnt lgkmcnt(12)
    v_mfma_f32_32x32x16_bf16 v[128:143], v[52:55], a[52:55], v[128:143]
    buffer_load_dwordx4 a[112:115], v9, s[32:35], s53 offen offset:0 sc1
    ds_read_b64_tr_b16 v[84:85], v12 offset:55296
    ds_read_b64_tr_b16 v[86:87], v12 offset:55808
    v_mfma_f32_32x32x16_bf16 v[144:159], v[56:59], a[52:55], v[144:159]
    ds_read_b64_tr_b16 v[88:89], v13 offset:55296
    ds_read_b64_tr_b16 v[90:91], v13 offset:55808
    s_waitcnt lgkmcnt(12)
    v_mfma_f32_32x32x16_bf16 v[160:175], v[60:63], a[52:55], v[160:175]
    buffer_load_dwordx4 a[116:119], v9, s[32:35], s53 offen offset:16 sc1
    ds_read_b64_tr_b16 v[92:93], v14 offset:55296
    ds_read_b64_tr_b16 v[94:95], v14 offset:55808
    v_mfma_f32_32x32x16_bf16 v[176:191], v[64:67], a[52:55], v[176:191]
    ds_read_b64_tr_b16 v[96:97], v15 offset:55296
    ds_read_b64_tr_b16 v[98:99], v15 offset:55808
    s_waitcnt lgkmcnt(12)
    v_mfma_f32_32x32x16_bf16 v[128:143], v[68:71], a[56:59], v[128:143]
    buffer_load_dwordx4 a[120:123], v9, s[32:35], s55 offen offset:0 sc1
    s_waitcnt vmcnt(23)
    s_barrier
    ds_read_b64_tr_b16 v[36:37], v16 offset:0
    ds_read_b64_tr_b16 v[38:39], v16 offset:512
    v_mfma_f32_32x32x16_bf16 v[144:159], v[72:75], a[56:59], v[144:159]
    ds_read_b64_tr_b16 v[40:41], v17 offset:0
    ds_read_b64_tr_b16 v[42:43], v17 offset:512
    s_waitcnt lgkmcnt(12)
    v_mfma_f32_32x32x16_bf16 v[160:175], v[76:79], a[56:59], v[160:175]
    buffer_load_dwordx4 a[124:127], v9, s[32:35], s55 offen offset:16 sc1
    ds_read_b64_tr_b16 v[44:45], v18 offset:0
    ds_read_b64_tr_b16 v[46:47], v18 offset:512
    v_mfma_f32_32x32x16_bf16 v[176:191], v[80:83], a[56:59], v[176:191]
    ds_read_b64_tr_b16 v[48:49], v19 offset:0
    ds_read_b64_tr_b16 v[50:51], v19 offset:512
    s_waitcnt lgkmcnt(12)
    v_mfma_f32_32x32x16_bf16 v[128:143], v[84:87], a[60:63], v[128:143]
    s_add_u32 m0, s47, 16384
    s_add_u32 s50, s56, 0
    buffer_load_dwordx4 v10, s[20:23], s50 offen lds
    ds_read_b64_tr_b16 v[52:53], v16 offset:2048
    ds_read_b64_tr_b16 v[54:55], v16 offset:2560
    v_mfma_f32_32x32x16_bf16 v[144:159], v[88:91], a[60:63], v[144:159]
    ds_read_b64_tr_b16 v[56:57], v17 offset:2048
    ds_read_b64_tr_b16 v[58:59], v17 offset:2560
    s_waitcnt lgkmcnt(12)
    v_mfma_f32_32x32x16_bf16 v[160:175], v[92:95], a[60:63], v[160:175]
    s_add_u32 m0, s47, 17408
    s_add_u32 s50, s56, 28672
    buffer_load_dwordx4 v10, s[20:23], s50 offen lds
    ds_read_b64_tr_b16 v[60:61], v18 offset:2048
    ds_read_b64_tr_b16 v[62:63], v18 offset:2560
    v_mfma_f32_32x32x16_bf16 v[176:191], v[96:99], a[60:63], v[176:191]
    ds_read_b64_tr_b16 v[64:65], v19 offset:2048
    ds_read_b64_tr_b16 v[66:67], v19 offset:2560
    s_waitcnt lgkmcnt(12)
    v_mfma_f32_32x32x16_bf16 v[128:143], v[36:39], a[64:67], v[128:143]
    s_add_u32 m0, s47, 18432
    s_add_u32 s50, s56, 57344
    buffer_load_dwordx4 v10, s[20:23], s50 offen lds
    ds_read_b64_tr_b16 v[68:69], v16 offset:4096
    ds_read_b64_tr_b16 v[70:71], v16 offset:4608
    v_mfma_f32_32x32x16_bf16 v[144:159], v[40:43], a[64:67], v[144:159]
    ds_read_b64_tr_b16 v[72:73], v17 offset:4096
    ds_read_b64_tr_b16 v[74:75], v17 offset:4608
    s_waitcnt lgkmcnt(12)
    v_mfma_f32_32x32x16_bf16 v[160:175], v[44:47], a[64:67], v[160:175]
    s_add_u32 m0, s47, 19456
    s_add_u32 s50, s56, 86016
    buffer_load_dwordx4 v10, s[20:23], s50 offen lds
    ds_read_b64_tr_b16 v[76:77], v18 offset:4096
    ds_read_b64_tr_b16 v[78:79], v18 offset:4608
    v_mfma_f32_32x32x16_bf16 v[176:191], v[48:51], a[64:67], v[176:191]
    ds_read_b64_tr_b16 v[80:81], v19 offset:4096
    ds_read_b64_tr_b16 v[82:83], v19 offset:4608
    s_waitcnt lgkmcnt(12)
    v_mfma_f32_32x32x16_bf16 v[128:143], v[52:55], a[68:71], v[128:143]
    s_add_u32 m0, s47, 32768
    s_add_u32 s50, s56, 229376
    buffer_load_dwordx4 v10, s[20:23], s50 offen lds
    ds_read_b64_tr_b16 v[84:85], v16 offset:6144
    ds_read_b64_tr_b16 v[86:87], v16 offset:6656
    v_mfma_f32_32x32x16_bf16 v[144:159], v[56:59], a[68:71], v[144:159]
    ds_read_b64_tr_b16 v[88:89], v17 offset:6144
    ds_read_b64_tr_b16 v[90:91], v17 offset:6656
    s_waitcnt lgkmcnt(12)
    v_mfma_f32_32x32x16_bf16 v[160:175], v[60:63], a[68:71], v[160:175]
    s_add_u32 m0, s47, 33792
    s_add_u32 s50, s56, 258048
    buffer_load_dwordx4 v10, s[20:23], s50 offen lds
    ds_read_b64_tr_b16 v[92:93], v18 offset:6144
    ds_read_b64_tr_b16 v[94:95], v18 offset:6656
    v_mfma_f32_32x32x16_bf16 v[176:191], v[64:67], a[68:71], v[176:191]
    ds_read_b64_tr_b16 v[96:97], v19 offset:6144
    ds_read_b64_tr_b16 v[98:99], v19 offset:6656
    s_waitcnt lgkmcnt(12)
    v_mfma_f32_32x32x16_bf16 v[128:143], v[68:71], a[72:75], v[128:143]
    s_add_u32 m0, s47, 34816
    s_add_u32 s50, s56, 286720
    buffer_load_dwordx4 v10, s[20:23], s50 offen lds
    s_waitcnt vmcnt(23)
    s_barrier
    ds_read_b64_tr_b16 v[36:37], v16 offset:16384
    ds_read_b64_tr_b16 v[38:39], v16 offset:16896
    v_mfma_f32_32x32x16_bf16 v[144:159], v[72:75], a[72:75], v[144:159]
    ds_read_b64_tr_b16 v[40:41], v17 offset:16384
    ds_read_b64_tr_b16 v[42:43], v17 offset:16896
    s_waitcnt lgkmcnt(12)
    v_mfma_f32_32x32x16_bf16 v[160:175], v[76:79], a[72:75], v[160:175]
    s_add_u32 m0, s47, 35840
    s_add_u32 s50, s56, 315392
    buffer_load_dwordx4 v10, s[20:23], s50 offen lds
    ds_read_b64_tr_b16 v[44:45], v18 offset:16384
    ds_read_b64_tr_b16 v[46:47], v18 offset:16896
    v_mfma_f32_32x32x16_bf16 v[176:191], v[80:83], a[72:75], v[176:191]
    ds_read_b64_tr_b16 v[48:49], v19 offset:16384
    ds_read_b64_tr_b16 v[50:51], v19 offset:16896
    s_waitcnt lgkmcnt(12)
    v_mfma_f32_32x32x16_bf16 v[128:143], v[84:87], a[76:79], v[128:143]
    s_add_u32 m0, s47, 49152
    s_add_u32 s50, s56, 458752
    buffer_load_dwordx4 v10, s[20:23], s50 offen lds
    ds_read_b64_tr_b16 v[52:53], v16 offset:18432
    ds_read_b64_tr_b16 v[54:55], v16 offset:18944
    v_mfma_f32_32x32x16_bf16 v[144:159], v[88:91], a[76:79], v[144:159]
    ds_read_b64_tr_b16 v[56:57], v17 offset:18432
    ds_read_b64_tr_b16 v[58:59], v17 offset:18944
    s_waitcnt lgkmcnt(12)
    v_mfma_f32_32x32x16_bf16 v[160:175], v[92:95], a[76:79], v[160:175]
    s_add_u32 m0, s47, 50176
    s_add_u32 s50, s56, 487424
    buffer_load_dwordx4 v10, s[20:23], s50 offen lds
    ds_read_b64_tr_b16 v[60:61], v18 offset:18432
    ds_read_b64_tr_b16 v[62:63], v18 offset:18944
    v_mfma_f32_32x32x16_bf16 v[176:191], v[96:99], a[76:79], v[176:191]
    ds_read_b64_tr_b16 v[64:65], v19 offset:18432
    ds_read_b64_tr_b16 v[66:67], v19 offset:18944
    s_waitcnt lgkmcnt(12)
    v_mfma_f32_32x32x16_bf16 v[128:143], v[36:39], a[80:83], v[128:143]
    s_add_u32 m0, s47, 51200
    s_add_u32 s50, s56, 516096
    buffer_load_dwordx4 v10, s[20:23], s50 offen lds
    ds_read_b64_tr_b16 v[68:69], v16 offset:20480
    ds_read_b64_tr_b16 v[70:71], v16 offset:20992
    v_mfma_f32_32x32x16_bf16 v[144:159], v[40:43], a[80:83], v[144:159]
    ds_read_b64_tr_b16 v[72:73], v17 offset:20480
    ds_read_b64_tr_b16 v[74:75], v17 offset:20992
    s_waitcnt lgkmcnt(12)
    v_mfma_f32_32x32x16_bf16 v[160:175], v[44:47], a[80:83], v[160:175]
    s_add_u32 m0, s47, 52224
    s_add_u32 s50, s56, 544768
    buffer_load_dwordx4 v10, s[20:23], s50 offen lds
    ds_read_b64_tr_b16 v[76:77], v18 offset:20480
    ds_read_b64_tr_b16 v[78:79], v18 offset:20992
    v_mfma_f32_32x32x16_bf16 v[176:191], v[48:51], a[80:83], v[176:191]
    ds_read_b64_tr_b16 v[80:81], v19 offset:20480
    ds_read_b64_tr_b16 v[82:83], v19 offset:20992
    s_waitcnt lgkmcnt(12)
    v_mfma_f32_32x32x16_bf16 v[128:143], v[52:55], a[84:87], v[128:143]
    ds_read_b64_tr_b16 v[84:85], v16 offset:22528
    ds_read_b64_tr_b16 v[86:87], v16 offset:23040
    v_mfma_f32_32x32x16_bf16 v[144:159], v[56:59], a[84:87], v[144:159]
    ds_read_b64_tr_b16 v[88:89], v17 offset:22528
    ds_read_b64_tr_b16 v[90:91], v17 offset:23040
    s_waitcnt lgkmcnt(12)
    v_mfma_f32_32x32x16_bf16 v[160:175], v[60:63], a[84:87], v[160:175]
    ds_read_b64_tr_b16 v[92:93], v18 offset:22528
    ds_read_b64_tr_b16 v[94:95], v18 offset:23040
    v_mfma_f32_32x32x16_bf16 v[176:191], v[64:67], a[84:87], v[176:191]
    ds_read_b64_tr_b16 v[96:97], v19 offset:22528
    ds_read_b64_tr_b16 v[98:99], v19 offset:23040
    s_waitcnt lgkmcnt(12)
    v_mfma_f32_32x32x16_bf16 v[128:143], v[68:71], a[88:91], v[128:143]
    s_waitcnt vmcnt(12)
    v_cmp_gt_u32 vcc, 32, v1
    s_nop 1
    v_cndmask_b32 v106, 0, v106, vcc
    v_cndmask_b32 v107, 0, v107, vcc
    s_waitcnt vmcnt(20)
    s_barrier
    ds_read_b64_tr_b16 v[36:37], v12 offset:0
    ds_read_b64_tr_b16 v[38:39], v12 offset:512
    v_mfma_f32_32x32x16_bf16 v[144:159], v[72:75], a[88:91], v[144:159]
    v_add_f32 v100, v100, v102
    v_add_f32 v101, v101, v103
    v_add_f32 v100, v100, v104
    ds_read_b64_tr_b16 v[40:41], v13 offset:0
    ds_read_b64_tr_b16 v[42:43], v13 offset:512
    s_waitcnt lgkmcnt(12)
    v_mfma_f32_32x32x16_bf16 v[160:175], v[76:79], a[88:91], v[160:175]
    s_add_u32 m0, s47, 65536
    s_add_u32 s50, s56, 688128
    buffer_load_dwordx4 v10, s[20:23], s50 offen lds
    v_add_f32 v101, v101, v105
    v_add_f32 v100, v100, v106
    v_add_f32 v101, v101, v107
    ds_read_b64_tr_b16 v[44:45], v14 offset:0
    ds_read_b64_tr_b16 v[46:47], v14 offset:512
    v_mfma_f32_32x32x16_bf16 v[176:191], v[80:83], a[88:91], v[176:191]
    v_mov_b32 v102, v100
    v_mov_b32 v103, v100
    s_nop 1
    v_permlane32_swap_b32 v102, v103
    ds_read_b64_tr_b16 v[48:49], v15 offset:0
    ds_read_b64_tr_b16 v[50:51], v15 offset:512
    s_waitcnt lgkmcnt(12)
    v_mfma_f32_32x32x16_bf16 v[128:143], v[84:87], a[92:95], v[128:143]
    s_add_u32 m0, s47, 66560
    s_add_u32 s50, s56, 716800
    buffer_load_dwordx4 v10, s[20:23], s50 offen lds
    v_add_f32 v100, v102, v103
    v_mov_b32 v104, v101
    v_mov_b32 v105, v101
    ds_read_b64_tr_b16 v[52:53], v12 offset:2048
    ds_read_b64_tr_b16 v[54:55], v12 offset:2560
    v_mfma_f32_32x32x16_bf16 v[144:159], v[88:91], a[92:95], v[144:159]
    v_permlane32_swap_b32 v104, v105
    v_add_f32 v101, v104, v105
    v_mul_f32 v100, 0x3b124925, v100
    ds_read_b64_tr_b16 v[56:57], v13 offset:2048
    ds_read_b64_tr_b16 v[58:59], v13 offset:2560
    s_waitcnt lgkmcnt(12)
    v_mfma_f32_32x32x16_bf16 v[160:175], v[92:95], a[92:95], v[160:175]
    s_add_u32 m0, s47, 67584
    s_add_u32 s50, s56, 745472
    buffer_load_dwordx4 v10, s[20:23], s50 offen lds
    v_mul_f32 v101, 0x3b124925, v101
    v_fma_f32 v101, -v100, v100, v101
    v_max_f32 v101, 0, v101
    ds_read_b64_tr_b16 v[60:61], v14 offset:2048
    ds_read_b64_tr_b16 v[62:63], v14 offset:2560
    v_mfma_f32_32x32x16_bf16 v[176:191], v[96:99], a[92:95], v[176:191]
    v_cvt_pk_bf16_f32 v100, v101, v100
    v_lshlrev_b32 v101, 16, v100
    v_and_b32 v100, 0xffff0000, v100
    ds_read_b64_tr_b16 v[64:65], v15 offset:2048
    ds_read_b64_tr_b16 v[66:67], v15 offset:2560
    s_waitcnt lgkmcnt(12)
    v_mfma_f32_32x32x16_bf16 v[128:143], v[36:39], a[96:99], v[128:143]
    s_add_u32 m0, s47, 68608
    s_add_u32 s50, s56, 774144
    buffer_load_dwordx4 v10, s[20:23], s50 offen lds
    v_add_f32 v101, 0x3727c5ac, v101
    v_xor_b32 v114, 0x80000000, v100
    v_cvt_pk_bf16_f32 v101, v101, v101
    ds_read_b64_tr_b16 v[68:69], v12 offset:4096
    ds_read_b64_tr_b16 v[70:71], v12 offset:4608
    v_mfma_f32_32x32x16_bf16 v[144:159], v[40:43], a[96:99], v[144:159]
    v_and_b32 v101, 0xffff0000, v101
    v_sqrt_f32 v101, v101
    s_nop 0
    v_cvt_pk_bf16_f32 v116, v101, v101
    ds_read_b64_tr_b16 v[72:73], v13 offset:4096
    ds_read_b64_tr_b16 v[74:75], v13 offset:4608
    s_waitcnt lgkmcnt(12)
    v_mfma_f32_32x32x16_bf16 v[160:175], v[44:47], a[96:99], v[160:175]
    v_and_b32 v116, 0xffff0000, v116
    v_rcp_f32 v115, v116
    s_nop 0
    v_mul_f32 v117, 0xbfb8aa3b, v115
    ds_read_b64_tr_b16 v[76:77], v14 offset:4096
    ds_read_b64_tr_b16 v[78:79], v14 offset:4608
    v_mfma_f32_32x32x16_bf16 v[176:191], v[48:51], a[96:99], v[176:191]
    v_lshrrev_b32 v104, 16, v114
    v_cmp_gt_u32 vcc, 32, v1
    s_nop 1
    v_cndmask_b32 v104, 0, v104, vcc
    ds_read_b64_tr_b16 v[80:81], v15 offset:4096
    ds_read_b64_tr_b16 v[82:83], v15 offset:4608
    s_waitcnt lgkmcnt(12)
    v_mfma_f32_32x32x16_bf16 v[128:143], v[52:55], a[100:103], v[128:143]
    v_mov_b32 v105, v104
    v_mov_b32 v106, 0
    v_mov_b32 v107, 0
    ds_read_b64_tr_b16 v[84:85], v12 offset:6144
    ds_read_b64_tr_b16 v[86:87], v12 offset:6656
    v_mfma_f32_32x32x16_bf16 v[144:159], v[56:59], a[100:103], v[144:159]
    ds_read_b64_tr_b16 v[88:89], v13 offset:6144
    ds_read_b64_tr_b16 v[90:91], v13 offset:6656
    s_waitcnt lgkmcnt(12)
    v_mfma_f32_32x32x16_bf16 v[160:175], v[60:63], a[100:103], v[160:175]
    ds_read_b64_tr_b16 v[92:93], v14 offset:6144
    ds_read_b64_tr_b16 v[94:95], v14 offset:6656
    v_mfma_f32_32x32x16_bf16 v[176:191], v[64:67], a[100:103], v[176:191]
    ds_read_b64_tr_b16 v[96:97], v15 offset:6144
    ds_read_b64_tr_b16 v[98:99], v15 offset:6656
    s_waitcnt lgkmcnt(12)
    v_mfma_f32_32x32x16_bf16 v[128:143], v[68:71], a[104:107], v[128:143]
    s_waitcnt vmcnt(12)
    s_barrier
    ds_read_b64_tr_b16 v[36:37], v12 offset:16384
    ds_read_b64_tr_b16 v[38:39], v12 offset:16896
    v_mfma_f32_32x32x16_bf16 v[144:159], v[72:75], a[104:107], v[144:159]
    ds_read_b64_tr_b16 v[40:41], v13 offset:16384
    ds_read_b64_tr_b16 v[42:43], v13 offset:16896
    s_waitcnt lgkmcnt(12)
    v_mfma_f32_32x32x16_bf16 v[160:175], v[76:79], a[104:107], v[160:175]
    s_add_u32 m0, s47, 81920
    s_add_u32 s50, s56, 917504
    buffer_load_dwordx4 v10, s[20:23], s50 offen lds
    ds_read_b64_tr_b16 v[44:45], v14 offset:16384
    ds_read_b64_tr_b16 v[46:47], v14 offset:16896
    v_mfma_f32_32x32x16_bf16 v[176:191], v[80:83], a[104:107], v[176:191]
    ds_read_b64_tr_b16 v[48:49], v15 offset:16384
    ds_read_b64_tr_b16 v[50:51], v15 offset:16896
    s_waitcnt lgkmcnt(12)
    v_mfma_f32_32x32x16_bf16 v[128:143], v[84:87], a[108:111], v[128:143]
    v_mfma_f32_32x32x16_bf16 v[128:143], a[112:115], v[104:107], v[128:143]
    s_add_u32 m0, s47, 82944
    s_add_u32 s50, s56, 946176
    buffer_load_dwordx4 v10, s[20:23], s50 offen lds
    ds_read_b64_tr_b16 v[52:53], v12 offset:18432
    ds_read_b64_tr_b16 v[54:55], v12 offset:18944
    v_mfma_f32_32x32x16_bf16 v[144:159], v[88:91], a[108:111], v[144:159]
    v_mfma_f32_32x32x16_bf16 v[144:159], a[114:117], v[104:107], v[144:159]
    ds_read_b64_tr_b16 v[56:57], v13 offset:18432
    ds_read_b64_tr_b16 v[58:59], v13 offset:18944
    s_waitcnt lgkmcnt(12)
    v_mfma_f32_32x32x16_bf16 v[160:175], v[92:95], a[108:111], v[160:175]
    v_mfma_f32_32x32x16_bf16 v[160:175], a[116:119], v[104:107], v[160:175]
    s_add_u32 m0, s47, 83968
    s_add_u32 s50, s56, 974848
    buffer_load_dwordx4 v10, s[20:23], s50 offen lds
    ds_read_b64_tr_b16 v[60:61], v14 offset:18432
    ds_read_b64_tr_b16 v[62:63], v14 offset:18944
    v_mfma_f32_32x32x16_bf16 v[176:191], v[96:99], a[108:111], v[176:191]
    v_mfma_f32_32x32x16_bf16 v[176:191], a[118:121], v[104:107], v[176:191]
    ds_read_b64_tr_b16 v[64:65], v15 offset:18432
    ds_read_b64_tr_b16 v[66:67], v15 offset:18944
    s_waitcnt lgkmcnt(12)
    v_mfma_f32_32x32x16_bf16 v[192:207], v[36:39], a[0:3], 0
    s_add_u32 m0, s47, 84992
    s_add_u32 s50, s56, 1003520
    buffer_load_dwordx4 v10, s[20:23], s50 offen lds
    v_mul_f32 v128, v117, v128
    v_mul_f32 v129, v117, v129
    v_mul_f32 v130, v117, v130
    ds_read_b64_tr_b16 v[68:69], v12 offset:20480
    ds_read_b64_tr_b16 v[70:71], v12 offset:20992
    v_mfma_f32_32x32x16_bf16 v[208:223], v[40:43], a[0:3], 0
    v_mul_f32 v131, v117, v131
    v_mul_f32 v132, v117, v132
    v_mul_f32 v133, v117, v133
    ds_read_b64_tr_b16 v[72:73], v13 offset:20480
    ds_read_b64_tr_b16 v[74:75], v13 offset:20992
    s_waitcnt lgkmcnt(12)
    v_mfma_f32_32x32x16_bf16 v[224:239], v[44:47], a[0:3], 0
    v_mul_f32 v134, v117, v134
    v_mul_f32 v135, v117, v135
    v_exp_f32 v128, v128
    ds_read_b64_tr_b16 v[76:77], v14 offset:20480
    ds_read_b64_tr_b16 v[78:79], v14 offset:20992
    v_mfma_f32_32x32x16_bf16 v[240:255], v[48:51], a[0:3], 0
    v_exp_f32 v129, v129
    v_exp_f32 v130, v130
    v_exp_f32 v131, v131
    ds_read_b64_tr_b16 v[80:81], v15 offset:20480
    ds_read_b64_tr_b16 v[82:83], v15 offset:20992
    s_waitcnt lgkmcnt(12)
    v_mfma_f32_32x32x16_bf16 v[192:207], v[52:55], a[4:7], v[192:207]
    v_exp_f32 v132, v132
    v_exp_f32 v133, v133
    v_exp_f32 v134, v134
    ds_read_b64_tr_b16 v[84:85], v12 offset:22528
    ds_read_b64_tr_b16 v[86:87], v12 offset:23040
    v_mfma_f32_32x32x16_bf16 v[208:223], v[56:59], a[4:7], v[208:223]
    v_exp_f32 v135, v135
    v_fma_f32 v128, v128, v116, v116
    v_fma_f32 v129, v129, v116, v116
    ds_read_b64_tr_b16 v[88:89], v13 offset:22528
    ds_read_b64_tr_b16 v[90:91], v13 offset:23040
    s_waitcnt lgkmcnt(12)
    v_mfma_f32_32x32x16_bf16 v[224:239], v[60:63], a[4:7], v[224:239]
    v_fma_f32 v130, v130, v116, v116
    v_fma_f32 v131, v131, v116, v116
    v_fma_f32 v132, v132, v116, v116
    ds_read_b64_tr_b16 v[92:93], v14 offset:22528
    ds_read_b64_tr_b16 v[94:95], v14 offset:23040
    v_mfma_f32_32x32x16_bf16 v[240:255], v[64:67], a[4:7], v[240:255]
    v_fma_f32 v133, v133, v116, v116
    v_fma_f32 v134, v134, v116, v116
    v_fma_f32 v135, v135, v116, v116
    ds_read_b64_tr_b16 v[96:97], v15 offset:22528
    ds_read_b64_tr_b16 v[98:99], v15 offset:23040
    s_waitcnt lgkmcnt(12)
    v_mfma_f32_32x32x16_bf16 v[192:207], v[68:71], a[8:11], v[192:207]
    v_rcp_f32 v128, v128
    v_rcp_f32 v129, v129
    v_rcp_f32 v130, v130
    s_waitcnt vmcnt(12)
    s_barrier
    ds_read_b64_tr_b16 v[36:37], v12 offset:32768
    ds_read_b64_tr_b16 v[38:39], v12 offset:33280
    v_mfma_f32_32x32x16_bf16 v[208:223], v[72:75], a[8:11], v[208:223]
    v_rcp_f32 v131, v131
    v_rcp_f32 v132, v132
    v_rcp_f32 v133, v133
    ds_read_b64_tr_b16 v[40:41], v13 offset:32768
    ds_read_b64_tr_b16 v[42:43], v13 offset:33280
    s_waitcnt lgkmcnt(12)
    v_mfma_f32_32x32x16_bf16 v[224:239], v[76:79], a[8:11], v[224:239]
    s_add_u32 m0, s47, 0
    s_add_u32 s50, s56, 1146880
    buffer_load_dwordx4 v10, s[20:23], s50 offen lds
    v_rcp_f32 v134, v134
    v_rcp_f32 v135, v135
    v_mul_f32 v136, v136, v128
    ds_read_b64_tr_b16 v[44:45], v14 offset:32768
    ds_read_b64_tr_b16 v[46:47], v14 offset:33280
    v_mfma_f32_32x32x16_bf16 v[240:255], v[80:83], a[8:11], v[240:255]
    v_mul_f32 v137, v137, v129
    v_mul_f32 v138, v138, v130
    v_mul_f32 v139, v139, v131
    ds_read_b64_tr_b16 v[48:49], v15 offset:32768
    ds_read_b64_tr_b16 v[50:51], v15 offset:33280
    s_waitcnt lgkmcnt(12)
    v_mfma_f32_32x32x16_bf16 v[192:207], v[84:87], a[12:15], v[192:207]
    s_add_u32 m0, s47, 1024
    s_add_u32 s50, s56, 1175552
    buffer_load_dwordx4 v10, s[20:23], s50 offen lds
    v_mul_f32 v140, v140, v132
    v_mul_f32 v141, v141, v133
    v_mul_f32 v142, v142, v134
    ds_read_b64_tr_b16 v[52:53], v12 offset:34816
    ds_read_b64_tr_b16 v[54:55], v12 offset:35328
    v_mfma_f32_32x32x16_bf16 v[208:223], v[88:91], a[12:15], v[208:223]
    v_mul_f32 v143, v143, v135
    v_cvt_pk_bf16_f32 v128, v136, v137
    v_cvt_pk_bf16_f32 v129, v138, v139
    ds_read_b64_tr_b16 v[56:57], v13 offset:34816
    ds_read_b64_tr_b16 v[58:59], v13 offset:35328
    s_waitcnt lgkmcnt(12)
    v_mfma_f32_32x32x16_bf16 v[224:239], v[92:95], a[12:15], v[224:239]
    s_add_u32 m0, s47, 2048
    s_add_u32 s50, s56, 1204224
    buffer_load_dwordx4 v10, s[20:23], s50 offen lds
    v_cvt_pk_bf16_f32 v130, v140, v141
    v_cvt_pk_bf16_f32 v131, v142, v143
    s_add_u32 s50, s54, 0
    buffer_store_dwordx4 v[128:131], v11, s[32:35], s50 offen sc1
    ds_read_b64_tr_b16 v[60:61], v14 offset:34816
    ds_read_b64_tr_b16 v[62:63], v14 offset:35328
    v_mfma_f32_32x32x16_bf16 v[240:255], v[96:99], a[12:15], v[240:255]
    v_mul_f32 v144, v117, v144
    v_mul_f32 v145, v117, v145
    v_mul_f32 v146, v117, v146
    ds_read_b64_tr_b16 v[64:65], v15 offset:34816
    ds_read_b64_tr_b16 v[66:67], v15 offset:35328
    s_waitcnt lgkmcnt(12)
    v_mfma_f32_32x32x16_bf16 v[192:207], v[36:39], a[16:19], v[192:207]
    s_add_u32 m0, s47, 3072
    s_add_u32 s50, s56, 1232896
    buffer_load_dwordx4 v10, s[20:23], s50 offen lds
    v_mul_f32 v147, v117, v147
    v_mul_f32 v148, v117, v148
    v_mul_f32 v149, v117, v149
    ds_read_b64_tr_b16 v[68:69], v12 offset:36864
    ds_read_b64_tr_b16 v[70:71], v12 offset:37376
    v_mfma_f32_32x32x16_bf16 v[208:223], v[40:43], a[16:19], v[208:223]
    v_mul_f32 v150, v117, v150
    v_mul_f32 v151, v117, v151
    v_exp_f32 v144, v144
    ds_read_b64_tr_b16 v[72:73], v13 offset:36864
    ds_read_b64_tr_b16 v[74:75], v13 offset:37376
    s_waitcnt lgkmcnt(12)
    v_mfma_f32_32x32x16_bf16 v[224:239], v[44:47], a[16:19], v[224:239]
    v_exp_f32 v145, v145
    v_exp_f32 v146, v146
    v_exp_f32 v147, v147
    ds_read_b64_tr_b16 v[76:77], v14 offset:36864
    ds_read_b64_tr_b16 v[78:79], v14 offset:37376
    v_mfma_f32_32x32x16_bf16 v[240:255], v[48:51], a[16:19], v[240:255]
    v_exp_f32 v148, v148
    v_exp_f32 v149, v149
    v_exp_f32 v150, v150
    ds_read_b64_tr_b16 v[80:81], v15 offset:36864
    ds_read_b64_tr_b16 v[82:83], v15 offset:37376
    s_waitcnt lgkmcnt(12)
    v_mfma_f32_32x32x16_bf16 v[192:207], v[52:55], a[20:23], v[192:207]
    v_exp_f32 v151, v151
    v_fma_f32 v144, v144, v116, v116
    v_fma_f32 v145, v145, v116, v116
    ds_read_b64_tr_b16 v[84:85], v12 offset:38912
    ds_read_b64_tr_b16 v[86:87], v12 offset:39424
    v_mfma_f32_32x32x16_bf16 v[208:223], v[56:59], a[20:23], v[208:223]
    v_fma_f32 v146, v146, v116, v116
    v_fma_f32 v147, v147, v116, v116
    v_fma_f32 v148, v148, v116, v116
    ds_read_b64_tr_b16 v[88:89], v13 offset:38912
    ds_read_b64_tr_b16 v[90:91], v13 offset:39424
    s_waitcnt lgkmcnt(12)
    v_mfma_f32_32x32x16_bf16 v[224:239], v[60:63], a[20:23], v[224:239]
    v_fma_f32 v149, v149, v116, v116
    v_fma_f32 v150, v150, v116, v116
    v_fma_f32 v151, v151, v116, v116
    ds_read_b64_tr_b16 v[92:93], v14 offset:38912
    ds_read_b64_tr_b16 v[94:95], v14 offset:39424
    v_mfma_f32_32x32x16_bf16 v[240:255], v[64:67], a[20:23], v[240:255]
    v_rcp_f32 v144, v144
    v_rcp_f32 v145, v145
    v_rcp_f32 v146, v146
    ds_read_b64_tr_b16 v[96:97], v15 offset:38912
    ds_read_b64_tr_b16 v[98:99], v15 offset:39424
    s_waitcnt lgkmcnt(12)
    v_mfma_f32_32x32x16_bf16 v[192:207], v[68:71], a[24:27], v[192:207]
    v_rcp_f32 v147, v147
    v_rcp_f32 v148, v148
    v_rcp_f32 v149, v149
    s_waitcnt vmcnt(13)
    s_barrier
    ds_read_b64_tr_b16 v[36:37], v12 offset:49152
    ds_read_b64_tr_b16 v[38:39], v12 offset:49664
    v_mfma_f32_32x32x16_bf16 v[208:223], v[72:75], a[24:27], v[208:223]
    v_rcp_f32 v150, v150
    v_rcp_f32 v151, v151
    v_mul_f32 v152, v152, v144
    ds_read_b64_tr_b16 v[40:41], v13 offset:49152
    ds_read_b64_tr_b16 v[42:43], v13 offset:49664
    s_waitcnt lgkmcnt(12)
    v_mfma_f32_32x32x16_bf16 v[224:239], v[76:79], a[24:27], v[224:239]
    s_add_u32 m0, s47, 16384
    s_add_u32 s50, s56, 1376256
    buffer_load_dwordx4 v10, s[20:23], s50 offen lds
    v_mul_f32 v153, v153, v145
    v_mul_f32 v154, v154, v146
    v_mul_f32 v155, v155, v147
    ds_read_b64_tr_b16 v[44:45], v14 offset:49152
    ds_read_b64_tr_b16 v[46:47], v14 offset:49664
    v_mfma_f32_32x32x16_bf16 v[240:255], v[80:83], a[24:27], v[240:255]
    v_mul_f32 v156, v156, v148
    v_mul_f32 v157, v157, v149
    v_mul_f32 v158, v158, v150
    ds_read_b64_tr_b16 v[48:49], v15 offset:49152
    ds_read_b64_tr_b16 v[50:51], v15 offset:49664
    s_waitcnt lgkmcnt(12)
    v_mfma_f32_32x32x16_bf16 v[192:207], v[84:87], a[28:31], v[192:207]
    s_add_u32 m0, s47, 17408
    s_add_u32 s50, s56, 1404928
    buffer_load_dwordx4 v10, s[20:23], s50 offen lds
    v_mul_f32 v159, v159, v151
    v_cvt_pk_bf16_f32 v144, v152, v153
    v_cvt_pk_bf16_f32 v145, v154, v155
    ds_read_b64_tr_b16 v[52:53], v12 offset:51200
    ds_read_b64_tr_b16 v[54:55], v12 offset:51712
    v_mfma_f32_32x32x16_bf16 v[208:223], v[88:91], a[28:31], v[208:223]
    v_cvt_pk_bf16_f32 v146, v156, v157
    v_cvt_pk_bf16_f32 v147, v158, v159
    s_add_u32 s50, s54, 1024
    buffer_store_dwordx4 v[144:147], v11, s[32:35], s50 offen sc1
    ds_read_b64_tr_b16 v[56:57], v13 offset:51200
    ds_read_b64_tr_b16 v[58:59], v13 offset:51712
    s_waitcnt lgkmcnt(12)
    v_mfma_f32_32x32x16_bf16 v[224:239], v[92:95], a[28:31], v[224:239]
    s_add_u32 m0, s47, 18432
    s_add_u32 s50, s56, 1433600
    buffer_load_dwordx4 v10, s[20:23], s50 offen lds
    v_mul_f32 v160, v117, v160
    v_mul_f32 v161, v117, v161
    v_mul_f32 v162, v117, v162
    ds_read_b64_tr_b16 v[60:61], v14 offset:51200
    ds_read_b64_tr_b16 v[62:63], v14 offset:51712
    v_mfma_f32_32x32x16_bf16 v[240:255], v[96:99], a[28:31], v[240:255]
    v_mul_f32 v163, v117, v163
    v_mul_f32 v164, v117, v164
    v_mul_f32 v165, v117, v165
    ds_read_b64_tr_b16 v[64:65], v15 offset:51200
    ds_read_b64_tr_b16 v[66:67], v15 offset:51712
    s_waitcnt lgkmcnt(12)
    v_mfma_f32_32x32x16_bf16 v[192:207], v[36:39], a[32:35], v[192:207]
    s_add_u32 m0, s47, 19456
    s_add_u32 s50, s56, 1462272
    buffer_load_dwordx4 v10, s[20:23], s50 offen lds
    v_mul_f32 v166, v117, v166
    v_mul_f32 v167, v117, v167
    v_exp_f32 v160, v160
    ds_read_b64_tr_b16 v[68:69], v12 offset:53248
    ds_read_b64_tr_b16 v[70:71], v12 offset:53760
    v_mfma_f32_32x32x16_bf16 v[208:223], v[40:43], a[32:35], v[208:223]
    v_exp_f32 v161, v161
    v_exp_f32 v162, v162
    v_exp_f32 v163, v163
    ds_read_b64_tr_b16 v[72:73], v13 offset:53248
    ds_read_b64_tr_b16 v[74:75], v13 offset:53760
    s_waitcnt lgkmcnt(12)
    v_mfma_f32_32x32x16_bf16 v[224:239], v[44:47], a[32:35], v[224:239]
    s_add_u32 m0, s79, 0
    s_mul_i32 s50, s68, 14
    s_add_u32 s50, s50, s42
    buffer_load_dwordx4 v27, s[16:19], s50 offen lds
    v_exp_f32 v164, v164
    v_exp_f32 v165, v165
    v_exp_f32 v166, v166
    ds_read_b64_tr_b16 v[76:77], v14 offset:53248
    ds_read_b64_tr_b16 v[78:79], v14 offset:53760
    v_mfma_f32_32x32x16_bf16 v[240:255], v[48:51], a[32:35], v[240:255]
    v_exp_f32 v167, v167
    v_fma_f32 v160, v160, v116, v116
    v_fma_f32 v161, v161, v116, v116
    ds_read_b64_tr_b16 v[80:81], v15 offset:53248
    ds_read_b64_tr_b16 v[82:83], v15 offset:53760
    s_waitcnt lgkmcnt(12)
    v_mfma_f32_32x32x16_bf16 v[192:207], v[52:55], a[36:39], v[192:207]
    s_add_u32 m0, s79, 1024
    s_mul_i32 s50, s68, 14
    s_add_u32 s50, s50, s42
    buffer_load_dwordx4 v34, s[16:19], s50 offen lds
    v_fma_f32 v162, v162, v116, v116
    v_fma_f32 v163, v163, v116, v116
    v_fma_f32 v164, v164, v116, v116
    ds_read_b64_tr_b16 v[84:85], v12 offset:55296
    ds_read_b64_tr_b16 v[86:87], v12 offset:55808
    v_mfma_f32_32x32x16_bf16 v[208:223], v[56:59], a[36:39], v[208:223]
    v_fma_f32 v165, v165, v116, v116
    v_fma_f32 v166, v166, v116, v116
    v_fma_f32 v167, v167, v116, v116
    ds_read_b64_tr_b16 v[88:89], v13 offset:55296
    ds_read_b64_tr_b16 v[90:91], v13 offset:55808
    s_waitcnt lgkmcnt(12)
    v_mfma_f32_32x32x16_bf16 v[224:239], v[60:63], a[36:39], v[224:239]
    s_add_u32 m0, s79, 2048
    s_mul_i32 s50, s69, 14
    s_add_u32 s50, s50, s42
    buffer_load_dwordx4 v27, s[16:19], s50 offen lds
    v_rcp_f32 v160, v160
    v_rcp_f32 v161, v161
    v_rcp_f32 v162, v162
    ds_read_b64_tr_b16 v[92:93], v14 offset:55296
    ds_read_b64_tr_b16 v[94:95], v14 offset:55808
    v_mfma_f32_32x32x16_bf16 v[240:255], v[64:67], a[36:39], v[240:255]
    v_rcp_f32 v163, v163
    v_rcp_f32 v164, v164
    v_rcp_f32 v165, v165
    ds_read_b64_tr_b16 v[96:97], v15 offset:55296
    ds_read_b64_tr_b16 v[98:99], v15 offset:55808
    s_waitcnt lgkmcnt(12)
    v_mfma_f32_32x32x16_bf16 v[192:207], v[68:71], a[40:43], v[192:207]
    s_add_u32 m0, s79, 3072
    s_mul_i32 s50, s69, 14
    s_add_u32 s50, s50, s42
    buffer_load_dwordx4 v34, s[16:19], s50 offen lds
    v_rcp_f32 v166, v166
    v_rcp_f32 v167, v167
    v_mul_f32 v168, v168, v160
    s_waitcnt vmcnt(18)
    s_barrier
    ds_read_b64_tr_b16 v[36:37], v16 offset:0
    ds_read_b64_tr_b16 v[38:39], v16 offset:512
    v_mfma_f32_32x32x16_bf16 v[208:223], v[72:75], a[40:43], v[208:223]
    v_mul_f32 v169, v169, v161
    v_mul_f32 v170, v170, v162
    v_mul_f32 v171, v171, v163
    ds_read_b64_tr_b16 v[40:41], v17 offset:0
    ds_read_b64_tr_b16 v[42:43], v17 offset:512
    s_waitcnt lgkmcnt(12)
    v_mfma_f32_32x32x16_bf16 v[224:239], v[76:79], a[40:43], v[224:239]
    s_add_u32 m0, s79, 4096
    s_mul_i32 s50, s70, 14
    s_add_u32 s50, s50, s42
    buffer_load_dwordx4 v27, s[16:19], s50 offen lds
    v_mul_f32 v172, v172, v164
    v_mul_f32 v173, v173, v165
    v_mul_f32 v174, v174, v166
    ds_read_b64_tr_b16 v[44:45], v18 offset:0
    ds_read_b64_tr_b16 v[46:47], v18 offset:512
    v_mfma_f32_32x32x16_bf16 v[240:255], v[80:83], a[40:43], v[240:255]
    v_mul_f32 v175, v175, v167
    v_cvt_pk_bf16_f32 v160, v168, v169
    v_cvt_pk_bf16_f32 v161, v170, v171
    ds_read_b64_tr_b16 v[48:49], v19 offset:0
    ds_read_b64_tr_b16 v[50:51], v19 offset:512
    s_waitcnt lgkmcnt(12)
    v_mfma_f32_32x32x16_bf16 v[192:207], v[84:87], a[44:47], v[192:207]
    s_add_u32 m0, s79, 5120
    s_mul_i32 s50, s70, 14
    s_add_u32 s50, s50, s42
    buffer_load_dwordx4 v34, s[16:19], s50 offen lds
    v_cvt_pk_bf16_f32 v162, v172, v173
    v_cvt_pk_bf16_f32 v163, v174, v175
    s_add_u32 s50, s54, 2048
    buffer_store_dwordx4 v[160:163], v11, s[32:35], s50 offen sc1
    ds_read_b64_tr_b16 v[52:53], v16 offset:2048
    ds_read_b64_tr_b16 v[54:55], v16 offset:2560
    v_mfma_f32_32x32x16_bf16 v[208:223], v[88:91], a[44:47], v[208:223]
    v_mul_f32 v176, v117, v176
    v_mul_f32 v177, v117, v177
    v_mul_f32 v178, v117, v178
    ds_read_b64_tr_b16 v[56:57], v17 offset:2048
    ds_read_b64_tr_b16 v[58:59], v17 offset:2560
    s_waitcnt lgkmcnt(12)
    v_mfma_f32_32x32x16_bf16 v[224:239], v[92:95], a[44:47], v[224:239]
    s_add_u32 m0, s79, 6144
    s_mul_i32 s50, s71, 14
    s_add_u32 s50, s50, s42
    buffer_load_dwordx4 v27, s[16:19], s50 offen lds
    v_mul_f32 v179, v117, v179
    v_mul_f32 v180, v117, v180
    v_mul_f32 v181, v117, v181
    ds_read_b64_tr_b16 v[60:61], v18 offset:2048
    ds_read_b64_tr_b16 v[62:63], v18 offset:2560
    v_mfma_f32_32x32x16_bf16 v[240:255], v[96:99], a[44:47], v[240:255]
    v_mul_f32 v182, v117, v182
    v_mul_f32 v183, v117, v183
    v_exp_f32 v176, v176
    ds_read_b64_tr_b16 v[64:65], v19 offset:2048
    ds_read_b64_tr_b16 v[66:67], v19 offset:2560
    s_waitcnt lgkmcnt(12)
    v_mfma_f32_32x32x16_bf16 v[192:207], v[36:39], a[48:51], v[192:207]
    s_add_u32 m0, s79, 7168
    s_mul_i32 s50, s71, 14
    s_add_u32 s50, s50, s42
    buffer_load_dwordx4 v34, s[16:19], s50 offen lds
    v_exp_f32 v177, v177
    v_exp_f32 v178, v178
    v_exp_f32 v179, v179
    ds_read_b64_tr_b16 v[68:69], v16 offset:4096
    ds_read_b64_tr_b16 v[70:71], v16 offset:4608
    v_mfma_f32_32x32x16_bf16 v[208:223], v[40:43], a[48:51], v[208:223]
    v_exp_f32 v180, v180
    v_exp_f32 v181, v181
    v_exp_f32 v182, v182
    ds_read_b64_tr_b16 v[72:73], v17 offset:4096
    ds_read_b64_tr_b16 v[74:75], v17 offset:4608
    s_waitcnt lgkmcnt(12)
    v_mfma_f32_32x32x16_bf16 v[224:239], v[44:47], a[48:51], v[224:239]
    s_add_u32 m0, s79, 8192
    s_mul_i32 s50, s72, 14
    s_add_u32 s50, s50, s42
    buffer_load_dwordx4 v27, s[16:19], s50 offen lds
    v_exp_f32 v183, v183
    v_fma_f32 v176, v176, v116, v116
    v_fma_f32 v177, v177, v116, v116
    ds_read_b64_tr_b16 v[76:77], v18 offset:4096
    ds_read_b64_tr_b16 v[78:79], v18 offset:4608
    v_mfma_f32_32x32x16_bf16 v[240:255], v[48:51], a[48:51], v[240:255]
    v_fma_f32 v178, v178, v116, v116
    v_fma_f32 v179, v179, v116, v116
    v_fma_f32 v180, v180, v116, v116
    ds_read_b64_tr_b16 v[80:81], v19 offset:4096
    ds_read_b64_tr_b16 v[82:83], v19 offset:4608
    s_waitcnt lgkmcnt(12)
    v_mfma_f32_32x32x16_bf16 v[192:207], v[52:55], a[52:55], v[192:207]
    s_add_u32 m0, s79, 9216
    s_mul_i32 s50, s72, 14
    s_add_u32 s50, s50, s42
    buffer_load_dwordx4 v34, s[16:19], s50 offen lds
    v_fma_f32 v181, v181, v116, v116
    v_fma_f32 v182, v182, v116, v116
    v_fma_f32 v183, v183, v116, v116
    ds_read_b64_tr_b16 v[84:85], v16 offset:6144
    ds_read_b64_tr_b16 v[86:87], v16 offset:6656
    v_mfma_f32_32x32x16_bf16 v[208:223], v[56:59], a[52:55], v[208:223]
    v_rcp_f32 v176, v176
    v_rcp_f32 v177, v177
    v_rcp_f32 v178, v178
    ds_read_b64_tr_b16 v[88:89], v17 offset:6144
    ds_read_b64_tr_b16 v[90:91], v17 offset:6656
    s_waitcnt lgkmcnt(12)
    v_mfma_f32_32x32x16_bf16 v[224:239], v[60:63], a[52:55], v[224:239]
    s_add_u32 m0, s79, 10240
    s_mul_i32 s50, s73, 14
    s_add_u32 s50, s50, s42
    buffer_load_dwordx4 v27, s[16:19], s50 offen lds
    v_rcp_f32 v179, v179
    v_rcp_f32 v180, v180
    v_rcp_f32 v181, v181
    ds_read_b64_tr_b16 v[92:93], v18 offset:6144
    ds_read_b64_tr_b16 v[94:95], v18 offset:6656
    v_mfma_f32_32x32x16_bf16 v[240:255], v[64:67], a[52:55], v[240:255]
    v_rcp_f32 v182, v182
    v_rcp_f32 v183, v183
    v_mul_f32 v184, v184, v176
    ds_read_b64_tr_b16 v[96:97], v19 offset:6144
    ds_read_b64_tr_b16 v[98:99], v19 offset:6656
    s_waitcnt lgkmcnt(12)
    v_mfma_f32_32x32x16_bf16 v[192:207], v[68:71], a[56:59], v[192:207]
    s_add_u32 m0, s79, 11264
    s_mul_i32 s50, s73, 14
    s_add_u32 s50, s50, s42
    buffer_load_dwordx4 v34, s[16:19], s50 offen lds
    v_mul_f32 v185, v185, v177
    v_mul_f32 v186, v186, v178
    v_mul_f32 v187, v187, v179
    s_waitcnt vmcnt(23)
    s_barrier
    ds_read_b64_tr_b16 v[36:37], v16 offset:16384
    ds_read_b64_tr_b16 v[38:39], v16 offset:16896
    v_mfma_f32_32x32x16_bf16 v[208:223], v[72:75], a[56:59], v[208:223]
    v_mul_f32 v188, v188, v180
    v_mul_f32 v189, v189, v181
    v_mul_f32 v190, v190, v182
    ds_read_b64_tr_b16 v[40:41], v17 offset:16384
    ds_read_b64_tr_b16 v[42:43], v17 offset:16896
    s_waitcnt lgkmcnt(12)
    v_mfma_f32_32x32x16_bf16 v[224:239], v[76:79], a[56:59], v[224:239]
    s_add_u32 m0, s79, 12288
    s_mul_i32 s50, s74, 14
    s_add_u32 s50, s50, s42
    buffer_load_dwordx4 v27, s[16:19], s50 offen lds
    v_mul_f32 v191, v191, v183
    v_cvt_pk_bf16_f32 v176, v184, v185
    v_cvt_pk_bf16_f32 v177, v186, v187
    ds_read_b64_tr_b16 v[44:45], v18 offset:16384
    ds_read_b64_tr_b16 v[46:47], v18 offset:16896
    v_mfma_f32_32x32x16_bf16 v[240:255], v[80:83], a[56:59], v[240:255]
    v_cvt_pk_bf16_f32 v178, v188, v189
    v_cvt_pk_bf16_f32 v179, v190, v191
    s_add_u32 s50, s54, 3072
    buffer_store_dwordx4 v[176:179], v11, s[32:35], s50 offen sc1
    ds_read_b64_tr_b16 v[48:49], v19 offset:16384
    ds_read_b64_tr_b16 v[50:51], v19 offset:16896
    s_waitcnt lgkmcnt(12)
    v_mfma_f32_32x32x16_bf16 v[192:207], v[84:87], a[60:63], v[192:207]
    s_add_u32 m0, s79, 13312
    s_mul_i32 s50, s74, 14
    s_add_u32 s50, s50, s42
    buffer_load_dwordx4 v34, s[16:19], s50 offen lds
    ds_read_b64_tr_b16 v[52:53], v16 offset:18432
    ds_read_b64_tr_b16 v[54:55], v16 offset:18944
    v_mfma_f32_32x32x16_bf16 v[208:223], v[88:91], a[60:63], v[208:223]
    ds_read_b64_tr_b16 v[56:57], v17 offset:18432
    ds_read_b64_tr_b16 v[58:59], v17 offset:18944
    s_waitcnt lgkmcnt(12)
    v_mfma_f32_32x32x16_bf16 v[224:239], v[92:95], a[60:63], v[224:239]
    s_add_u32 m0, s79, 14336
    s_mul_i32 s50, s75, 14
    s_add_u32 s50, s50, s42
    buffer_load_dwordx4 v27, s[16:19], s50 offen lds
    ds_read_b64_tr_b16 v[60:61], v18 offset:18432
    ds_read_b64_tr_b16 v[62:63], v18 offset:18944
    v_mfma_f32_32x32x16_bf16 v[240:255], v[96:99], a[60:63], v[240:255]
    ds_read_b64_tr_b16 v[64:65], v19 offset:18432
    ds_read_b64_tr_b16 v[66:67], v19 offset:18944
    s_waitcnt lgkmcnt(12)
    v_mfma_f32_32x32x16_bf16 v[192:207], v[36:39], a[64:67], v[192:207]
    s_add_u32 m0, s79, 15360
    s_mul_i32 s50, s75, 14
    s_add_u32 s50, s50, s42
    buffer_load_dwordx4 v34, s[16:19], s50 offen lds
    ds_read_b64_tr_b16 v[68:69], v16 offset:20480
    ds_read_b64_tr_b16 v[70:71], v16 offset:20992
    v_mfma_f32_32x32x16_bf16 v[208:223], v[40:43], a[64:67], v[208:223]
    ds_read_b64_tr_b16 v[72:73], v17 offset:20480
    ds_read_b64_tr_b16 v[74:75], v17 offset:20992
    s_waitcnt lgkmcnt(12)
    v_mfma_f32_32x32x16_bf16 v[224:239], v[44:47], a[64:67], v[224:239]
    ds_read_b64_tr_b16 v[76:77], v18 offset:20480
    ds_read_b64_tr_b16 v[78:79], v18 offset:20992
    v_mfma_f32_32x32x16_bf16 v[240:255], v[48:51], a[64:67], v[240:255]
    ds_read_b64_tr_b16 v[80:81], v19 offset:20480
    ds_read_b64_tr_b16 v[82:83], v19 offset:20992
    s_waitcnt lgkmcnt(12)
    v_mfma_f32_32x32x16_bf16 v[192:207], v[52:55], a[68:71], v[192:207]
    ds_read_b64_tr_b16 v[84:85], v16 offset:22528
    ds_read_b64_tr_b16 v[86:87], v16 offset:23040
    v_mfma_f32_32x32x16_bf16 v[208:223], v[56:59], a[68:71], v[208:223]
    ds_read_b64_tr_b16 v[88:89], v17 offset:22528
    ds_read_b64_tr_b16 v[90:91], v17 offset:23040
    s_waitcnt lgkmcnt(12)
    v_mfma_f32_32x32x16_bf16 v[224:239], v[60:63], a[68:71], v[224:239]
    s_waitcnt vmcnt(3)
    s_mov_b64 exec, 1
    buffer_store_dword v111, v112, s[32:35], s60 offen offset:32 sc1
    s_mov_b64 exec, -1
    ds_read_b64_tr_b16 v[92:93], v18 offset:22528
    ds_read_b64_tr_b16 v[94:95], v18 offset:23040
    v_mfma_f32_32x32x16_bf16 v[240:255], v[64:67], a[68:71], v[240:255]
    ds_read_b64_tr_b16 v[96:97], v19 offset:22528
    ds_read_b64_tr_b16 v[98:99], v19 offset:23040
    s_waitcnt lgkmcnt(12)
    v_mfma_f32_32x32x16_bf16 v[192:207], v[68:71], a[72:75], v[192:207]
    s_waitcnt vmcnt(17)
    ds_read_b64_tr_b16 a[130:131], v24 offset:0
    ds_read_b64_tr_b16 a[132:133], v24 offset:1024
    ds_read_b64_tr_b16 a[134:135], v25 offset:0
    ds_read_b64_tr_b16 a[136:137], v25 offset:1024
    s_waitcnt vmcnt(24)
    s_barrier
    ds_read_b64_tr_b16 v[36:37], v12 offset:0
    ds_read_b64_tr_b16 v[38:39], v12 offset:512
    v_mfma_f32_32x32x16_bf16 v[208:223], v[72:75], a[72:75], v[208:223]
    ds_read_b64_tr_b16 v[40:41], v12 offset:2048
    ds_read_b64_tr_b16 v[42:43], v12 offset:2560
    s_waitcnt lgkmcnt(12)
    v_mfma_f32_32x32x16_bf16 v[224:239], v[76:79], a[72:75], v[224:239]
    s_waitcnt vmcnt(15)
    ds_read_b64_tr_b16 a[138:139], v24 offset:2048
    ds_read_b64_tr_b16 a[140:141], v24 offset:3072
    ds_read_b64_tr_b16 a[142:143], v25 offset:2048
    ds_read_b64_tr_b16 a[144:145], v25 offset:3072
    ds_read_b64_tr_b16 v[44:45], v12 offset:4096
    ds_read_b64_tr_b16 v[46:47], v12 offset:4608
    v_mfma_f32_32x32x16_bf16 v[240:255], v[80:83], a[72:75], v[240:255]
    ds_read_b64_tr_b16 v[48:49], v12 offset:6144
    ds_read_b64_tr_b16 v[50:51], v12 offset:6656
    s_waitcnt lgkmcnt(12)
    v_mfma_f32_32x32x16_bf16 v[192:207], v[84:87], a[76:79], v[192:207]
    s_waitcnt vmcnt(13)
    ds_read_b64_tr_b16 a[146:147], v24 offset:4096
    ds_read_b64_tr_b16 a[148:149], v24 offset:5120
    ds_read_b64_tr_b16 a[150:151], v25 offset:4096
    ds_read_b64_tr_b16 a[152:153], v25 offset:5120
    s_waitcnt vmcnt(19)
    s_barrier
    ds_read_b64_tr_b16 v[52:53], v12 offset:16384
    ds_read_b64_tr_b16 v[54:55], v12 offset:16896
    v_mfma_f32_32x32x16_bf16 v[208:223], v[88:91], a[76:79], v[208:223]
    ds_read_b64_tr_b16 v[56:57], v12 offset:18432
    ds_read_b64_tr_b16 v[58:59], v12 offset:18944
    s_waitcnt lgkmcnt(12)
    v_mfma_f32_32x32x16_bf16 v[224:239], v[92:95], a[76:79], v[224:239]
    s_waitcnt vmcnt(10)
    ds_read_b64_tr_b16 a[154:155], v24 offset:6144
    ds_read_b64_tr_b16 a[156:157], v24 offset:7168
    ds_read_b64_tr_b16 a[158:159], v25 offset:6144
    ds_read_b64_tr_b16 a[160:161], v25 offset:7168
    ds_read_b64_tr_b16 v[60:61], v12 offset:20480
    ds_read_b64_tr_b16 v[62:63], v12 offset:20992
    v_mfma_f32_32x32x16_bf16 v[240:255], v[96:99], a[76:79], v[240:255]
    ds_read_b64_tr_b16 v[64:65], v12 offset:22528
    ds_read_b64_tr_b16 v[66:67], v12 offset:23040
    s_waitcnt lgkmcnt(12)
    v_mfma_f32_32x32x16_bf16 v[192:207], v[36:39], a[80:83], v[192:207]
    s_waitcnt vmcnt(8)
    ds_read_b64_tr_b16 a[162:163], v24 offset:8192
    ds_read_b64_tr_b16 a[164:165], v24 offset:9216
    ds_read_b64_tr_b16 a[166:167], v25 offset:8192
    ds_read_b64_tr_b16 a[168:169], v25 offset:9216
    ds_read_b64_tr_b16 v[68:69], v13 offset:0
    ds_read_b64_tr_b16 v[70:71], v13 offset:512
    v_mfma_f32_32x32x16_bf16 v[192:207], v[40:43], a[84:87], v[192:207]
    ds_read_b64_tr_b16 v[72:73], v13 offset:2048
    ds_read_b64_tr_b16 v[74:75], v13 offset:2560
    s_waitcnt lgkmcnt(12)
    v_mfma_f32_32x32x16_bf16 v[192:207], v[44:47], a[88:91], v[192:207]
    s_waitcnt vmcnt(6)
    ds_read_b64_tr_b16 a[170:171], v24 offset:10240
    ds_read_b64_tr_b16 a[172:173], v24 offset:11264
    ds_read_b64_tr_b16 a[174:175], v25 offset:10240
    ds_read_b64_tr_b16 a[176:177], v25 offset:11264
    s_add_u32 m0, s79, 0
    s_mul_i32 s50, s8, 14
    s_add_u32 s50, s50, s42
    buffer_load_dwordx4 v27, s[16:19], s50 offen lds
    ds_read_b64_tr_b16 v[76:77], v13 offset:4096
    ds_read_b64_tr_b16 v[78:79], v13 offset:4608
    v_mfma_f32_32x32x16_bf16 v[192:207], v[48:51], a[92:95], v[192:207]
    ds_read_b64_tr_b16 v[80:81], v13 offset:6144
    ds_read_b64_tr_b16 v[82:83], v13 offset:6656
    s_waitcnt lgkmcnt(12)
    v_mfma_f32_32x32x16_bf16 v[192:207], v[52:55], a[96:99], v[192:207]
    s_waitcnt vmcnt(4)
    ds_read_b64_tr_b16 a[178:179], v24 offset:12288
    ds_read_b64_tr_b16 a[180:181], v24 offset:13312
    ds_read_b64_tr_b16 a[182:183], v25 offset:12288
    ds_read_b64_tr_b16 a[184:185], v25 offset:13312
    s_add_u32 m0, s79, 1024
    s_mul_i32 s50, s8, 14
    s_add_u32 s50, s50, s42
    buffer_load_dwordx4 v34, s[16:19], s50 offen lds
    ds_read_b64_tr_b16 v[84:85], v13 offset:16384
    ds_read_b64_tr_b16 v[86:87], v13 offset:16896
    v_mfma_f32_32x32x16_bf16 v[192:207], v[56:59], a[100:103], v[192:207]
    ds_read_b64_tr_b16 v[88:89], v13 offset:18432
    ds_read_b64_tr_b16 v[90:91], v13 offset:18944
    s_waitcnt lgkmcnt(12)
    v_mfma_f32_32x32x16_bf16 v[192:207], v[60:63], a[104:107], v[192:207]
    s_waitcnt vmcnt(3)
    ds_read_b64_tr_b16 a[186:187], v24 offset:14336
    ds_read_b64_tr_b16 a[188:189], v24 offset:15360
    ds_read_b64_tr_b16 a[190:191], v25 offset:14336
    ds_read_b64_tr_b16 a[192:193], v25 offset:15360
    s_add_u32 m0, s79, 2048
    s_mul_i32 s50, s9, 14
    s_add_u32 s50, s50, s42
    buffer_load_dwordx4 v27, s[16:19], s50 offen lds
    ds_read_b64_tr_b16 v[92:93], v13 offset:20480
    ds_read_b64_tr_b16 v[94:95], v13 offset:20992
    v_mfma_f32_32x32x16_bf16 v[192:207], v[64:67], a[108:111], v[192:207]
    v_mfma_f32_32x32x16_bf16 v[192:207], a[120:123], v[104:107], v[192:207]
    ds_read_b64_tr_b16 v[96:97], v13 offset:22528
    ds_read_b64_tr_b16 v[98:99], v13 offset:23040
    s_waitcnt lgkmcnt(12)
    v_mfma_f32_32x32x16_bf16 v[208:223], v[68:71], a[80:83], v[208:223]
    s_add_u32 m0, s79, 3072
    s_mul_i32 s50, s9, 14
    s_add_u32 s50, s50, s42
    buffer_load_dwordx4 v34, s[16:19], s50 offen lds
    s_nop 3
    v_mul_f32 v192, v117, v192
    v_mul_f32 v193, v117, v193
    v_mul_f32 v194, v117, v194
    v_mul_f32 v195, v117, v195
    v_mul_f32 v196, v117, v196
    v_mul_f32 v197, v117, v197
    ds_read_b64_tr_b16 v[36:37], v14 offset:0
    ds_read_b64_tr_b16 v[38:39], v14 offset:512
    v_mfma_f32_32x32x16_bf16 v[208:223], v[72:75], a[84:87], v[208:223]
    v_mul_f32 v198, v117, v198
    v_mul_f32 v199, v117, v199
    v_exp_f32 v192, v192
    v_exp_f32 v193, v193
    v_exp_f32 v194, v194
    v_exp_f32 v195, v195
    ds_read_b64_tr_b16 v[40:41], v14 offset:2048
    ds_read_b64_tr_b16 v[42:43], v14 offset:2560
    s_waitcnt lgkmcnt(12)
    v_mfma_f32_32x32x16_bf16 v[208:223], v[76:79], a[88:91], v[208:223]
    s_add_u32 m0, s79, 4096
    s_mul_i32 s50, s10, 14
    s_add_u32 s50, s50, s42
    buffer_load_dwordx4 v27, s[16:19], s50 offen lds
    v_exp_f32 v196, v196
    v_exp_f32 v197, v197
    v_exp_f32 v198, v198
    v_exp_f32 v199, v199
    v_fma_f32 v192, v192, v116, v116
    v_fma_f32 v193, v193, v116, v116
    ds_read_b64_tr_b16 v[44:45], v14 offset:4096
    ds_read_b64_tr_b16 v[46:47], v14 offset:4608
    v_mfma_f32_32x32x16_bf16 v[208:223], v[80:83], a[92:95], v[208:223]
    v_fma_f32 v194, v194, v116, v116
    v_fma_f32 v195, v195, v116, v116
    v_fma_f32 v196, v196, v116, v116
    v_fma_f32 v197, v197, v116, v116
    v_fma_f32 v198, v198, v116, v116
    v_fma_f32 v199, v199, v116, v116
    ds_read_b64_tr_b16 v[48:49], v14 offset:6144
    ds_read_b64_tr_b16 v[50:51], v14 offset:6656
    s_waitcnt lgkmcnt(12)
    v_mfma_f32_32x32x16_bf16 v[208:223], v[84:87], a[96:99], v[208:223]
    s_add_u32 m0, s79, 5120
    s_mul_i32 s50, s10, 14
    s_add_u32 s50, s50, s42
    buffer_load_dwordx4 v34, s[16:19], s50 offen lds
    v_rcp_f32 v192, v192
    v_rcp_f32 v193, v193
    v_rcp_f32 v194, v194
    v_rcp_f32 v195, v195
    v_rcp_f32 v196, v196
    v_rcp_f32 v197, v197
    ds_read_b64_tr_b16 v[52:53], v14 offset:16384
    ds_read_b64_tr_b16 v[54:55], v14 offset:16896
    v_mfma_f32_32x32x16_bf16 v[208:223], v[88:91], a[100:103], v[208:223]
    v_rcp_f32 v198, v198
    v_rcp_f32 v199, v199
    v_mul_f32 v200, v200, v192
    v_mul_f32 v201, v201, v193
    v_mul_f32 v202, v202, v194
    v_mul_f32 v203, v203, v195
    ds_read_b64_tr_b16 v[56:57], v14 offset:18432
    ds_read_b64_tr_b16 v[58:59], v14 offset:18944
    s_waitcnt lgkmcnt(12)
    v_mfma_f32_32x32x16_bf16 v[208:223], v[92:95], a[104:107], v[208:223]
    s_add_u32 m0, s79, 6144
    s_mul_i32 s50, s11, 14
    s_add_u32 s50, s50, s42
    buffer_load_dwordx4 v27, s[16:19], s50 offen lds
    v_mul_f32 v204, v204, v196
    v_mul_f32 v205, v205, v197
    v_mul_f32 v206, v206, v198
    v_mul_f32 v207, v207, v199
    v_cvt_pk_bf16_f32 v192, v200, v201
    v_cvt_pk_bf16_f32 v193, v202, v203
    ds_read_b64_tr_b16 v[60:61], v14 offset:20480
    ds_read_b64_tr_b16 v[62:63], v14 offset:20992
    v_mfma_f32_32x32x16_bf16 v[208:223], v[96:99], a[108:111], v[208:223]
    v_mfma_f32_32x32x16_bf16 v[208:223], a[122:125], v[104:107], v[208:223]
    ds_read_b64_tr_b16 v[64:65], v14 offset:22528
    ds_read_b64_tr_b16 v[66:67], v14 offset:23040
    s_waitcnt lgkmcnt(12)
    v_mfma_f32_32x32x16_bf16 v[224:239], v[36:39], a[80:83], v[224:239]
    s_add_u32 m0, s79, 7168
    s_mul_i32 s50, s11, 14
    s_add_u32 s50, s50, s42
    buffer_load_dwordx4 v34, s[16:19], s50 offen lds
    v_cvt_pk_bf16_f32 v194, v204, v205
    v_cvt_pk_bf16_f32 v195, v206, v207
    s_add_u32 s50, s62, 0
    buffer_store_dwordx4 v[192:195], v11, s[32:35], s50 offen sc1
    v_mul_f32 v208, v117, v208
    v_mul_f32 v209, v117, v209
    v_mul_f32 v210, v117, v210
    ds_read_b64_tr_b16 v[68:69], v15 offset:0
    ds_read_b64_tr_b16 v[70:71], v15 offset:512
    v_mfma_f32_32x32x16_bf16 v[224:239], v[40:43], a[84:87], v[224:239]
    v_mul_f32 v211, v117, v211
    v_mul_f32 v212, v117, v212
    v_mul_f32 v213, v117, v213
    v_mul_f32 v214, v117, v214
    v_mul_f32 v215, v117, v215
    v_exp_f32 v208, v208
    ds_read_b64_tr_b16 v[72:73], v15 offset:2048
    ds_read_b64_tr_b16 v[74:75], v15 offset:2560
    s_waitcnt lgkmcnt(12)
    v_mfma_f32_32x32x16_bf16 v[224:239], v[44:47], a[88:91], v[224:239]
    s_add_u32 m0, s79, 8192
    s_mul_i32 s50, s12, 14
    s_add_u32 s50, s50, s42
    buffer_load_dwordx4 v27, s[16:19], s50 offen lds
    v_exp_f32 v209, v209
    v_exp_f32 v210, v210
    v_exp_f32 v211, v211
    v_exp_f32 v212, v212
    v_exp_f32 v213, v213
    v_exp_f32 v214, v214
    ds_read_b64_tr_b16 v[76:77], v15 offset:4096
    ds_read_b64_tr_b16 v[78:79], v15 offset:4608
    v_mfma_f32_32x32x16_bf16 v[224:239], v[48:51], a[92:95], v[224:239]
    v_exp_f32 v215, v215
    v_fma_f32 v208, v208, v116, v116
    v_fma_f32 v209, v209, v116, v116
    v_fma_f32 v210, v210, v116, v116
    v_fma_f32 v211, v211, v116, v116
    v_fma_f32 v212, v212, v116, v116
    ds_read_b64_tr_b16 v[80:81], v15 offset:6144
    ds_read_b64_tr_b16 v[82:83], v15 offset:6656
    s_waitcnt lgkmcnt(12)
    v_mfma_f32_32x32x16_bf16 v[224:239], v[52:55], a[96:99], v[224:239]
    s_add_u32 m0, s79, 9216
    s_mul_i32 s50, s12, 14
    s_add_u32 s50, s50, s42
    buffer_load_dwordx4 v34, s[16:19], s50 offen lds
    v_fma_f32 v213, v213, v116, v116
    v_fma_f32 v214, v214, v116, v116
    v_fma_f32 v215, v215, v116, v116
    v_rcp_f32 v208, v208
    v_rcp_f32 v209, v209
    v_rcp_f32 v210, v210
    ds_read_b64_tr_b16 v[84:85], v15 offset:16384
    ds_read_b64_tr_b16 v[86:87], v15 offset:16896
    v_mfma_f32_32x32x16_bf16 v[224:239], v[56:59], a[100:103], v[224:239]
    v_rcp_f32 v211, v211
    v_rcp_f32 v212, v212
    v_rcp_f32 v213, v213
    v_rcp_f32 v214, v214
    v_rcp_f32 v215, v215
    v_mul_f32 v216, v216, v208
    ds_read_b64_tr_b16 v[88:89], v15 offset:18432
    ds_read_b64_tr_b16 v[90:91], v15 offset:18944
    s_waitcnt lgkmcnt(12)
    v_mfma_f32_32x32x16_bf16 v[224:239], v[60:63], a[104:107], v[224:239]
    s_add_u32 m0, s79, 10240
    s_mul_i32 s50, s13, 14
    s_add_u32 s50, s50, s42
    buffer_load_dwordx4 v27, s[16:19], s50 offen lds
    v_mul_f32 v217, v217, v209
    v_mul_f32 v218, v218, v210
    v_mul_f32 v219, v219, v211
    v_mul_f32 v220, v220, v212
    v_mul_f32 v221, v221, v213
    v_mul_f32 v222, v222, v214
    ds_read_b64_tr_b16 v[92:93], v15 offset:20480
    ds_read_b64_tr_b16 v[94:95], v15 offset:20992
    v_mfma_f32_32x32x16_bf16 v[224:239], v[64:67], a[108:111], v[224:239]
    v_mfma_f32_32x32x16_bf16 v[224:239], a[124:127], v[104:107], v[224:239]
    ds_read_b64_tr_b16 v[96:97], v15 offset:22528
    ds_read_b64_tr_b16 v[98:99], v15 offset:23040
    s_waitcnt lgkmcnt(12)
    v_mfma_f32_32x32x16_bf16 v[240:255], v[68:71], a[80:83], v[240:255]
    buffer_load_dword v113, v110, s[32:35], s61 offen offset:32 sc1
    s_add_u32 m0, s79, 11264
    s_mul_i32 s50, s13, 14
    s_add_u32 s50, s50, s42
    buffer_load_dwordx4 v34, s[16:19], s50 offen lds
    v_mul_f32 v223, v223, v215
    v_cvt_pk_bf16_f32 v208, v216, v217
    v_cvt_pk_bf16_f32 v209, v218, v219
    v_cvt_pk_bf16_f32 v210, v220, v221
    v_cvt_pk_bf16_f32 v211, v222, v223
    s_add_u32 s50, s62, 1024
    buffer_store_dwordx4 v[208:211], v11, s[32:35], s50 offen sc1
    v_mfma_f32_32x32x16_bf16 v[240:255], v[72:75], a[84:87], v[240:255]
    v_mul_f32 v224, v117, v224
    v_mul_f32 v225, v117, v225
    v_mul_f32 v226, v117, v226
    v_mul_f32 v227, v117, v227
    v_mul_f32 v228, v117, v228
    v_mul_f32 v229, v117, v229
    s_waitcnt lgkmcnt(8)
    v_mfma_f32_32x32x16_bf16 v[240:255], v[76:79], a[88:91], v[240:255]
    s_add_u32 m0, s79, 12288
    s_mul_i32 s50, s68, 14
    s_add_u32 s50, s50, s43
    buffer_load_dwordx4 v27, s[16:19], s50 offen lds
    v_mul_f32 v230, v117, v230
    v_mul_f32 v231, v117, v231
    v_exp_f32 v224, v224
    v_exp_f32 v225, v225
    v_exp_f32 v226, v226
    v_exp_f32 v227, v227
    v_mfma_f32_32x32x16_bf16 v[240:255], v[80:83], a[92:95], v[240:255]
    v_exp_f32 v228, v228
    v_exp_f32 v229, v229
    v_exp_f32 v230, v230
    v_exp_f32 v231, v231
    v_fma_f32 v224, v224, v116, v116
    v_fma_f32 v225, v225, v116, v116
    s_waitcnt lgkmcnt(4)
    v_mfma_f32_32x32x16_bf16 v[240:255], v[84:87], a[96:99], v[240:255]
    s_add_u32 m0, s79, 13312
    s_mul_i32 s50, s68, 14
    s_add_u32 s50, s50, s43
    buffer_load_dwordx4 v34, s[16:19], s50 offen lds
    v_fma_f32 v226, v226, v116, v116
    v_fma_f32 v227, v227, v116, v116
    v_fma_f32 v228, v228, v116, v116
    v_fma_f32 v229, v229, v116, v116
    v_fma_f32 v230, v230, v116, v116
    v_fma_f32 v231, v231, v116, v116
    v_mfma_f32_32x32x16_bf16 v[240:255], v[88:91], a[100:103], v[240:255]
    v_rcp_f32 v224, v224
    v_rcp_f32 v225, v225
    v_rcp_f32 v226, v226
    v_rcp_f32 v227, v227
    v_rcp_f32 v228, v228
    v_rcp_f32 v229, v229
    s_waitcnt lgkmcnt(0)
    v_mfma_f32_32x32x16_bf16 v[240:255], v[92:95], a[104:107], v[240:255]
    s_add_u32 m0, s79, 14336
    s_mul_i32 s50, s69, 14
    s_add_u32 s50, s50, s43
    buffer_load_dwordx4 v27, s[16:19], s50 offen lds
    v_rcp_f32 v230, v230
    v_rcp_f32 v231, v231
    v_mul_f32 v232, v232, v224
    v_mul_f32 v233, v233, v225
    v_mul_f32 v234, v234, v226
    v_mul_f32 v235, v235, v227
    v_mfma_f32_32x32x16_bf16 v[240:255], v[96:99], a[108:111], v[240:255]
    v_mfma_f32_32x32x16_bf16 v[240:255], a[126:129], v[104:107], v[240:255]
    v_mul_f32 v236, v236, v228
    v_mul_f32 v237, v237, v229
    v_mul_f32 v238, v238, v230
    v_mul_f32 v239, v239, v231
    v_cvt_pk_bf16_f32 v224, v232, v233
    v_cvt_pk_bf16_f32 v225, v234, v235
    v_cvt_pk_bf16_f32 v226, v236, v237
    v_cvt_pk_bf16_f32 v227, v238, v239
    s_add_u32 s50, s62, 2048
    buffer_store_dwordx4 v[224:227], v11, s[32:35], s50 offen sc1
    s_nop 1
    v_mul_f32 v240, v117, v240
    v_mul_f32 v241, v117, v241
    v_mul_f32 v242, v117, v242
    v_mul_f32 v243, v117, v243
    v_mul_f32 v244, v117, v244
    v_mul_f32 v245, v117, v245
    v_mul_f32 v246, v117, v246
    v_mul_f32 v247, v117, v247
    v_exp_f32 v240, v240
    v_exp_f32 v241, v241
    v_exp_f32 v242, v242
    v_exp_f32 v243, v243
    v_exp_f32 v244, v244
    v_exp_f32 v245, v245
    v_exp_f32 v246, v246
    v_exp_f32 v247, v247
    v_fma_f32 v240, v240, v116, v116
    v_fma_f32 v241, v241, v116, v116
    v_fma_f32 v242, v242, v116, v116
    v_fma_f32 v243, v243, v116, v116
    v_fma_f32 v244, v244, v116, v116
    v_fma_f32 v245, v245, v116, v116
    v_fma_f32 v246, v246, v116, v116
    v_fma_f32 v247, v247, v116, v116
    v_rcp_f32 v240, v240
    v_rcp_f32 v241, v241
    v_rcp_f32 v242, v242
    v_rcp_f32 v243, v243
    v_rcp_f32 v244, v244
    v_rcp_f32 v245, v245
    v_rcp_f32 v246, v246
    v_rcp_f32 v247, v247
    v_mul_f32 v248, v248, v240
    v_mul_f32 v249, v249, v241
    v_mul_f32 v250, v250, v242
    v_mul_f32 v251, v251, v243
    v_mul_f32 v252, v252, v244
    v_mul_f32 v253, v253, v245
    v_mul_f32 v254, v254, v246
    v_mul_f32 v255, v255, v247
    v_cvt_pk_bf16_f32 v240, v248, v249
    v_cvt_pk_bf16_f32 v241, v250, v251
    v_cvt_pk_bf16_f32 v242, v252, v253
    v_cvt_pk_bf16_f32 v243, v254, v255
    s_add_u32 s50, s62, 3072
    buffer_store_dwordx4 v[240:243], v11, s[32:35], s50 offen sc1
    s_add_u32 m0, s79, 15360
    s_mul_i32 s50, s69, 14
    s_add_u32 s50, s50, s43
    buffer_load_dwordx4 v34, s[16:19], s50 offen lds
    s_waitcnt vmcnt(8)
    v_cmp_ne_u32 vcc, 1, v113
    s_cmp_eq_u64 vcc, 0
    s_cbranch_scc1 K3_PAX
    s_mov_b32 s53, 0
K3_PA:
    buffer_load_dword v113, v110, s[32:35], s61 offen offset:32 sc1
    s_add_u32 s53, s53, 1
    s_waitcnt vmcnt(0)
    v_cmp_ne_u32 vcc, 1, v113
    s_cmp_gt_u32 s53, 0x400000
    s_cbranch_scc1 K3_PAX
    s_cmp_lg_u64 vcc, 0
    s_cbranch_scc1 K3_PA
K3_PAX:
    s_add_u32 s50, s68, s66
    buffer_load_dwordx4 a[0:3], v11, s[32:35], s50 offen sc1
    s_add_u32 s50, s68, s66
    s_add_u32 s50, s50, 114688
    buffer_load_dwordx4 a[4:7], v11, s[32:35], s50 offen sc1
    s_add_u32 s50, s69, s66
    buffer_load_dwordx4 a[8:11], v11, s[32:35], s50 offen sc1
    s_add_u32 s50, s69, s66
    s_add_u32 s50, s50, 114688
    buffer_load_dwordx4 a[12:15], v11, s[32:35], s50 offen sc1
    s_add_u32 s50, s70, s66
    buffer_load_dwordx4 a[16:19], v11, s[32:35], s50 offen sc1
    s_add_u32 s50, s70, s66
    s_add_u32 s50, s50, 114688
    buffer_load_dwordx4 a[20:23], v11, s[32:35], s50 offen sc1
    s_add_u32 s50, s71, s66
    buffer_load_dwordx4 a[24:27], v11, s[32:35], s50 offen sc1
    s_add_u32 s50, s71, s66
    s_add_u32 s50, s50, 114688
    buffer_load_dwordx4 a[28:31], v11, s[32:35], s50 offen sc1
    s_add_u32 s50, s72, s66
    buffer_load_dwordx4 a[32:35], v11, s[32:35], s50 offen sc1
    s_add_u32 s50, s72, s66
    s_add_u32 s50, s50, 114688
    buffer_load_dwordx4 a[36:39], v11, s[32:35], s50 offen sc1
    s_add_u32 s50, s73, s66
    buffer_load_dwordx4 a[40:43], v11, s[32:35], s50 offen sc1
    s_add_u32 s50, s73, s66
    s_add_u32 s50, s50, 114688
    buffer_load_dwordx4 a[44:47], v11, s[32:35], s50 offen sc1
    s_waitcnt vmcnt(13)
    s_mov_b64 exec, 1
    buffer_store_dword v111, v112, s[32:35], s60 offen sc1
    s_mov_b64 exec, -1
    s_add_u32 s50, s74, s66
    buffer_load_dwordx4 a[48:51], v11, s[32:35], s50 offen sc1
    s_add_u32 s50, s74, s66
    s_add_u32 s50, s50, 114688
    buffer_load_dwordx4 a[52:55], v11, s[32:35], s50 offen sc1
    s_add_u32 s50, s75, s66
    buffer_load_dwordx4 a[56:59], v11, s[32:35], s50 offen sc1
    s_add_u32 s50, s75, s66
    s_add_u32 s50, s50, 114688
    buffer_load_dwordx4 a[60:63], v11, s[32:35], s50 offen sc1
    s_add_u32 s50, s8, s66
    buffer_load_dwordx4 a[64:67], v11, s[32:35], s50 offen sc1
    s_add_u32 s50, s8, s66
    s_add_u32 s50, s50, 114688
    buffer_load_dwordx4 a[68:71], v11, s[32:35], s50 offen sc1
    s_add_u32 s50, s9, s66
    buffer_load_dwordx4 a[72:75], v11, s[32:35], s50 offen sc1
    s_add_u32 s50, s9, s66
    s_add_u32 s50, s50, 114688
    buffer_load_dwordx4 a[76:79], v11, s[32:35], s50 offen sc1
    s_add_u32 s50, s10, s66
    buffer_load_dwordx4 a[80:83], v11, s[32:35], s50 offen sc1
    s_add_u32 s50, s10, s66
    s_add_u32 s50, s50, 114688
    buffer_load_dwordx4 a[84:87], v11, s[32:35], s50 offen sc1
    s_add_u32 s50, s11, s66
    buffer_load_dwordx4 a[88:91], v11, s[32:35], s50 offen sc1
    s_add_u32 s50, s11, s66
    s_add_u32 s50, s50, 114688
    buffer_load_dwordx4 a[92:95], v11, s[32:35], s50 offen sc1
    s_add_u32 s50, s12, s66
    buffer_load_dwordx4 a[96:99], v11, s[32:35], s50 offen sc1
    s_add_u32 s50, s12, s66
    s_add_u32 s50, s50, 114688
    buffer_load_dwordx4 a[100:103], v11, s[32:35], s50 offen sc1
    s_add_u32 s50, s13, s66
    buffer_load_dwordx4 a[104:107], v11, s[32:35], s50 offen sc1
    s_add_u32 s50, s13, s66
    s_add_u32 s50, s50, 114688
    buffer_load_dwordx4 a[108:111], v11, s[32:35], s50 offen sc1
    s_barrier
    s_waitcnt vmcnt(27)
    v_mfma_f32_32x32x16_bf16 v[128:143], a[130:133], a[0:3], 0
    v_mfma_f32_32x32x16_bf16 v[144:159], a[130:133], a[4:7], 0
    v_mfma_f32_32x32x16_bf16 v[160:175], a[134:137], a[0:3], 0
    v_mfma_f32_32x32x16_bf16 v[176:191], a[134:137], a[4:7], 0
    s_add_u32 m0, s78, 0
    s_mul_i32 s50, s70, 14
    s_add_u32 s50, s50, s43
    buffer_load_dwordx4 v27, s[16:19], s50 offen lds
    s_add_u32 m0, s78, 1024
    s_mul_i32 s50, s70, 14
    s_add_u32 s50, s50, s43
    buffer_load_dwordx4 v34, s[16:19], s50 offen lds
    s_add_u32 m0, s78, 2048
    s_mul_i32 s50, s71, 14
    s_add_u32 s50, s50, s43
    buffer_load_dwordx4 v27, s[16:19], s50 offen lds
    s_waitcnt vmcnt(28)
    v_mfma_f32_32x32x16_bf16 v[128:143], a[138:141], a[8:11], v[128:143]
    v_mfma_f32_32x32x16_bf16 v[144:159], a[138:141], a[12:15], v[144:159]
    v_mfma_f32_32x32x16_bf16 v[160:175], a[142:145], a[8:11], v[160:175]
    v_mfma_f32_32x32x16_bf16 v[176:191], a[142:145], a[12:15], v[176:191]
    s_add_u32 m0, s78, 3072
    s_mul_i32 s50, s71, 14
    s_add_u32 s50, s50, s43
    buffer_load_dwordx4 v34, s[16:19], s50 offen lds
    s_add_u32 m0, s78, 4096
    s_mul_i32 s50, s72, 14
    s_add_u32 s50, s50, s43
    buffer_load_dwordx4 v27, s[16:19], s50 offen lds
    s_add_u32 m0, s78, 5120
    s_mul_i32 s50, s72, 14
    s_add_u32 s50, s50, s43
    buffer_load_dwordx4 v34, s[16:19], s50 offen lds
    s_waitcnt vmcnt(29)
    v_mfma_f32_32x32x16_bf16 v[128:143], a[146:149], a[16:19], v[128:143]
    v_mfma_f32_32x32x16_bf16 v[144:159], a[146:149], a[20:23], v[144:159]
    v_mfma_f32_32x32x16_bf16 v[160:175], a[150:153], a[16:19], v[160:175]
    v_mfma_f32_32x32x16_bf16 v[176:191], a[150:153], a[20:23], v[176:191]
    s_add_u32 m0, s78, 6144
    s_mul_i32 s50, s73, 14
    s_add_u32 s50, s50, s43
    buffer_load_dwordx4 v27, s[16:19], s50 offen lds
    s_add_u32 m0, s78, 7168
    s_mul_i32 s50, s73, 14
    s_add_u32 s50, s50, s43
    buffer_load_dwordx4 v34, s[16:19], s50 offen lds
    s_add_u32 m0, s78, 8192
    s_mul_i32 s50, s74, 14
    s_add_u32 s50, s50, s43
    buffer_load_dwordx4 v27, s[16:19], s50 offen lds
    s_waitcnt vmcnt(30)
    v_mfma_f32_32x32x16_bf16 v[128:143], a[154:157], a[24:27], v[128:143]
    v_mfma_f32_32x32x16_bf16 v[144:159], a[154:157], a[28:31], v[144:159]
    v_mfma_f32_32x32x16_bf16 v[160:175], a[158:161], a[24:27], v[160:175]
    v_mfma_f32_32x32x16_bf16 v[176:191], a[158:161], a[28:31], v[176:191]
    s_add_u32 m0, s78, 9216
    s_mul_i32 s50, s74, 14
    s_add_u32 s50, s50, s43
    buffer_load_dwordx4 v34, s[16:19], s50 offen lds
    s_add_u32 m0, s78, 10240
    s_mul_i32 s50, s75, 14
    s_add_u32 s50, s50, s43
    buffer_load_dwordx4 v27, s[16:19], s50 offen lds
    s_add_u32 m0, s78, 11264
    s_mul_i32 s50, s75, 14
    s_add_u32 s50, s50, s43
    buffer_load_dwordx4 v34, s[16:19], s50 offen lds
    s_waitcnt vmcnt(31)
    v_mfma_f32_32x32x16_bf16 v[128:143], a[162:165], a[32:35], v[128:143]
    v_mfma_f32_32x32x16_bf16 v[144:159], a[162:165], a[36:39], v[144:159]
    v_mfma_f32_32x32x16_bf16 v[160:175], a[166:169], a[32:35], v[160:175]
    v_mfma_f32_32x32x16_bf16 v[176:191], a[166:169], a[36:39], v[176:191]
    s_add_u32 m0, s78, 12288
    s_mul_i32 s50, s8, 14
    s_add_u32 s50, s50, s43
    buffer_load_dwordx4 v27, s[16:19], s50 offen lds
    s_add_u32 m0, s78, 13312
    s_mul_i32 s50, s8, 14
    s_add_u32 s50, s50, s43
    buffer_load_dwordx4 v34, s[16:19], s50 offen lds
    s_add_u32 m0, s78, 14336
    s_mul_i32 s50, s9, 14
    s_add_u32 s50, s50, s43
    buffer_load_dwordx4 v27, s[16:19], s50 offen lds
    s_waitcnt vmcnt(32)
    v_mfma_f32_32x32x16_bf16 v[128:143], a[170:173], a[40:43], v[128:143]
    v_mfma_f32_32x32x16_bf16 v[144:159], a[170:173], a[44:47], v[144:159]
    v_mfma_f32_32x32x16_bf16 v[160:175], a[174:177], a[40:43], v[160:175]
    v_mfma_f32_32x32x16_bf16 v[176:191], a[174:177], a[44:47], v[176:191]
    s_add_u32 m0, s78, 15360
    s_mul_i32 s50, s9, 14
    s_add_u32 s50, s50, s43
    buffer_load_dwordx4 v34, s[16:19], s50 offen lds
    s_add_u32 m0, s78, 16384
    s_mul_i32 s50, s10, 14
    s_add_u32 s50, s50, s43
    buffer_load_dwordx4 v27, s[16:19], s50 offen lds
    s_add_u32 m0, s78, 17408
    s_mul_i32 s50, s10, 14
    s_add_u32 s50, s50, s43
    buffer_load_dwordx4 v34, s[16:19], s50 offen lds
    s_waitcnt vmcnt(32)
    v_mfma_f32_32x32x16_bf16 v[128:143], a[178:181], a[48:51], v[128:143]
    v_mfma_f32_32x32x16_bf16 v[144:159], a[178:181], a[52:55], v[144:159]
    v_mfma_f32_32x32x16_bf16 v[160:175], a[182:185], a[48:51], v[160:175]
    v_mfma_f32_32x32x16_bf16 v[176:191], a[182:185], a[52:55], v[176:191]
    s_add_u32 m0, s78, 18432
    s_mul_i32 s50, s11, 14
    s_add_u32 s50, s50, s43
    buffer_load_dwordx4 v27, s[16:19], s50 offen lds
    s_add_u32 m0, s78, 19456
    s_mul_i32 s50, s11, 14
    s_add_u32 s50, s50, s43
    buffer_load_dwordx4 v34, s[16:19], s50 offen lds
    s_add_u32 m0, s78, 20480
    s_mul_i32 s50, s12, 14
    s_add_u32 s50, s50, s43
    buffer_load_dwordx4 v27, s[16:19], s50 offen lds
    ds_read_b64_tr_b16 v[36:37], v24 offset:0
    ds_read_b64_tr_b16 v[38:39], v24 offset:1024
    ds_read_b64_tr_b16 v[40:41], v25 offset:0
    ds_read_b64_tr_b16 v[42:43], v25 offset:1024
    s_waitcnt vmcnt(33)
    s_waitcnt lgkmcnt(4)
    v_mfma_f32_32x32x16_bf16 v[128:143], a[186:189], a[56:59], v[128:143]
    v_mfma_f32_32x32x16_bf16 v[144:159], a[186:189], a[60:63], v[144:159]
    v_mfma_f32_32x32x16_bf16 v[160:175], a[190:193], a[56:59], v[160:175]
    v_mfma_f32_32x32x16_bf16 v[176:191], a[190:193], a[60:63], v[176:191]
    s_add_u32 m0, s78, 21504
    s_mul_i32 s50, s12, 14
    s_add_u32 s50, s50, s43
    buffer_load_dwordx4 v34, s[16:19], s50 offen lds
    s_add_u32 m0, s78, 22528
    s_mul_i32 s50, s13, 14
    s_add_u32 s50, s50, s43
    buffer_load_dwordx4 v27, s[16:19], s50 offen lds
    s_add_u32 m0, s78, 23552
    s_mul_i32 s50, s13, 14
    s_add_u32 s50, s50, s43
    buffer_load_dwordx4 v34, s[16:19], s50 offen lds
    s_mov_b32 s53, 0
    buffer_load_dword v113, v110, s[32:35], s61 offen sc1
    buffer_load_dword v108, v110, s[32:35], s61 offen sc1
K3_POLL:
    buffer_load_dword v109, v110, s[32:35], s61 offen sc1
    s_waitcnt vmcnt(2)
    v_cmp_ne_u32 vcc, 1, v113
    s_cmp_eq_u64 vcc, 0
    s_cbranch_scc1 K3_POLLX
    buffer_load_dword v113, v110, s[32:35], s61 offen sc1
    s_waitcnt vmcnt(2)
    v_cmp_ne_u32 vcc, 1, v108
    s_cmp_eq_u64 vcc, 0
    s_cbranch_scc1 K3_POLLX
    buffer_load_dword v108, v110, s[32:35], s61 offen sc1
    s_waitcnt vmcnt(2)
    v_cmp_ne_u32 vcc, 1, v109
    s_cmp_eq_u64 vcc, 0
    s_cbranch_scc1 K3_POLLX
    s_add_u32 s53, s53, 1
    s_cmp_lt_u32 s53, 0x200000
    s_cbranch_scc1 K3_POLL
K3_POLLX:
    s_add_u32 s50, s68, s67
    buffer_load_dwordx4 a[0:3], v11, s[32:35], s50 offen sc1
    s_add_u32 s50, s68, s67
    s_add_u32 s50, s50, 114688
    buffer_load_dwordx4 a[4:7], v11, s[32:35], s50 offen sc1
    s_add_u32 s50, s69, s67
    buffer_load_dwordx4 a[8:11], v11, s[32:35], s50 offen sc1
    s_add_u32 s50, s69, s67
    s_add_u32 s50, s50, 114688
    buffer_load_dwordx4 a[12:15], v11, s[32:35], s50 offen sc1
    s_add_u32 s50, s70, s67
    buffer_load_dwordx4 a[16:19], v11, s[32:35], s50 offen sc1
    s_add_u32 s50, s70, s67
    s_add_u32 s50, s50, 114688
    buffer_load_dwordx4 a[20:23], v11, s[32:35], s50 offen sc1
    s_add_u32 s50, s71, s67
    buffer_load_dwordx4 a[24:27], v11, s[32:35], s50 offen sc1
    s_add_u32 s50, s71, s67
    s_add_u32 s50, s50, 114688
    buffer_load_dwordx4 a[28:31], v11, s[32:35], s50 offen sc1
    s_add_u32 s50, s72, s67
    buffer_load_dwordx4 a[32:35], v11, s[32:35], s50 offen sc1
    s_add_u32 s50, s72, s67
    s_add_u32 s50, s50, 114688
    buffer_load_dwordx4 a[36:39], v11, s[32:35], s50 offen sc1
    s_add_u32 s50, s73, s67
    buffer_load_dwordx4 a[40:43], v11, s[32:35], s50 offen sc1
    s_add_u32 s50, s73, s67
    s_add_u32 s50, s50, 114688
    buffer_load_dwordx4 a[44:47], v11, s[32:35], s50 offen sc1
    s_add_u32 s50, s74, s67
    buffer_load_dwordx4 a[48:51], v11, s[32:35], s50 offen sc1
    s_add_u32 s50, s74, s67
    s_add_u32 s50, s50, 114688
    buffer_load_dwordx4 a[52:55], v11, s[32:35], s50 offen sc1
    s_add_u32 s50, s75, s67
    buffer_load_dwordx4 a[56:59], v11, s[32:35], s50 offen sc1
    s_add_u32 s50, s75, s67
    s_add_u32 s50, s50, 114688
    buffer_load_dwordx4 a[60:63], v11, s[32:35], s50 offen sc1
    ds_read_b64_tr_b16 v[44:45], v24 offset:2048
    ds_read_b64_tr_b16 v[46:47], v24 offset:3072
    ds_read_b64_tr_b16 v[48:49], v25 offset:2048
    ds_read_b64_tr_b16 v[50:51], v25 offset:3072
    s_waitcnt lgkmcnt(4)
    v_mfma_f32_32x32x16_bf16 v[128:143], v[36:39], a[64:67], v[128:143]
    v_mfma_f32_32x32x16_bf16 v[144:159], v[36:39], a[68:71], v[144:159]
    v_mfma_f32_32x32x16_bf16 v[160:175], v[40:43], a[64:67], v[160:175]
    v_mfma_f32_32x32x16_bf16 v[176:191], v[40:43], a[68:71], v[176:191]
    s_add_u32 s50, s8, s67
    buffer_load_dwordx4 a[64:67], v11, s[32:35], s50 offen sc1
    s_add_u32 s50, s8, s67
    s_add_u32 s50, s50, 114688
    buffer_load_dwordx4 a[68:71], v11, s[32:35], s50 offen sc1
    ds_read_b64_tr_b16 v[36:37], v24 offset:4096
    ds_read_b64_tr_b16 v[38:39], v24 offset:5120
    ds_read_b64_tr_b16 v[40:41], v25 offset:4096
    ds_read_b64_tr_b16 v[42:43], v25 offset:5120
    s_waitcnt lgkmcnt(4)
    v_mfma_f32_32x32x16_bf16 v[128:143], v[44:47], a[72:75], v[128:143]
    v_mfma_f32_32x32x16_bf16 v[144:159], v[44:47], a[76:79], v[144:159]
    v_mfma_f32_32x32x16_bf16 v[160:175], v[48:51], a[72:75], v[160:175]
    v_mfma_f32_32x32x16_bf16 v[176:191], v[48:51], a[76:79], v[176:191]
    s_add_u32 s50, s9, s67
    buffer_load_dwordx4 a[72:75], v11, s[32:35], s50 offen sc1
    s_add_u32 s50, s9, s67
    s_add_u32 s50, s50, 114688
    buffer_load_dwordx4 a[76:79], v11, s[32:35], s50 offen sc1
    ds_read_b64_tr_b16 v[44:45], v24 offset:6144
    ds_read_b64_tr_b16 v[46:47], v24 offset:7168
    ds_read_b64_tr_b16 v[48:49], v25 offset:6144
    ds_read_b64_tr_b16 v[50:51], v25 offset:7168
    s_waitcnt lgkmcnt(4)
    v_mfma_f32_32x32x16_bf16 v[128:143], v[36:39], a[80:83], v[128:143]
    v_mfma_f32_32x32x16_bf16 v[144:159], v[36:39], a[84:87], v[144:159]
    v_mfma_f32_32x32x16_bf16 v[160:175], v[40:43], a[80:83], v[160:175]
    v_mfma_f32_32x32x16_bf16 v[176:191], v[40:43], a[84:87], v[176:191]
    s_add_u32 s50, s10, s67
    buffer_load_dwordx4 a[80:83], v11, s[32:35], s50 offen sc1
    s_add_u32 s50, s10, s67
    s_add_u32 s50, s50, 114688
    buffer_load_dwordx4 a[84:87], v11, s[32:35], s50 offen sc1
    ds_read_b64_tr_b16 v[36:37], v24 offset:8192
    ds_read_b64_tr_b16 v[38:39], v24 offset:9216
    ds_read_b64_tr_b16 v[40:41], v25 offset:8192
    ds_read_b64_tr_b16 v[42:43], v25 offset:9216
    s_waitcnt lgkmcnt(4)
    v_mfma_f32_32x32x16_bf16 v[128:143], v[44:47], a[88:91], v[128:143]
    v_mfma_f32_32x32x16_bf16 v[144:159], v[44:47], a[92:95], v[144:159]
    v_mfma_f32_32x32x16_bf16 v[160:175], v[48:51], a[88:91], v[160:175]
    v_mfma_f32_32x32x16_bf16 v[176:191], v[48:51], a[92:95], v[176:191]
    s_add_u32 s50, s11, s67
    buffer_load_dwordx4 a[88:91], v11, s[32:35], s50 offen sc1
    s_add_u32 s50, s11, s67
    s_add_u32 s50, s50, 114688
    buffer_load_dwordx4 a[92:95], v11, s[32:35], s50 offen sc1
    ds_read_b64_tr_b16 v[44:45], v24 offset:10240
    ds_read_b64_tr_b16 v[46:47], v24 offset:11264
    ds_read_b64_tr_b16 v[48:49], v25 offset:10240
    ds_read_b64_tr_b16 v[50:51], v25 offset:11264
    s_waitcnt lgkmcnt(4)
    v_mfma_f32_32x32x16_bf16 v[128:143], v[36:39], a[96:99], v[128:143]
    v_mfma_f32_32x32x16_bf16 v[144:159], v[36:39], a[100:103], v[144:159]
    v_mfma_f32_32x32x16_bf16 v[160:175], v[40:43], a[96:99], v[160:175]
    v_mfma_f32_32x32x16_bf16 v[176:191], v[40:43], a[100:103], v[176:191]
    s_add_u32 s50, s12, s67
    buffer_load_dwordx4 a[96:99], v11, s[32:35], s50 offen sc1
    s_add_u32 s50, s12, s67
    s_add_u32 s50, s50, 114688
    buffer_load_dwordx4 a[100:103], v11, s[32:35], s50 offen sc1
    ds_read_b64_tr_b16 v[36:37], v24 offset:12288
    ds_read_b64_tr_b16 v[38:39], v24 offset:13312
    ds_read_b64_tr_b16 v[40:41], v25 offset:12288
    ds_read_b64_tr_b16 v[42:43], v25 offset:13312
    s_waitcnt lgkmcnt(4)
    v_mfma_f32_32x32x16_bf16 v[128:143], v[44:47], a[104:107], v[128:143]
    v_mfma_f32_32x32x16_bf16 v[144:159], v[44:47], a[108:111], v[144:159]
    v_mfma_f32_32x32x16_bf16 v[160:175], v[48:51], a[104:107], v[160:175]
    v_mfma_f32_32x32x16_bf16 v[176:191], v[48:51], a[108:111], v[176:191]
    s_add_u32 s50, s13, s67
    buffer_load_dwordx4 a[104:107], v11, s[32:35], s50 offen sc1
    s_add_u32 s50, s13, s67
    s_add_u32 s50, s50, 114688
    buffer_load_dwordx4 a[108:111], v11, s[32:35], s50 offen sc1
    ds_read_b64_tr_b16 v[44:45], v24 offset:14336
    ds_read_b64_tr_b16 v[46:47], v24 offset:15360
    ds_read_b64_tr_b16 v[48:49], v25 offset:14336
    ds_read_b64_tr_b16 v[50:51], v25 offset:15360
    s_waitcnt vmcnt(26)
    s_waitcnt lgkmcnt(4)
    v_mfma_f32_32x32x16_bf16 v[128:143], v[36:39], a[0:3], v[128:143]
    v_mfma_f32_32x32x16_bf16 v[144:159], v[36:39], a[4:7], v[144:159]
    v_mfma_f32_32x32x16_bf16 v[160:175], v[40:43], a[0:3], v[160:175]
    v_mfma_f32_32x32x16_bf16 v[176:191], v[40:43], a[4:7], v[176:191]
    buffer_load_dwordx4 v[52:55], v26, s[32:35], s63 offen sc1
    buffer_load_dwordx4 v[56:59], v26, s[32:35], s63 offen offset:128 sc1
    ds_read_b64_tr_b16 v[36:37], v28 offset:0
    ds_read_b64_tr_b16 v[38:39], v28 offset:1024
    ds_read_b64_tr_b16 v[40:41], v29 offset:0
    ds_read_b64_tr_b16 v[42:43], v29 offset:1024
    s_waitcnt vmcnt(26)
    s_waitcnt lgkmcnt(4)
    v_mfma_f32_32x32x16_bf16 v[128:143], v[44:47], a[8:11], v[128:143]
    v_mfma_f32_32x32x16_bf16 v[144:159], v[44:47], a[12:15], v[144:159]
    v_mfma_f32_32x32x16_bf16 v[160:175], v[48:51], a[8:11], v[160:175]
    v_mfma_f32_32x32x16_bf16 v[176:191], v[48:51], a[12:15], v[176:191]
    ds_read_b64_tr_b16 v[44:45], v28 offset:2048
    ds_read_b64_tr_b16 v[46:47], v28 offset:3072
    ds_read_b64_tr_b16 v[48:49], v29 offset:2048
    ds_read_b64_tr_b16 v[50:51], v29 offset:3072
    s_waitcnt vmcnt(24)
    s_waitcnt lgkmcnt(4)
    v_mfma_f32_32x32x16_bf16 v[128:143], v[36:39], a[16:19], v[128:143]
    v_mfma_f32_32x32x16_bf16 v[144:159], v[36:39], a[20:23], v[144:159]
    v_mfma_f32_32x32x16_bf16 v[160:175], v[40:43], a[16:19], v[160:175]
    v_mfma_f32_32x32x16_bf16 v[176:191], v[40:43], a[20:23], v[176:191]
    ds_read_b64_tr_b16 v[36:37], v28 offset:4096
    ds_read_b64_tr_b16 v[38:39], v28 offset:5120
    ds_read_b64_tr_b16 v[40:41], v29 offset:4096
    ds_read_b64_tr_b16 v[42:43], v29 offset:5120
    s_waitcnt vmcnt(22)
    s_waitcnt lgkmcnt(4)
    v_mfma_f32_32x32x16_bf16 v[128:143], v[44:47], a[24:27], v[128:143]
    v_mfma_f32_32x32x16_bf16 v[144:159], v[44:47], a[28:31], v[144:159]
    v_mfma_f32_32x32x16_bf16 v[160:175], v[48:51], a[24:27], v[160:175]
    v_mfma_f32_32x32x16_bf16 v[176:191], v[48:51], a[28:31], v[176:191]
    ds_read_b64_tr_b16 v[44:45], v28 offset:6144
    ds_read_b64_tr_b16 v[46:47], v28 offset:7168
    ds_read_b64_tr_b16 v[48:49], v29 offset:6144
    ds_read_b64_tr_b16 v[50:51], v29 offset:7168
    s_waitcnt vmcnt(20)
    s_waitcnt lgkmcnt(4)
    v_mfma_f32_32x32x16_bf16 v[128:143], v[36:39], a[32:35], v[128:143]
    v_mfma_f32_32x32x16_bf16 v[144:159], v[36:39], a[36:39], v[144:159]
    v_mfma_f32_32x32x16_bf16 v[160:175], v[40:43], a[32:35], v[160:175]
    v_mfma_f32_32x32x16_bf16 v[176:191], v[40:43], a[36:39], v[176:191]
    ds_read_b64_tr_b16 v[36:37], v28 offset:8192
    ds_read_b64_tr_b16 v[38:39], v28 offset:9216
    ds_read_b64_tr_b16 v[40:41], v29 offset:8192
    ds_read_b64_tr_b16 v[42:43], v29 offset:9216
    s_waitcnt vmcnt(18)
    s_waitcnt lgkmcnt(4)
    v_mfma_f32_32x32x16_bf16 v[128:143], v[44:47], a[40:43], v[128:143]
    v_mfma_f32_32x32x16_bf16 v[144:159], v[44:47], a[44:47], v[144:159]
    v_mfma_f32_32x32x16_bf16 v[160:175], v[48:51], a[40:43], v[160:175]
    v_mfma_f32_32x32x16_bf16 v[176:191], v[48:51], a[44:47], v[176:191]
    ds_read_b64_tr_b16 v[44:45], v28 offset:10240
    ds_read_b64_tr_b16 v[46:47], v28 offset:11264
    ds_read_b64_tr_b16 v[48:49], v29 offset:10240
    ds_read_b64_tr_b16 v[50:51], v29 offset:11264
    s_waitcnt vmcnt(16)
    s_waitcnt lgkmcnt(4)
    v_mfma_f32_32x32x16_bf16 v[128:143], v[36:39], a[48:51], v[128:143]
    v_mfma_f32_32x32x16_bf16 v[144:159], v[36:39], a[52:55], v[144:159]
    v_mfma_f32_32x32x16_bf16 v[160:175], v[40:43], a[48:51], v[160:175]
    v_mfma_f32_32x32x16_bf16 v[176:191], v[40:43], a[52:55], v[176:191]
    ds_read_b64_tr_b16 v[36:37], v28 offset:12288
    ds_read_b64_tr_b16 v[38:39], v28 offset:13312
    ds_read_b64_tr_b16 v[40:41], v29 offset:12288
    ds_read_b64_tr_b16 v[42:43], v29 offset:13312
    s_waitcnt vmcnt(14)
    s_waitcnt lgkmcnt(4)
    v_mfma_f32_32x32x16_bf16 v[128:143], v[44:47], a[56:59], v[128:143]
    v_mfma_f32_32x32x16_bf16 v[144:159], v[44:47], a[60:63], v[144:159]
    v_mfma_f32_32x32x16_bf16 v[160:175], v[48:51], a[56:59], v[160:175]
    v_mfma_f32_32x32x16_bf16 v[176:191], v[48:51], a[60:63], v[176:191]
    ds_read_b64_tr_b16 v[44:45], v28 offset:14336
    ds_read_b64_tr_b16 v[46:47], v28 offset:15360
    ds_read_b64_tr_b16 v[48:49], v29 offset:14336
    ds_read_b64_tr_b16 v[50:51], v29 offset:15360
    s_waitcnt vmcnt(12)
    s_waitcnt lgkmcnt(4)
    v_mfma_f32_32x32x16_bf16 v[128:143], v[36:39], a[64:67], v[128:143]
    v_mfma_f32_32x32x16_bf16 v[144:159], v[36:39], a[68:71], v[144:159]
    v_mfma_f32_32x32x16_bf16 v[160:175], v[40:43], a[64:67], v[160:175]
    v_mfma_f32_32x32x16_bf16 v[176:191], v[40:43], a[68:71], v[176:191]
    ds_read_b64_tr_b16 v[36:37], v28 offset:16384
    ds_read_b64_tr_b16 v[38:39], v28 offset:17408
    ds_read_b64_tr_b16 v[40:41], v29 offset:16384
    ds_read_b64_tr_b16 v[42:43], v29 offset:17408
    s_waitcnt vmcnt(10)
    s_waitcnt lgkmcnt(4)
    v_mfma_f32_32x32x16_bf16 v[128:143], v[44:47], a[72:75], v[128:143]
    v_mfma_f32_32x32x16_bf16 v[144:159], v[44:47], a[76:79], v[144:159]
    v_mfma_f32_32x32x16_bf16 v[160:175], v[48:51], a[72:75], v[160:175]
    v_mfma_f32_32x32x16_bf16 v[176:191], v[48:51], a[76:79], v[176:191]
    ds_read_b64_tr_b16 v[44:45], v28 offset:18432
    ds_read_b64_tr_b16 v[46:47], v28 offset:19456
    ds_read_b64_tr_b16 v[48:49], v29 offset:18432
    ds_read_b64_tr_b16 v[50:51], v29 offset:19456
    s_waitcnt vmcnt(8)
    s_waitcnt lgkmcnt(4)
    v_mfma_f32_32x32x16_bf16 v[128:143], v[36:39], a[80:83], v[128:143]
    v_mfma_f32_32x32x16_bf16 v[144:159], v[36:39], a[84:87], v[144:159]
    v_mfma_f32_32x32x16_bf16 v[160:175], v[40:43], a[80:83], v[160:175]
    v_mfma_f32_32x32x16_bf16 v[176:191], v[40:43], a[84:87], v[176:191]
    ds_read_b64_tr_b16 v[36:37], v28 offset:20480
    ds_read_b64_tr_b16 v[38:39], v28 offset:21504
    ds_read_b64_tr_b16 v[40:41], v29 offset:20480
    ds_read_b64_tr_b16 v[42:43], v29 offset:21504
    s_waitcnt vmcnt(6)
    s_waitcnt lgkmcnt(4)
    v_mfma_f32_32x32x16_bf16 v[128:143], v[44:47], a[88:91], v[128:143]
    v_mfma_f32_32x32x16_bf16 v[144:159], v[44:47], a[92:95], v[144:159]
    v_mfma_f32_32x32x16_bf16 v[160:175], v[48:51], a[88:91], v[160:175]
    v_mfma_f32_32x32x16_bf16 v[176:191], v[48:51], a[92:95], v[176:191]
    ds_read_b64_tr_b16 v[44:45], v28 offset:22528
    ds_read_b64_tr_b16 v[46:47], v28 offset:23552
    ds_read_b64_tr_b16 v[48:49], v29 offset:22528
    ds_read_b64_tr_b16 v[50:51], v29 offset:23552
    s_waitcnt vmcnt(4)
    s_waitcnt lgkmcnt(4)
    v_mfma_f32_32x32x16_bf16 v[128:143], v[36:39], a[96:99], v[128:143]
    v_mfma_f32_32x32x16_bf16 v[144:159], v[36:39], a[100:103], v[144:159]
    v_mfma_f32_32x32x16_bf16 v[160:175], v[40:43], a[96:99], v[160:175]
    v_mfma_f32_32x32x16_bf16 v[176:191], v[40:43], a[100:103], v[176:191]
    s_waitcnt vmcnt(2)
    s_waitcnt lgkmcnt(0)
    v_mfma_f32_32x32x16_bf16 v[128:143], v[44:47], a[104:107], v[128:143]
    v_mfma_f32_32x32x16_bf16 v[144:159], v[44:47], a[108:111], v[144:159]
    v_mfma_f32_32x32x16_bf16 v[160:175], v[48:51], a[104:107], v[160:175]
    v_mfma_f32_32x32x16_bf16 v[176:191], v[48:51], a[108:111], v[176:191]
    s_nop 8
    ds_write_b128 v30, v[128:131] offset:0
    ds_write_b128 v30, v[132:135] offset:32
    ds_write_b128 v30, v[136:139] offset:64
    ds_write_b128 v30, v[140:143] offset:96
    ds_write_b128 v30, v[144:147] offset:8704
    ds_write_b128 v30, v[148:151] offset:8736
    ds_write_b128 v30, v[152:155] offset:8768
    ds_write_b128 v30, v[156:159] offset:8800
    ds_write_b128 v30, v[160:163] offset:128
    ds_write_b128 v30, v[164:167] offset:160
    ds_write_b128 v30, v[168:171] offset:192
    ds_write_b128 v30, v[172:175] offset:224
    ds_write_b128 v30, v[176:179] offset:8832
    ds_write_b128 v30, v[180:183] offset:8864
    ds_write_b128 v30, v[184:187] offset:8896
    ds_write_b128 v30, v[188:191] offset:8928
    s_waitcnt lgkmcnt(0)
    s_barrier
    s_waitcnt vmcnt(0)
    ds_read_b128 v[60:63], v31 offset:0
    ds_read_b128 v[64:67], v31 offset:16
    ds_read_b128 v[68:71], v31 offset:24576
    ds_read_b128 v[72:75], v31 offset:24592
    ds_read_b128 v[76:79], v33 offset:0
    ds_read_b128 v[80:83], v33 offset:16
    ds_read_b128 v[84:87], v33 offset:24576
    ds_read_b128 v[88:91], v33 offset:24592
    ds_read_b128 v[92:95], v31 offset:2176
    ds_read_b128 v[96:99], v31 offset:2192
    ds_read_b128 v[100:103], v31 offset:26752
    ds_read_b128 v[104:107], v31 offset:26768
    ds_read_b128 v[108:111], v33 offset:2176
    ds_read_b128 v[112:115], v33 offset:2192
    ds_read_b128 v[116:119], v33 offset:26752
    ds_read_b128 v[120:123], v33 offset:26768
    s_waitcnt lgkmcnt(8)
    v_add_f32 v60, v60, v68
    v_add_f32 v76, v76, v84
    v_add_f32 v61, v61, v69
    v_add_f32 v77, v77, v85
    v_add_f32 v62, v62, v70
    v_add_f32 v78, v78, v86
    v_add_f32 v63, v63, v71
    v_add_f32 v79, v79, v87
    v_add_f32 v64, v64, v72
    v_add_f32 v80, v80, v88
    v_add_f32 v65, v65, v73
    v_add_f32 v81, v81, v89
    v_add_f32 v66, v66, v74
    v_add_f32 v82, v82, v90
    v_add_f32 v67, v67, v75
    v_add_f32 v83, v83, v91
    v_add_f32 v60, v60, v76
    v_add_f32 v61, v61, v77
    v_add_f32 v62, v62, v78
    v_add_f32 v63, v63, v79
    v_add_f32 v64, v64, v80
    v_add_f32 v65, v65, v81
    v_add_f32 v66, v66, v82
    v_add_f32 v67, v67, v83
    v_cvt_pk_bf16_f32 v68, v60, v61
    v_cvt_pk_bf16_f32 v69, v62, v63
    v_cvt_pk_bf16_f32 v70, v64, v65
    v_cvt_pk_bf16_f32 v71, v66, v67
    v_lshlrev_b32 v60, 16, v68
    v_and_b32 v61, s41, v68
    v_lshlrev_b32 v76, 16, v52
    v_and_b32 v77, s41, v52
    v_lshlrev_b32 v62, 16, v69
    v_and_b32 v63, s41, v69
    v_lshlrev_b32 v78, 16, v53
    v_and_b32 v79, s41, v53
    v_lshlrev_b32 v64, 16, v70
    v_and_b32 v65, s41, v70
    v_lshlrev_b32 v80, 16, v54
    v_and_b32 v81, s41, v54
    v_lshlrev_b32 v66, 16, v71
    v_and_b32 v67, s41, v71
    v_lshlrev_b32 v82, 16, v55
    v_and_b32 v83, s41, v55
    v_add_f32 v60, v60, v76
    v_add_f32 v61, v61, v77
    v_add_f32 v62, v62, v78
    v_add_f32 v63, v63, v79
    v_add_f32 v64, v64, v80
    v_add_f32 v65, v65, v81
    v_add_f32 v66, v66, v82
    v_add_f32 v67, v67, v83
    v_cvt_pk_bf16_f32 v68, v60, v61
    v_cvt_pk_bf16_f32 v69, v62, v63
    v_cvt_pk_bf16_f32 v70, v64, v65
    v_cvt_pk_bf16_f32 v71, v66, v67
    s_add_u32 s50, s76, 0
    buffer_store_dwordx4 v[68:71], v32, s[24:27], s50 offen
    s_waitcnt lgkmcnt(0)
    v_add_f32 v92, v92, v100
    v_add_f32 v108, v108, v116
    v_add_f32 v93, v93, v101
    v_add_f32 v109, v109, v117
    v_add_f32 v94, v94, v102
    v_add_f32 v110, v110, v118
    v_add_f32 v95, v95, v103
    v_add_f32 v111, v111, v119
    v_add_f32 v96, v96, v104
    v_add_f32 v112, v112, v120
    v_add_f32 v97, v97, v105
    v_add_f32 v113, v113, v121
    v_add_f32 v98, v98, v106
    v_add_f32 v114, v114, v122
    v_add_f32 v99, v99, v107
    v_add_f32 v115, v115, v123
    v_add_f32 v92, v92, v108
    v_add_f32 v93, v93, v109
    v_add_f32 v94, v94, v110
    v_add_f32 v95, v95, v111
    v_add_f32 v96, v96, v112
    v_add_f32 v97, v97, v113
    v_add_f32 v98, v98, v114
    v_add_f32 v99, v99, v115
    v_cvt_pk_bf16_f32 v100, v92, v93
    v_cvt_pk_bf16_f32 v101, v94, v95
    v_cvt_pk_bf16_f32 v102, v96, v97
    v_cvt_pk_bf16_f32 v103, v98, v99
    v_lshlrev_b32 v92, 16, v100
    v_and_b32 v93, s41, v100
    v_lshlrev_b32 v108, 16, v56
    v_and_b32 v109, s41, v56
    v_lshlrev_b32 v94, 16, v101
    v_and_b32 v95, s41, v101
    v_lshlrev_b32 v110, 16, v57
    v_and_b32 v111, s41, v57
    v_lshlrev_b32 v96, 16, v102
    v_and_b32 v97, s41, v102
    v_lshlrev_b32 v112, 16, v58
    v_and_b32 v113, s41, v58
    v_lshlrev_b32 v98, 16, v103
    v_and_b32 v99, s41, v103
    v_lshlrev_b32 v114, 16, v59
    v_and_b32 v115, s41, v59
    v_add_f32 v92, v92, v108
    v_add_f32 v93, v93, v109
    v_add_f32 v94, v94, v110
    v_add_f32 v95, v95, v111
    v_add_f32 v96, v96, v112
    v_add_f32 v97, v97, v113
    v_add_f32 v98, v98, v114
    v_add_f32 v99, v99, v115
    v_cvt_pk_bf16_f32 v100, v92, v93
    v_cvt_pk_bf16_f32 v101, v94, v95
    v_cvt_pk_bf16_f32 v102, v96, v97
    v_cvt_pk_bf16_f32 v103, v98, v99
    s_add_u32 s50, s76, 7168
    buffer_store_dwordx4 v[100:103], v32, s[24:27], s50 offen
    s_endpgm
K3_PF:
    s_sub_u32 s36, s2, 224
    s_waitcnt lgkmcnt(0)
    s_mov_b32 s16, s4
    s_mov_b32 s17, s5
    s_mov_b32 s18, 1605632
    s_mov_b32 s19, 0x00020000
    s_mov_b32 s20, s8
    s_mov_b32 s21, s9
    s_mov_b32 s22, 1605632
    s_mov_b32 s23, 0x00020000
    s_mov_b32 s24, s10
    s_mov_b32 s25, s11
    s_mov_b32 s26, 1605632
    s_mov_b32 s27, 0x00020000
    s_mov_b32 s32, s14
    s_mov_b32 s33, s15
    s_mov_b32 s34, 268435456
    s_mov_b32 s35, 0x00020000
    s_cmp_ge_u32 s36, 28
    s_cbranch_scc1 K3_PF2
    s_cmp_ge_u32 s36, 14
    s_cselect_b32 s37, 1, 0
    s_cselect_b32 s28, s10, s8
    s_cselect_b32 s29, s11, s9
    s_mov_b32 s30, 1605632
    s_mov_b32 s31, 0x00020000
    s_mul_i32 s39, s37, 14
    s_sub_u32 s39, s36, s39
    v_lshrrev_b32 v7, 4, v0
    v_and_b32 v8, 15, v0
    v_mul_u32_u24 v9, 3584, v7
    v_lshl_add_u32 v9, v8, 4, v9
    s_lshl_b32 s50, s39, 8
    s_add_u32 s51, s50, 0
    buffer_load_dwordx4 v[20:23], v9, s[28:31], s51 offen
    s_add_u32 s51, s50, 57344
    buffer_load_dwordx4 v[24:27], v9, s[28:31], s51 offen
    s_add_u32 s51, s50, 114688
    buffer_load_dwordx4 v[28:31], v9, s[28:31], s51 offen
    s_add_u32 s51, s50, 172032
    buffer_load_dwordx4 v[32:35], v9, s[28:31], s51 offen
    s_add_u32 s51, s50, 229376
    buffer_load_dwordx4 v[36:39], v9, s[28:31], s51 offen
    s_add_u32 s51, s50, 286720
    buffer_load_dwordx4 v[40:43], v9, s[28:31], s51 offen
    s_add_u32 s51, s50, 344064
    buffer_load_dwordx4 v[44:47], v9, s[28:31], s51 offen
    s_add_u32 s51, s50, 401408
    buffer_load_dwordx4 v[48:51], v9, s[28:31], s51 offen
    s_add_u32 s51, s50, 458752
    buffer_load_dwordx4 v[52:55], v9, s[28:31], s51 offen
    s_add_u32 s51, s50, 516096
    buffer_load_dwordx4 v[56:59], v9, s[28:31], s51 offen
    s_add_u32 s51, s50, 573440
    buffer_load_dwordx4 v[60:63], v9, s[28:31], s51 offen
    s_add_u32 s51, s50, 630784
    buffer_load_dwordx4 v[64:67], v9, s[28:31], s51 offen
    s_add_u32 s51, s50, 688128
    buffer_load_dwordx4 v[68:71], v9, s[28:31], s51 offen
    s_add_u32 s51, s50, 745472
    buffer_load_dwordx4 v[72:75], v9, s[28:31], s51 offen
    s_add_u32 s51, s50, 802816
    buffer_load_dwordx4 v[76:79], v9, s[28:31], s51 offen
    s_add_u32 s51, s50, 860160
    buffer_load_dwordx4 v[80:83], v9, s[28:31], s51 offen
    s_add_u32 s51, s50, 917504
    buffer_load_dwordx4 v[84:87], v9, s[28:31], s51 offen
    s_add_u32 s51, s50, 974848
    buffer_load_dwordx4 v[88:91], v9, s[28:31], s51 offen
    s_add_u32 s51, s50, 1032192
    buffer_load_dwordx4 v[92:95], v9, s[28:31], s51 offen
    s_add_u32 s51, s50, 1089536
    buffer_load_dwordx4 v[96:99], v9, s[28:31], s51 offen
    s_add_u32 s51, s50, 1146880
    buffer_load_dwordx4 v[100:103], v9, s[28:31], s51 offen
    s_add_u32 s51, s50, 1204224
    buffer_load_dwordx4 v[104:107], v9, s[28:31], s51 offen
    s_add_u32 s51, s50, 1261568
    buffer_load_dwordx4 v[108:111], v9, s[28:31], s51 offen
    s_add_u32 s51, s50, 1318912
    buffer_load_dwordx4 v[112:115], v9, s[28:31], s51 offen
    s_add_u32 s51, s50, 1376256
    buffer_load_dwordx4 v[116:119], v9, s[28:31], s51 offen
    s_add_u32 s51, s50, 1433600
    buffer_load_dwordx4 v[120:123], v9, s[28:31], s51 offen
    s_add_u32 s51, s50, 1490944
    buffer_load_dwordx4 v[124:127], v9, s[28:31], s51 offen
    s_add_u32 s51, s50, 1548288
    buffer_load_dwordx4 v[128:131], v9, s[28:31], s51 offen
    v_mov_b32 v140, 0
    v_mov_b32 v141, 0
    v_mov_b32 v142, 0
    v_mov_b32 v143, 0
    v_mov_b32 v144, 0
    v_mov_b32 v145, 0
    v_mov_b32 v146, 0
    v_mov_b32 v147, 0
    s_waitcnt vmcnt(27)
    v_lshlrev_b32 v11, 16, v20
    v_and_b32 v12, s41, v20
    v_add_f32 v140, v140, v11
    v_add_f32 v141, v141, v12
    v_lshlrev_b32 v11, 16, v21
    v_and_b32 v12, s41, v21
    v_add_f32 v142, v142, v11
    v_add_f32 v143, v143, v12
    v_lshlrev_b32 v11, 16, v22
    v_and_b32 v12, s41, v22
    v_add_f32 v144, v144, v11
    v_add_f32 v145, v145, v12
    v_lshlrev_b32 v11, 16, v23
    v_and_b32 v12, s41, v23
    v_add_f32 v146, v146, v11
    v_add_f32 v147, v147, v12
    s_waitcnt vmcnt(26)
    v_lshlrev_b32 v11, 16, v24
    v_and_b32 v12, s41, v24
    v_add_f32 v140, v140, v11
    v_add_f32 v141, v141, v12
    v_lshlrev_b32 v11, 16, v25
    v_and_b32 v12, s41, v25
    v_add_f32 v142, v142, v11
    v_add_f32 v143, v143, v12
    v_lshlrev_b32 v11, 16, v26
    v_and_b32 v12, s41, v26
    v_add_f32 v144, v144, v11
    v_add_f32 v145, v145, v12
    v_lshlrev_b32 v11, 16, v27
    v_and_b32 v12, s41, v27
    v_add_f32 v146, v146, v11
    v_add_f32 v147, v147, v12
    s_waitcnt vmcnt(25)
    v_lshlrev_b32 v11, 16, v28
    v_and_b32 v12, s41, v28
    v_add_f32 v140, v140, v11
    v_add_f32 v141, v141, v12
    v_lshlrev_b32 v11, 16, v29
    v_and_b32 v12, s41, v29
    v_add_f32 v142, v142, v11
    v_add_f32 v143, v143, v12
    v_lshlrev_b32 v11, 16, v30
    v_and_b32 v12, s41, v30
    v_add_f32 v144, v144, v11
    v_add_f32 v145, v145, v12
    v_lshlrev_b32 v11, 16, v31
    v_and_b32 v12, s41, v31
    v_add_f32 v146, v146, v11
    v_add_f32 v147, v147, v12
    s_waitcnt vmcnt(24)
    v_lshlrev_b32 v11, 16, v32
    v_and_b32 v12, s41, v32
    v_add_f32 v140, v140, v11
    v_add_f32 v141, v141, v12
    v_lshlrev_b32 v11, 16, v33
    v_and_b32 v12, s41, v33
    v_add_f32 v142, v142, v11
    v_add_f32 v143, v143, v12
    v_lshlrev_b32 v11, 16, v34
    v_and_b32 v12, s41, v34
    v_add_f32 v144, v144, v11
    v_add_f32 v145, v145, v12
    v_lshlrev_b32 v11, 16, v35
    v_and_b32 v12, s41, v35
    v_add_f32 v146, v146, v11
    v_add_f32 v147, v147, v12
    s_waitcnt vmcnt(23)
    v_lshlrev_b32 v11, 16, v36
    v_and_b32 v12, s41, v36
    v_add_f32 v140, v140, v11
    v_add_f32 v141, v141, v12
    v_lshlrev_b32 v11, 16, v37
    v_and_b32 v12, s41, v37
    v_add_f32 v142, v142, v11
    v_add_f32 v143, v143, v12
    v_lshlrev_b32 v11, 16, v38
    v_and_b32 v12, s41, v38
    v_add_f32 v144, v144, v11
    v_add_f32 v145, v145, v12
    v_lshlrev_b32 v11, 16, v39
    v_and_b32 v12, s41, v39
    v_add_f32 v146, v146, v11
    v_add_f32 v147, v147, v12
    s_waitcnt vmcnt(22)
    v_lshlrev_b32 v11, 16, v40
    v_and_b32 v12, s41, v40
    v_add_f32 v140, v140, v11
    v_add_f32 v141, v141, v12
    v_lshlrev_b32 v11, 16, v41
    v_and_b32 v12, s41, v41
    v_add_f32 v142, v142, v11
    v_add_f32 v143, v143, v12
    v_lshlrev_b32 v11, 16, v42
    v_and_b32 v12, s41, v42
    v_add_f32 v144, v144, v11
    v_add_f32 v145, v145, v12
    v_lshlrev_b32 v11, 16, v43
    v_and_b32 v12, s41, v43
    v_add_f32 v146, v146, v11
    v_add_f32 v147, v147, v12
    s_waitcnt vmcnt(21)
    v_lshlrev_b32 v11, 16, v44
    v_and_b32 v12, s41, v44
    v_add_f32 v140, v140, v11
    v_add_f32 v141, v141, v12
    v_lshlrev_b32 v11, 16, v45
    v_and_b32 v12, s41, v45
    v_add_f32 v142, v142, v11
    v_add_f32 v143, v143, v12
    v_lshlrev_b32 v11, 16, v46
    v_and_b32 v12, s41, v46
    v_add_f32 v144, v144, v11
    v_add_f32 v145, v145, v12
    v_lshlrev_b32 v11, 16, v47
    v_and_b32 v12, s41, v47
    v_add_f32 v146, v146, v11
    v_add_f32 v147, v147, v12
    s_waitcnt vmcnt(20)
    v_lshlrev_b32 v11, 16, v48
    v_and_b32 v12, s41, v48
    v_add_f32 v140, v140, v11
    v_add_f32 v141, v141, v12
    v_lshlrev_b32 v11, 16, v49
    v_and_b32 v12, s41, v49
    v_add_f32 v142, v142, v11
    v_add_f32 v143, v143, v12
    v_lshlrev_b32 v11, 16, v50
    v_and_b32 v12, s41, v50
    v_add_f32 v144, v144, v11
    v_add_f32 v145, v145, v12
    v_lshlrev_b32 v11, 16, v51
    v_and_b32 v12, s41, v51
    v_add_f32 v146, v146, v11
    v_add_f32 v147, v147, v12
    s_waitcnt vmcnt(19)
    v_lshlrev_b32 v11, 16, v52
    v_and_b32 v12, s41, v52
    v_add_f32 v140, v140, v11
    v_add_f32 v141, v141, v12
    v_lshlrev_b32 v11, 16, v53
    v_and_b32 v12, s41, v53
    v_add_f32 v142, v142, v11
    v_add_f32 v143, v143, v12
    v_lshlrev_b32 v11, 16, v54
    v_and_b32 v12, s41, v54
    v_add_f32 v144, v144, v11
    v_add_f32 v145, v145, v12
    v_lshlrev_b32 v11, 16, v55
    v_and_b32 v12, s41, v55
    v_add_f32 v146, v146, v11
    v_add_f32 v147, v147, v12
    s_waitcnt vmcnt(18)
    v_lshlrev_b32 v11, 16, v56
    v_and_b32 v12, s41, v56
    v_add_f32 v140, v140, v11
    v_add_f32 v141, v141, v12
    v_lshlrev_b32 v11, 16, v57
    v_and_b32 v12, s41, v57
    v_add_f32 v142, v142, v11
    v_add_f32 v143, v143, v12
    v_lshlrev_b32 v11, 16, v58
    v_and_b32 v12, s41, v58
    v_add_f32 v144, v144, v11
    v_add_f32 v145, v145, v12
    v_lshlrev_b32 v11, 16, v59
    v_and_b32 v12, s41, v59
    v_add_f32 v146, v146, v11
    v_add_f32 v147, v147, v12
    s_waitcnt vmcnt(17)
    v_lshlrev_b32 v11, 16, v60
    v_and_b32 v12, s41, v60
    v_add_f32 v140, v140, v11
    v_add_f32 v141, v141, v12
    v_lshlrev_b32 v11, 16, v61
    v_and_b32 v12, s41, v61
    v_add_f32 v142, v142, v11
    v_add_f32 v143, v143, v12
    v_lshlrev_b32 v11, 16, v62
    v_and_b32 v12, s41, v62
    v_add_f32 v144, v144, v11
    v_add_f32 v145, v145, v12
    v_lshlrev_b32 v11, 16, v63
    v_and_b32 v12, s41, v63
    v_add_f32 v146, v146, v11
    v_add_f32 v147, v147, v12
    s_waitcnt vmcnt(16)
    v_lshlrev_b32 v11, 16, v64
    v_and_b32 v12, s41, v64
    v_add_f32 v140, v140, v11
    v_add_f32 v141, v141, v12
    v_lshlrev_b32 v11, 16, v65
    v_and_b32 v12, s41, v65
    v_add_f32 v142, v142, v11
    v_add_f32 v143, v143, v12
    v_lshlrev_b32 v11, 16, v66
    v_and_b32 v12, s41, v66
    v_add_f32 v144, v144, v11
    v_add_f32 v145, v145, v12
    v_lshlrev_b32 v11, 16, v67
    v_and_b32 v12, s41, v67
    v_add_f32 v146, v146, v11
    v_add_f32 v147, v147, v12
    s_waitcnt vmcnt(15)
    v_lshlrev_b32 v11, 16, v68
    v_and_b32 v12, s41, v68
    v_add_f32 v140, v140, v11
    v_add_f32 v141, v141, v12
    v_lshlrev_b32 v11, 16, v69
    v_and_b32 v12, s41, v69
    v_add_f32 v142, v142, v11
    v_add_f32 v143, v143, v12
    v_lshlrev_b32 v11, 16, v70
    v_and_b32 v12, s41, v70
    v_add_f32 v144, v144, v11
    v_add_f32 v145, v145, v12
    v_lshlrev_b32 v11, 16, v71
    v_and_b32 v12, s41, v71
    v_add_f32 v146, v146, v11
    v_add_f32 v147, v147, v12
    s_waitcnt vmcnt(14)
    v_lshlrev_b32 v11, 16, v72
    v_and_b32 v12, s41, v72
    v_add_f32 v140, v140, v11
    v_add_f32 v141, v141, v12
    v_lshlrev_b32 v11, 16, v73
    v_and_b32 v12, s41, v73
    v_add_f32 v142, v142, v11
    v_add_f32 v143, v143, v12
    v_lshlrev_b32 v11, 16, v74
    v_and_b32 v12, s41, v74
    v_add_f32 v144, v144, v11
    v_add_f32 v145, v145, v12
    v_lshlrev_b32 v11, 16, v75
    v_and_b32 v12, s41, v75
    v_add_f32 v146, v146, v11
    v_add_f32 v147, v147, v12
    s_waitcnt vmcnt(13)
    v_lshlrev_b32 v11, 16, v76
    v_and_b32 v12, s41, v76
    v_add_f32 v140, v140, v11
    v_add_f32 v141, v141, v12
    v_lshlrev_b32 v11, 16, v77
    v_and_b32 v12, s41, v77
    v_add_f32 v142, v142, v11
    v_add_f32 v143, v143, v12
    v_lshlrev_b32 v11, 16, v78
    v_and_b32 v12, s41, v78
    v_add_f32 v144, v144, v11
    v_add_f32 v145, v145, v12
    v_lshlrev_b32 v11, 16, v79
    v_and_b32 v12, s41, v79
    v_add_f32 v146, v146, v11
    v_add_f32 v147, v147, v12
    s_waitcnt vmcnt(12)
    v_lshlrev_b32 v11, 16, v80
    v_and_b32 v12, s41, v80
    v_add_f32 v140, v140, v11
    v_add_f32 v141, v141, v12
    v_lshlrev_b32 v11, 16, v81
    v_and_b32 v12, s41, v81
    v_add_f32 v142, v142, v11
    v_add_f32 v143, v143, v12
    v_lshlrev_b32 v11, 16, v82
    v_and_b32 v12, s41, v82
    v_add_f32 v144, v144, v11
    v_add_f32 v145, v145, v12
    v_lshlrev_b32 v11, 16, v83
    v_and_b32 v12, s41, v83
    v_add_f32 v146, v146, v11
    v_add_f32 v147, v147, v12
    s_waitcnt vmcnt(11)
    v_lshlrev_b32 v11, 16, v84
    v_and_b32 v12, s41, v84
    v_add_f32 v140, v140, v11
    v_add_f32 v141, v141, v12
    v_lshlrev_b32 v11, 16, v85
    v_and_b32 v12, s41, v85
    v_add_f32 v142, v142, v11
    v_add_f32 v143, v143, v12
    v_lshlrev_b32 v11, 16, v86
    v_and_b32 v12, s41, v86
    v_add_f32 v144, v144, v11
    v_add_f32 v145, v145, v12
    v_lshlrev_b32 v11, 16, v87
    v_and_b32 v12, s41, v87
    v_add_f32 v146, v146, v11
    v_add_f32 v147, v147, v12
    s_waitcnt vmcnt(10)
    v_lshlrev_b32 v11, 16, v88
    v_and_b32 v12, s41, v88
    v_add_f32 v140, v140, v11
    v_add_f32 v141, v141, v12
    v_lshlrev_b32 v11, 16, v89
    v_and_b32 v12, s41, v89
    v_add_f32 v142, v142, v11
    v_add_f32 v143, v143, v12
    v_lshlrev_b32 v11, 16, v90
    v_and_b32 v12, s41, v90
    v_add_f32 v144, v144, v11
    v_add_f32 v145, v145, v12
    v_lshlrev_b32 v11, 16, v91
    v_and_b32 v12, s41, v91
    v_add_f32 v146, v146, v11
    v_add_f32 v147, v147, v12
    s_waitcnt vmcnt(9)
    v_lshlrev_b32 v11, 16, v92
    v_and_b32 v12, s41, v92
    v_add_f32 v140, v140, v11
    v_add_f32 v141, v141, v12
    v_lshlrev_b32 v11, 16, v93
    v_and_b32 v12, s41, v93
    v_add_f32 v142, v142, v11
    v_add_f32 v143, v143, v12
    v_lshlrev_b32 v11, 16, v94
    v_and_b32 v12, s41, v94
    v_add_f32 v144, v144, v11
    v_add_f32 v145, v145, v12
    v_lshlrev_b32 v11, 16, v95
    v_and_b32 v12, s41, v95
    v_add_f32 v146, v146, v11
    v_add_f32 v147, v147, v12
    s_waitcnt vmcnt(8)
    v_lshlrev_b32 v11, 16, v96
    v_and_b32 v12, s41, v96
    v_add_f32 v140, v140, v11
    v_add_f32 v141, v141, v12
    v_lshlrev_b32 v11, 16, v97
    v_and_b32 v12, s41, v97
    v_add_f32 v142, v142, v11
    v_add_f32 v143, v143, v12
    v_lshlrev_b32 v11, 16, v98
    v_and_b32 v12, s41, v98
    v_add_f32 v144, v144, v11
    v_add_f32 v145, v145, v12
    v_lshlrev_b32 v11, 16, v99
    v_and_b32 v12, s41, v99
    v_add_f32 v146, v146, v11
    v_add_f32 v147, v147, v12
    s_waitcnt vmcnt(7)
    v_lshlrev_b32 v11, 16, v100
    v_and_b32 v12, s41, v100
    v_add_f32 v140, v140, v11
    v_add_f32 v141, v141, v12
    v_lshlrev_b32 v11, 16, v101
    v_and_b32 v12, s41, v101
    v_add_f32 v142, v142, v11
    v_add_f32 v143, v143, v12
    v_lshlrev_b32 v11, 16, v102
    v_and_b32 v12, s41, v102
    v_add_f32 v144, v144, v11
    v_add_f32 v145, v145, v12
    v_lshlrev_b32 v11, 16, v103
    v_and_b32 v12, s41, v103
    v_add_f32 v146, v146, v11
    v_add_f32 v147, v147, v12
    s_waitcnt vmcnt(6)
    v_lshlrev_b32 v11, 16, v104
    v_and_b32 v12, s41, v104
    v_add_f32 v140, v140, v11
    v_add_f32 v141, v141, v12
    v_lshlrev_b32 v11, 16, v105
    v_and_b32 v12, s41, v105
    v_add_f32 v142, v142, v11
    v_add_f32 v143, v143, v12
    v_lshlrev_b32 v11, 16, v106
    v_and_b32 v12, s41, v106
    v_add_f32 v144, v144, v11
    v_add_f32 v145, v145, v12
    v_lshlrev_b32 v11, 16, v107
    v_and_b32 v12, s41, v107
    v_add_f32 v146, v146, v11
    v_add_f32 v147, v147, v12
    s_waitcnt vmcnt(5)
    v_lshlrev_b32 v11, 16, v108
    v_and_b32 v12, s41, v108
    v_add_f32 v140, v140, v11
    v_add_f32 v141, v141, v12
    v_lshlrev_b32 v11, 16, v109
    v_and_b32 v12, s41, v109
    v_add_f32 v142, v142, v11
    v_add_f32 v143, v143, v12
    v_lshlrev_b32 v11, 16, v110
    v_and_b32 v12, s41, v110
    v_add_f32 v144, v144, v11
    v_add_f32 v145, v145, v12
    v_lshlrev_b32 v11, 16, v111
    v_and_b32 v12, s41, v111
    v_add_f32 v146, v146, v11
    v_add_f32 v147, v147, v12
    s_waitcnt vmcnt(4)
    v_lshlrev_b32 v11, 16, v112
    v_and_b32 v12, s41, v112
    v_add_f32 v140, v140, v11
    v_add_f32 v141, v141, v12
    v_lshlrev_b32 v11, 16, v113
    v_and_b32 v12, s41, v113
    v_add_f32 v142, v142, v11
    v_add_f32 v143, v143, v12
    v_lshlrev_b32 v11, 16, v114
    v_and_b32 v12, s41, v114
    v_add_f32 v144, v144, v11
    v_add_f32 v145, v145, v12
    v_lshlrev_b32 v11, 16, v115
    v_and_b32 v12, s41, v115
    v_add_f32 v146, v146, v11
    v_add_f32 v147, v147, v12
    s_waitcnt vmcnt(3)
    v_lshlrev_b32 v11, 16, v116
    v_and_b32 v12, s41, v116
    v_add_f32 v140, v140, v11
    v_add_f32 v141, v141, v12
    v_lshlrev_b32 v11, 16, v117
    v_and_b32 v12, s41, v117
    v_add_f32 v142, v142, v11
    v_add_f32 v143, v143, v12
    v_lshlrev_b32 v11, 16, v118
    v_and_b32 v12, s41, v118
    v_add_f32 v144, v144, v11
    v_add_f32 v145, v145, v12
    v_lshlrev_b32 v11, 16, v119
    v_and_b32 v12, s41, v119
    v_add_f32 v146, v146, v11
    v_add_f32 v147, v147, v12
    s_waitcnt vmcnt(2)
    v_lshlrev_b32 v11, 16, v120
    v_and_b32 v12, s41, v120
    v_add_f32 v140, v140, v11
    v_add_f32 v141, v141, v12
    v_lshlrev_b32 v11, 16, v121
    v_and_b32 v12, s41, v121
    v_add_f32 v142, v142, v11
    v_add_f32 v143, v143, v12
    v_lshlrev_b32 v11, 16, v122
    v_and_b32 v12, s41, v122
    v_add_f32 v144, v144, v11
    v_add_f32 v145, v145, v12
    v_lshlrev_b32 v11, 16, v123
    v_and_b32 v12, s41, v123
    v_add_f32 v146, v146, v11
    v_add_f32 v147, v147, v12
    s_waitcnt vmcnt(1)
    v_lshlrev_b32 v11, 16, v124
    v_and_b32 v12, s41, v124
    v_add_f32 v140, v140, v11
    v_add_f32 v141, v141, v12
    v_lshlrev_b32 v11, 16, v125
    v_and_b32 v12, s41, v125
    v_add_f32 v142, v142, v11
    v_add_f32 v143, v143, v12
    v_lshlrev_b32 v11, 16, v126
    v_and_b32 v12, s41, v126
    v_add_f32 v144, v144, v11
    v_add_f32 v145, v145, v12
    v_lshlrev_b32 v11, 16, v127
    v_and_b32 v12, s41, v127
    v_add_f32 v146, v146, v11
    v_add_f32 v147, v147, v12
    s_waitcnt vmcnt(0)
    v_lshlrev_b32 v11, 16, v128
    v_and_b32 v12, s41, v128
    v_add_f32 v140, v140, v11
    v_add_f32 v141, v141, v12
    v_lshlrev_b32 v11, 16, v129
    v_and_b32 v12, s41, v129
    v_add_f32 v142, v142, v11
    v_add_f32 v143, v143, v12
    v_lshlrev_b32 v11, 16, v130
    v_and_b32 v12, s41, v130
    v_add_f32 v144, v144, v11
    v_add_f32 v145, v145, v12
    v_lshlrev_b32 v11, 16, v131
    v_and_b32 v12, s41, v131
    v_add_f32 v146, v146, v11
    v_add_f32 v147, v147, v12
    v_lshlrev_b32 v11, 9, v7
    v_lshl_add_u32 v11, v8, 5, v11
    ds_write_b128 v11, v[140:143]
    ds_write_b128 v11, v[144:147] offset:16
    s_waitcnt lgkmcnt(0)
    s_barrier
    s_cmp_ge_u32 s38, 2
    s_cbranch_scc1 K3_PF1
    v_lshlrev_b32 v11, 2, v0
    ds_read_b32 v20, v11 offset:0
    ds_read_b32 v21, v11 offset:512
    ds_read_b32 v22, v11 offset:1024
    ds_read_b32 v23, v11 offset:1536
    ds_read_b32 v24, v11 offset:2048
    ds_read_b32 v25, v11 offset:2560
    ds_read_b32 v26, v11 offset:3072
    ds_read_b32 v27, v11 offset:3584
    ds_read_b32 v28, v11 offset:4096
    ds_read_b32 v29, v11 offset:4608
    ds_read_b32 v30, v11 offset:5120
    ds_read_b32 v31, v11 offset:5632
    ds_read_b32 v32, v11 offset:6144
    ds_read_b32 v33, v11 offset:6656
    ds_read_b32 v34, v11 offset:7168
    ds_read_b32 v35, v11 offset:7680
    s_waitcnt lgkmcnt(0)
    v_add_f32 v20, v20, v21
    v_add_f32 v20, v20, v22
    v_add_f32 v20, v20, v23
    v_add_f32 v20, v20, v24
    v_add_f32 v20, v20, v25
    v_add_f32 v20, v20, v26
    v_add_f32 v20, v20, v27
    v_add_f32 v20, v20, v28
    v_add_f32 v20, v20, v29
    v_add_f32 v20, v20, v30
    v_add_f32 v20, v20, v31
    v_add_f32 v20, v20, v32
    v_add_f32 v20, v20, v33
    v_add_f32 v20, v20, v34
    v_add_f32 v20, v20, v35
    v_cvt_pk_bf16_f32 v24, v20, v20
    v_and_b32 v22, s41, v24
    v_sub_f32 v22, v20, v22
    v_cvt_pk_bf16_f32 v25, v22, v22
    v_lshlrev_b32 v11, 6, v8
    v_lshl_add_u32 v11, v7, 3, v11
    s_lshl_b32 s50, s39, 11
    s_lshl_b32 s51, s37, 10
    s_add_u32 s50, s50, s51
    s_add_u32 s50, s50, 524288
    buffer_store_dwordx2 v[24:25], v11, s[32:35], s50 offen sc1
    s_lshl_b32 s50, s2, 7
    s_lshl_b32 s51, s38, 2
    s_add_u32 s50, s50, s51
    s_add_u32 s50, s50, 786432
    v_mov_b32 v26, 1
    v_mov_b32 v27, 0
    s_waitcnt vmcnt(0)
    s_mov_b64 exec, 1
    buffer_store_dword v26, v27, s[32:35], s50 offen sc1
    s_mov_b64 exec, -1
K3_PF1:
    s_barrier
K3_PF2:
    s_lshr_b32 s60, s36, 3
    s_lshl_b32 s60, s60, 2
    s_add_u32 s60, s60, s38
    s_mul_i32 s61, s60, 7168
    v_lshlrev_b32 v10, 7, v1
    v_mov_b32 v11, 0x7fff0000
    v_cmp_gt_u32 vcc, 56, v1
    s_nop 1
    v_cndmask_b32 v10, v11, v10, vcc
    s_add_u32 s62, s61, 524288
    buffer_load_dword v150, v10, s[20:23], s62 offen
    buffer_load_dword v151, v10, s[24:27], s62 offen
    s_add_u32 s62, s61, 638976
    buffer_load_dword v152, v10, s[20:23], s62 offen
    buffer_load_dword v153, v10, s[24:27], s62 offen
    s_add_u32 s62, s61, 753664
    buffer_load_dword v154, v10, s[20:23], s62 offen
    buffer_load_dword v155, v10, s[24:27], s62 offen
    s_add_u32 s62, s61, 868352
    buffer_load_dword v156, v10, s[20:23], s62 offen
    buffer_load_dword v157, v10, s[24:27], s62 offen
    s_add_u32 s62, s61, 983040
    buffer_load_dword v158, v10, s[20:23], s62 offen
    buffer_load_dword v159, v10, s[24:27], s62 offen
    s_add_u32 s62, s61, 1097728
    buffer_load_dword v160, v10, s[20:23], s62 offen
    buffer_load_dword v161, v10, s[24:27], s62 offen
    s_add_u32 s62, s61, 1212416
    buffer_load_dword v162, v10, s[20:23], s62 offen
    buffer_load_dword v163, v10, s[24:27], s62 offen
    s_add_u32 s62, s61, 1327104
    buffer_load_dword v164, v10, s[20:23], s62 offen
    buffer_load_dword v165, v10, s[24:27], s62 offen
    s_add_u32 s62, s61, 1441792
    buffer_load_dword v166, v10, s[20:23], s62 offen
    buffer_load_dword v167, v10, s[24:27], s62 offen
    s_add_u32 s62, s61, 1556480
    buffer_load_dword v168, v10, s[20:23], s62 offen
    buffer_load_dword v169, v10, s[24:27], s62 offen
    s_add_u32 s62, s61, 0
    buffer_load_dword v170, v10, s[16:19], s62 offen
    s_add_u32 s62, s61, 114688
    buffer_load_dword v171, v10, s[16:19], s62 offen
    s_add_u32 s62, s61, 229376
    buffer_load_dword v172, v10, s[16:19], s62 offen
    s_add_u32 s62, s61, 344064
    buffer_load_dword v173, v10, s[16:19], s62 offen
    s_add_u32 s62, s61, 458752
    buffer_load_dword v174, v10, s[16:19], s62 offen
    s_add_u32 s62, s61, 573440
    buffer_load_dword v175, v10, s[16:19], s62 offen
    s_add_u32 s62, s61, 688128
    buffer_load_dword v176, v10, s[16:19], s62 offen
    s_add_u32 s62, s61, 802816
    buffer_load_dword v177, v10, s[16:19], s62 offen
    s_add_u32 s62, s61, 917504
    buffer_load_dword v178, v10, s[16:19], s62 offen
    s_add_u32 s62, s61, 1032192
    buffer_load_dword v179, v10, s[16:19], s62 offen
    s_add_u32 s62, s61, 1146880
    buffer_load_dword v180, v10, s[16:19], s62 offen
    s_add_u32 s62, s61, 1261568
    buffer_load_dword v181, v10, s[16:19], s62 offen
    s_add_u32 s62, s61, 1376256
    buffer_load_dword v182, v10, s[16:19], s62 offen
    s_add_u32 s62, s61, 1490944
    buffer_load_dword v183, v10, s[16:19], s62 offen
K3_END:
    s_endpgm
.section .rodata,"a"
.p2align 6
.amdhsa_kernel k1_kernel
  .amdhsa_next_free_vgpr 256
  .amdhsa_next_free_sgpr 102
  .amdhsa_accum_offset 256
  .amdhsa_group_segment_fixed_size 0
  .amdhsa_kernarg_size 88
  .amdhsa_user_sgpr_count 2
  .amdhsa_user_sgpr_kernarg_segment_ptr 1
  .amdhsa_system_sgpr_workgroup_id_x 1
.end_amdhsa_kernel
.p2align 6
.amdhsa_kernel k3_kernel
  .amdhsa_next_free_vgpr 506
  .amdhsa_next_free_sgpr 102
  .amdhsa_accum_offset 256
  .amdhsa_group_segment_fixed_size 0
  .amdhsa_kernarg_size 88
  .amdhsa_user_sgpr_count 2
  .amdhsa_user_sgpr_kernarg_segment_ptr 1
  .amdhsa_system_sgpr_workgroup_id_x 1
.end_amdhsa_kernel
```
